```python
import torch

def _softmax(x, axis=-1):
    return torch.softmax(x, dim=axis)
def _gelu(x):
    return torch.nn.functional.gelu(x, approximate="tanh")
def _silu(x):
    return torch.nn.functional.silu(x)
def _sigmoid(x):
    return torch.sigmoid(x)
def _layernorm(x, axis=-1, eps=1e-5):
    m = x.mean(dim=axis, keepdim=True)
    v = x.var(dim=axis, keepdim=True, unbiased=False)
    return (x - m) / torch.sqrt(v + eps)
def _scatter_add(tgt, idx, src, axis=0):
    return tgt.clone().index_add_(axis, idx, src)
def _segment_sum(src, seg, n):
    out = torch.zeros((n,) + src.shape[1:], dtype=src.dtype)
    return out.index_add_(0, seg, src)
def _pad(x, pw):
    flat = tuple(v for pair in reversed(pw) for v in pair)
    return torch.nn.functional.pad(x, flat)

kernel_name = 'gated_mix__ssm_conv_s4d__mixer_token_mlp__prompt'

def setup_inputs():

    _w = (lambda a: (lambda t: t.to(torch.bfloat16) if t.is_floating_point() else t)(torch.as_tensor(a)))
    def _A_setup():
        Bsz, L, D, N = 1, 2048, 640, 128
        return {
            "u": _w((lambda *s: torch.randn(*s, dtype=torch.bfloat16) * 0.05)(Bsz, L, D)),
            "log_A_real": _w((lambda *s: torch.randn(*s, dtype=torch.bfloat16) * 3.2)(D, N) * 0.5),
            "A_imag": _w((lambda *s: torch.randn(*s, dtype=torch.bfloat16) * 0.05)(D, N) * 3.14),
            "C_real": _w((lambda *s: torch.randn(*s, dtype=torch.bfloat16) * 0.1)(D, N) / N ** 0.5),
            "C_imag": _w((lambda *s: torch.randn(*s, dtype=torch.bfloat16) * 0.1)(D, N) / N ** 0.5),
            "log_dt": _w((lambda *s: torch.randn(*s, dtype=torch.bfloat16) * 0.05)(D) * 0.5 - 4.0),
            "D_skip": _w((lambda *s: torch.randn(*s, dtype=torch.bfloat16) * 0.05)(D)),
        }
    _A_in = _A_setup()

    def _B_setup():
        B, S, D, F = 1, 2048, 640, 1728
        return {
            "x": _w((lambda *s: torch.randn(*s, dtype=torch.bfloat16) * 0.05)(B, S, D)),
            "w1": _w((lambda *s: torch.randn(*s, dtype=torch.bfloat16) * 0.2)(S, F) * (S ** -0.5)),
            "b1": _w((lambda *s: torch.randn(*s, dtype=torch.bfloat16) * 3.2)(F) * 0.02),
            "w2": _w((lambda *s: torch.randn(*s, dtype=torch.bfloat16) * 0.05)(F, S) * (F ** -0.5)),
            "b2": _w((lambda *s: torch.randn(*s, dtype=torch.bfloat16) * 0.1)(S) * 0.02),
        }
    _B_in = _B_setup()

    return {
        "A_u": _A_in["u"],
        "A_log_A_real": _A_in["log_A_real"],
        "A_A_imag": _A_in["A_imag"],
        "A_C_real": _A_in["C_real"],
        "A_C_imag": _A_in["C_imag"],
        "A_log_dt": _A_in["log_dt"],
        "A_D_skip": _A_in["D_skip"],
        "B_x": _B_in["x"],
        "B_w1": _B_in["w1"],
        "B_b1": _B_in["b1"],
        "B_w2": _B_in["w2"],
        "B_b2": _B_in["b2"],
        "gate_w": _w((lambda *s: torch.randn(*s, dtype=torch.bfloat16) * 0.05)(640) * 16.0),
    }

def reference(A_u, A_log_A_real, A_A_imag, A_C_real, A_C_imag, A_log_dt, A_D_skip, B_x, B_w1, B_b1, B_w2, B_b2, gate_w):
    def _A_ref(u, log_A_real, A_imag, C_real, C_imag, log_dt, D_skip):
        L = u.shape[1]
        dt = torch.exp(log_dt)
        A = -torch.exp(log_A_real) + 1j * A_imag
        C = (C_real + 1j * C_imag) * dt[:, None]
        pos = (lambda x, dt: x.to(dt))(torch.arange(L), log_dt.dtype)
        P = torch.exp((A * dt[:, None])[:, :, None] * pos[None, None, :])
        K = 2.0 * torch.einsum("dn,dnl->dl", C, P).real
        L2 = 2 * L
        u_t = (lambda x, *d: x.permute(*d))(u, 0, 2, 1)
        Kf = (lambda x, *a, **k: torch.fft.rfft(x.float(), *a, **k))(K, L2)
        Uf = (lambda x, *a, **k: torch.fft.rfft(x.float(), *a, **k))(u_t, L2)
        y = (lambda x, *a, **k: torch.fft.irfft(x, *a, **k).to(torch.bfloat16))(Uf * Kf[None, :, :], L2)[:, :, :L]
        y = (lambda x, *d: x.permute(*d))(y, 0, 2, 1)
        return y + u * D_skip[None, None, :]

    def _B_ref(x, w1, b1, w2, b2):
        B, S, D = x.shape
        h = _layernorm(x, axis=-1)
        u = torch.einsum("bsd,sf->bdf", h, w1) + b1
        u = _gelu(u)
        y = torch.einsum("bdf,fs->bds", u, w2) + b2
        return (lambda x, *d: x.permute(*d))(y, 0, 2, 1)

    x = A_u
    g = _sigmoid((x * gate_w).sum(-1, keepdims=True))
    a = _A_ref(x, A_log_A_real, A_A_imag, A_C_real, A_C_imag, A_log_dt, A_D_skip)
    b = _B_ref(x, B_w1, B_b1, B_w2, B_b2)
    return g * a + (1 - g) * b
```

```asm
; @launch grid=(256,1,1) block=(256,1,1) lds=163840
.amdgcn_target "amdgcn-amd-amdhsa--gfx950"
.text
.globl gated_mix__ssm_conv_s4d__mixer_token_mlp__prompt_kernel
.p2align 8
.type gated_mix__ssm_conv_s4d__mixer_token_mlp__prompt_kernel,@function
gated_mix__ssm_conv_s4d__mixer_token_mlp__prompt_kernel:
    s_cmp_ge_u32 s2, 0x100
    s_cbranch_scc1 L_exit
    s_load_dwordx16 s[16:31], s[0:1], 0
    s_load_dwordx16 s[32:47], s[0:1], 64
    v_lshrrev_b32 v1, 6, v0
    v_and_b32 v0, 63, v0
    v_readfirstlane_b32 s3, v1
    v_lshlrev_b32 v1, 4, v0
    s_mov_b32 s83, 0xffff0000
    v_mov_b32 v20, 157296
    v_mov_b32 v16, 0
    v_mov_b32 v17, 0
    v_mov_b32 v18, 0
    v_mov_b32 v19, 0
    ds_write_b128 v20, v[16:19]
    ds_write_b128 v20, v[16:19] offset:16
    v_lshrrev_b32 v24, 5, v0
    v_and_b32 v25, 31, v0
    v_lshlrev_b32 v25, 3, v25
    v_mul_u32_u24 v18, 1280, v24
    v_add_u32 v18, v18, v25
    s_lshl_b32 s80, s2, 2
    s_add_u32 s80, s80, s3
    s_mul_i32 s80, s80, 2560
    s_and_b32 s5, s2, 7
    s_lshr_b32 s91, s2, 3
    s_and_b32 s15, s91, 3
    s_lshr_b32 s78, s91, 2
    s_lshr_b32 s79, s5, 1
    s_and_b32 s6, s5, 1
    s_lshl_b32 s6, s6, 2
    s_add_u32 s6, s6, s15
    s_mul_i32 s7, s79, 7
    s_add_u32 s7, s7, s78
    s_cmp_lt_u32 s78, 7
    s_cselect_b32 s11, 1, 0
    s_cmp_lt_u32 s7, 27
    s_cselect_b32 s11, s11, 0
    s_mul_i32 s7, s7, s11
    s_mul_i32 s12, s78, 0
    s_add_u32 s12, s12, s15
    s_and_b32 s12, s12, 3
    s_mul_i32 s98, s12, 4
    s_cmp_eq_u32 s3, 3
    s_cselect_b32 s85, 5, 4
    s_mul_i32 s12, s12, s85
    s_cselect_b32 s75, -19, -15
    s_and_b32 s85, s5, 1
    s_mul_i32 s85, s85, 1
    s_add_u32 s12, s12, s85
    s_add_u32 s98, s98, s85
    s_and_b32 s90, s91, 7
    s_lshr_b32 s85, s91, 3
    s_lshl_b32 s8, s5, 2
    s_add_u32 s8, s8, s85
    s_sub_u32 s14, 31, s91
    s_lshl_b32 s85, s3, 5
    s_add_u32 s14, s14, s85
    s_cmp_lt_u32 s14, 80
    s_cselect_b32 s10, 1, 0
    s_cselect_b32 s14, s14, 0
    s_mul_i32 s9, s5, 80
    s_add_u32 s9, s9, s14
    s_lshl_b32 s72, s3, 15
    s_mul_i32 s73, s3, 8736
    s_add_u32 s73, s73, 131072
    s_mul_i32 s14, s3, 15
    s_add_u32 s14, s14, s12
    s_mul_i32 s74, s14, 110592
    s_lshl_b32 s15, s7, 7
    s_add_u32 s74, s74, s15
    s_mul_i32 s96, s98, 110592
    s_add_u32 s96, s96, s15
    s_mov_b32 s97, -1658880
    s_mul_i32 s77, s75, 40960
    s_mul_i32 s75, s75, 110592
    s_mul_i32 s76, s14, 40960
    s_mul_i32 s15, s6, 1280
    s_add_u32 s76, s76, s15
    s_add_u32 s76, s76, 0x100000
    s_lshr_b32 s15, s9, 1
    s_lshl_b32 s15, s15, 2
    s_waitcnt lgkmcnt(0)
    s_mov_b32 s48, s16
    s_and_b32 s49, s17, 0xffff
    s_mov_b32 s50, 0x280000
    s_mov_b32 s51, 0x20000
    buffer_load_dwordx2 v[64:65], v18, s[48:51], s80 offen offset:0 nt
    buffer_load_dwordx2 v[66:67], v18, s[48:51], s80 offen offset:256 nt
    buffer_load_dwordx2 v[68:69], v18, s[48:51], s80 offen offset:512 nt
    buffer_load_dwordx2 v[70:71], v18, s[48:51], s80 offen offset:768 nt
    buffer_load_dwordx2 v[72:73], v18, s[48:51], s80 offen offset:1024 nt
    s_getpc_b64 s[92:93]
L_pc:
    s_lshl_b32 s14, s91, 2
    s_add_u32 s14, s14, s3
    s_min_u32 s14, s14, (L_exit-L_pc)/512-1
    s_lshl_b32 s14, s14, 9
    v_lshlrev_b32 v19, 3, v0
    v_add_u32 v19, s14, v19
    global_load_dwordx2 v[252:253], v19, s[92:93]
    s_load_dword s4, s[46:47], 0
    s_load_dword s81, s[26:27], s15
    s_load_dword s82, s[28:29], s15
    s_mov_b32 s52, s32
    s_and_b32 s53, s33, 0xffff
    s_mov_b32 s54, 0x6c0000
    s_mov_b32 s55, 0x20000
    s_mul_i32 s54, s54, s11
    s_cmp_eq_u32 s3, 3
    s_cbranch_scc1 L_ld0
    v_lshlrev_b32 v19, 2, v0
    s_lshl_b32 s85, s9, 8
    v_add_u32 v19, s85, v19
    global_load_dword v84, v19, s[18:19] nt
    global_load_dword v85, v19, s[20:21] nt
    global_load_dword v86, v19, s[22:23] nt
    global_load_dword v87, v19, s[24:25] nt
    v_lshrrev_b32 v20, 4, v0
    v_lshlrev_b32 v20, 3, v20
    s_lshl_b32 s14, s7, 7
    s_lshl_b32 s15, s3, 5
    s_add_u32 s14, s14, s15
    v_add_u32 v20, s14, v20
    global_load_dwordx2 v[28:29], v20, s[34:35]
    v_and_b32 v20, 15, v0
    s_lshl_b32 s14, s8, 6
    s_lshl_b32 s15, s3, 4
    s_add_u32 s14, s14, s15
    v_add_u32 v30, s14, v20
    v_lshlrev_b32 v30, 1, v30
    global_load_ushort v15, v30, s[38:39]
    global_load_dwordx2 v[208:209], v25, s[40:41] offset:0
    global_load_dwordx2 v[210:211], v25, s[40:41] offset:256
    global_load_dwordx2 v[212:213], v25, s[40:41] offset:512
    global_load_dwordx2 v[214:215], v25, s[40:41] offset:768
    global_load_dwordx2 v[216:217], v25, s[40:41] offset:1024
    v_lshrrev_b32 v20, 3, v0
    v_mul_u32_u24 v20, 3456, v20
    v_and_b32 v21, 7, v0
    v_bfe_u32 v22, v0, 4, 1
    v_lshlrev_b32 v22, 1, v22
    v_xor_b32 v21, v21, v22
    v_xor_b32 v22, 0, v21
    v_lshl_add_u32 v2, v22, 4, v20
    v_xor_b32 v22, 4, v21
    v_lshl_add_u32 v3, v22, 4, v20
    v_add_u32 v3, 26624, v3
    v_xor_b32 v22, 0, v21
    v_lshl_add_u32 v4, v22, 4, v20
    v_add_u32 v4, 53248, v4
    v_xor_b32 v22, 4, v21
    v_lshl_add_u32 v5, v22, 4, v20
    v_add_u32 v5, 79872, v5
    s_mov_b32 s56, s36
    s_and_b32 s57, s37, 0xffff
    s_mov_b32 s58, 0x6c0000
    s_mov_b32 s59, 0x20000
    s_mov_b32 s60, s46
    s_and_b32 s61, s47, 0xffff
    s_mov_b32 s62, 0x1000000
    s_mov_b32 s63, 0x20000
    s_mov_b32 s68, s42
    s_and_b32 s69, s43, 0xffff
    s_mov_b32 s70, 0x280000
    s_mov_b32 s71, 0x20000
    s_add_u32 s64, s46, 0x700000
    s_addc_u32 s65, s47, 0
    s_and_b32 s65, s65, 0xffff
    s_mov_b32 s66, 0x21c000
    s_mov_b32 s67, 0x20000
    s_lshl_b32 s14, s3, 1
    v_add_u32 v26, s14, v24
    v_mul_u32_u24 v27, 1344, v26
    v_add_u32 v27, v27, v25
    v_add_u32 v27, 118784, v27
    v_lshrrev_b32 v20, 4, v0
    v_bfe_u32 v21, v0, 2, 2
    v_lshl_add_u32 v22, v20, 3, v21
    v_lshlrev_b32 v22, 7, v22
    v_and_b32 v23, 3, v0
    v_lshl_add_u32 v22, v23, 3, v22
    v_add_u32 v22, s72, v22
    v_lshrrev_b32 v21, 1, v21
    v_and_b32 v23, 1, v20
    v_lshl_or_b32 v21, v23, 1, v21
    v_xor_b32 v21, s3, v21
    v_xor_b32 v23, 0, v21
    v_lshl_add_u32 v6, v23, 5, v22
    v_xor_b32 v23, 1, v21
    v_lshl_add_u32 v7, v23, 5, v22
    v_xor_b32 v23, 2, v21
    v_lshl_add_u32 v8, v23, 5, v22
    v_xor_b32 v23, 3, v21
    v_lshl_add_u32 v9, v23, 5, v22
    v_mul_u32_u24 v10, 10240, v20
    v_and_b32 v21, 15, v0
    v_lshl_add_u32 v10, v21, 4, v10
    v_add_u32 v11, s72, v1
    s_xor_b32 s14, s3, 1
    s_lshl_b32 s14, s14, 15
    v_add_u32 v12, s14, v1
    s_xor_b32 s14, s3, 2
    s_lshl_b32 s14, s14, 15
    v_add_u32 v13, s14, v1
    s_xor_b32 s14, s3, 3
    s_lshl_b32 s14, s14, 15
    v_add_u32 v14, s14, v1
    s_waitcnt lgkmcnt(0)
    s_mul_i32 s4, s4, 1664525
    s_add_u32 s4, s4, 1013904223
    v_lshlrev_b32 v16, 5, v0
    v_sub_u32 v16, 2044, v16
    s_add_u32 s14, s73, 4640
    v_mov_b32 v19, 17024
    v_add_u32 v17, 0, v16
    v_cvt_f32_u32 v18, v17
    v_min_u32 v17, 0x80, v17
    v_cvt_pk_bf16_f32 v18, v18, v18
    v_sub_u32_sdwa v18, v18, v19 dst_sel:DWORD dst_unused:UNUSED_PAD src0_sel:WORD_0 src1_sel:DWORD
    v_max_i32 v18, v18, v17
    v_lshl_add_u32 v32, v18, 1, s14
    v_add_u32 v17, -4, v16
    v_cvt_f32_u32 v18, v17
    v_min_u32 v17, 0x80, v17
    v_cvt_pk_bf16_f32 v18, v18, v18
    v_sub_u32_sdwa v18, v18, v19 dst_sel:DWORD dst_unused:UNUSED_PAD src0_sel:WORD_0 src1_sel:DWORD
    v_max_i32 v18, v18, v17
    v_lshl_add_u32 v33, v18, 1, s14
    v_add_u32 v17, -8, v16
    v_cvt_f32_u32 v18, v17
    v_min_u32 v17, 0x80, v17
    v_cvt_pk_bf16_f32 v18, v18, v18
    v_sub_u32_sdwa v18, v18, v19 dst_sel:DWORD dst_unused:UNUSED_PAD src0_sel:WORD_0 src1_sel:DWORD
    v_max_i32 v18, v18, v17
    v_lshl_add_u32 v34, v18, 1, s14
    v_add_u32 v17, -12, v16
    v_cvt_f32_u32 v18, v17
    v_min_u32 v17, 0x80, v17
    v_cvt_pk_bf16_f32 v18, v18, v18
    v_sub_u32_sdwa v18, v18, v19 dst_sel:DWORD dst_unused:UNUSED_PAD src0_sel:WORD_0 src1_sel:DWORD
    v_max_i32 v18, v18, v17
    v_lshl_add_u32 v35, v18, 1, s14
    v_add_u32 v17, -16, v16
    v_cvt_f32_u32 v18, v17
    v_min_u32 v17, 0x80, v17
    v_cvt_pk_bf16_f32 v18, v18, v18
    v_sub_u32_sdwa v18, v18, v19 dst_sel:DWORD dst_unused:UNUSED_PAD src0_sel:WORD_0 src1_sel:DWORD
    v_max_i32 v18, v18, v17
    v_lshl_add_u32 v36, v18, 1, s14
    v_add_u32 v17, -20, v16
    v_cvt_f32_u32 v18, v17
    v_min_u32 v17, 0x80, v17
    v_cvt_pk_bf16_f32 v18, v18, v18
    v_sub_u32_sdwa v18, v18, v19 dst_sel:DWORD dst_unused:UNUSED_PAD src0_sel:WORD_0 src1_sel:DWORD
    v_max_i32 v18, v18, v17
    v_lshl_add_u32 v37, v18, 1, s14
    v_add_u32 v17, -24, v16
    v_cvt_f32_u32 v18, v17
    v_min_u32 v17, 0x80, v17
    v_cvt_pk_bf16_f32 v18, v18, v18
    v_sub_u32_sdwa v18, v18, v19 dst_sel:DWORD dst_unused:UNUSED_PAD src0_sel:WORD_0 src1_sel:DWORD
    v_max_i32 v18, v18, v17
    v_lshl_add_u32 v38, v18, 1, s14
    v_add_u32 v17, -28, v16
    v_cvt_f32_u32 v18, v17
    v_min_u32 v17, 0x80, v17
    v_cvt_pk_bf16_f32 v18, v18, v18
    v_sub_u32_sdwa v18, v18, v19 dst_sel:DWORD dst_unused:UNUSED_PAD src0_sel:WORD_0 src1_sel:DWORD
    v_max_i32 v18, v18, v17
    v_lshl_add_u32 v39, v18, 1, s14
    v_add_u32 v17, 1, v16
    v_cvt_f32_u32 v18, v17
    v_min_u32 v17, 0x80, v17
    v_cvt_pk_bf16_f32 v18, v18, v18
    v_sub_u32_sdwa v18, v18, v19 dst_sel:DWORD dst_unused:UNUSED_PAD src0_sel:WORD_0 src1_sel:DWORD
    v_max_i32 v18, v18, v17
    v_lshl_add_u32 v40, v18, 1, s14
    v_add_u32 v17, -3, v16
    v_cvt_f32_u32 v18, v17
    v_min_u32 v17, 0x80, v17
    v_cvt_pk_bf16_f32 v18, v18, v18
    v_sub_u32_sdwa v18, v18, v19 dst_sel:DWORD dst_unused:UNUSED_PAD src0_sel:WORD_0 src1_sel:DWORD
    v_max_i32 v18, v18, v17
    v_lshl_add_u32 v41, v18, 1, s14
    v_add_u32 v17, -7, v16
    v_cvt_f32_u32 v18, v17
    v_min_u32 v17, 0x80, v17
    v_cvt_pk_bf16_f32 v18, v18, v18
    v_sub_u32_sdwa v18, v18, v19 dst_sel:DWORD dst_unused:UNUSED_PAD src0_sel:WORD_0 src1_sel:DWORD
    v_max_i32 v18, v18, v17
    v_lshl_add_u32 v42, v18, 1, s14
    v_add_u32 v17, -11, v16
    v_cvt_f32_u32 v18, v17
    v_min_u32 v17, 0x80, v17
    v_cvt_pk_bf16_f32 v18, v18, v18
    v_sub_u32_sdwa v18, v18, v19 dst_sel:DWORD dst_unused:UNUSED_PAD src0_sel:WORD_0 src1_sel:DWORD
    v_max_i32 v18, v18, v17
    v_lshl_add_u32 v43, v18, 1, s14
    v_add_u32 v17, -15, v16
    v_cvt_f32_u32 v18, v17
    v_min_u32 v17, 0x80, v17
    v_cvt_pk_bf16_f32 v18, v18, v18
    v_sub_u32_sdwa v18, v18, v19 dst_sel:DWORD dst_unused:UNUSED_PAD src0_sel:WORD_0 src1_sel:DWORD
    v_max_i32 v18, v18, v17
    v_lshl_add_u32 v44, v18, 1, s14
    v_add_u32 v17, -19, v16
    v_cvt_f32_u32 v18, v17
    v_min_u32 v17, 0x80, v17
    v_cvt_pk_bf16_f32 v18, v18, v18
    v_sub_u32_sdwa v18, v18, v19 dst_sel:DWORD dst_unused:UNUSED_PAD src0_sel:WORD_0 src1_sel:DWORD
    v_max_i32 v18, v18, v17
    v_lshl_add_u32 v45, v18, 1, s14
    v_add_u32 v17, -23, v16
    v_cvt_f32_u32 v18, v17
    v_min_u32 v17, 0x80, v17
    v_cvt_pk_bf16_f32 v18, v18, v18
    v_sub_u32_sdwa v18, v18, v19 dst_sel:DWORD dst_unused:UNUSED_PAD src0_sel:WORD_0 src1_sel:DWORD
    v_max_i32 v18, v18, v17
    v_lshl_add_u32 v46, v18, 1, s14
    v_add_u32 v17, -27, v16
    v_cvt_f32_u32 v18, v17
    v_min_u32 v17, 0x80, v17
    v_cvt_pk_bf16_f32 v18, v18, v18
    v_sub_u32_sdwa v18, v18, v19 dst_sel:DWORD dst_unused:UNUSED_PAD src0_sel:WORD_0 src1_sel:DWORD
    v_max_i32 v18, v18, v17
    v_lshl_add_u32 v47, v18, 1, s14
    v_add_u32 v17, 2, v16
    v_cvt_f32_u32 v18, v17
    v_min_u32 v17, 0x80, v17
    v_cvt_pk_bf16_f32 v18, v18, v18
    v_sub_u32_sdwa v18, v18, v19 dst_sel:DWORD dst_unused:UNUSED_PAD src0_sel:WORD_0 src1_sel:DWORD
    v_max_i32 v18, v18, v17
    v_lshl_add_u32 v48, v18, 1, s14
    v_add_u32 v17, -2, v16
    v_cvt_f32_u32 v18, v17
    v_min_u32 v17, 0x80, v17
    v_cvt_pk_bf16_f32 v18, v18, v18
    v_sub_u32_sdwa v18, v18, v19 dst_sel:DWORD dst_unused:UNUSED_PAD src0_sel:WORD_0 src1_sel:DWORD
    v_max_i32 v18, v18, v17
    v_lshl_add_u32 v49, v18, 1, s14
    v_add_u32 v17, -6, v16
    v_cvt_f32_u32 v18, v17
    v_min_u32 v17, 0x80, v17
    v_cvt_pk_bf16_f32 v18, v18, v18
    v_sub_u32_sdwa v18, v18, v19 dst_sel:DWORD dst_unused:UNUSED_PAD src0_sel:WORD_0 src1_sel:DWORD
    v_max_i32 v18, v18, v17
    v_lshl_add_u32 v50, v18, 1, s14
    v_add_u32 v17, -10, v16
    v_cvt_f32_u32 v18, v17
    v_min_u32 v17, 0x80, v17
    v_cvt_pk_bf16_f32 v18, v18, v18
    v_sub_u32_sdwa v18, v18, v19 dst_sel:DWORD dst_unused:UNUSED_PAD src0_sel:WORD_0 src1_sel:DWORD
    v_max_i32 v18, v18, v17
    v_lshl_add_u32 v51, v18, 1, s14
    v_add_u32 v17, -14, v16
    v_cvt_f32_u32 v18, v17
    v_min_u32 v17, 0x80, v17
    v_cvt_pk_bf16_f32 v18, v18, v18
    v_sub_u32_sdwa v18, v18, v19 dst_sel:DWORD dst_unused:UNUSED_PAD src0_sel:WORD_0 src1_sel:DWORD
    v_max_i32 v18, v18, v17
    v_lshl_add_u32 v52, v18, 1, s14
    v_add_u32 v17, -18, v16
    v_cvt_f32_u32 v18, v17
    v_min_u32 v17, 0x80, v17
    v_cvt_pk_bf16_f32 v18, v18, v18
    v_sub_u32_sdwa v18, v18, v19 dst_sel:DWORD dst_unused:UNUSED_PAD src0_sel:WORD_0 src1_sel:DWORD
    v_max_i32 v18, v18, v17
    v_lshl_add_u32 v53, v18, 1, s14
    v_add_u32 v17, -22, v16
    v_cvt_f32_u32 v18, v17
    v_min_u32 v17, 0x80, v17
    v_cvt_pk_bf16_f32 v18, v18, v18
    v_sub_u32_sdwa v18, v18, v19 dst_sel:DWORD dst_unused:UNUSED_PAD src0_sel:WORD_0 src1_sel:DWORD
    v_max_i32 v18, v18, v17
    v_lshl_add_u32 v54, v18, 1, s14
    v_add_u32 v17, -26, v16
    v_cvt_f32_u32 v18, v17
    v_min_u32 v17, 0x80, v17
    v_cvt_pk_bf16_f32 v18, v18, v18
    v_sub_u32_sdwa v18, v18, v19 dst_sel:DWORD dst_unused:UNUSED_PAD src0_sel:WORD_0 src1_sel:DWORD
    v_max_i32 v18, v18, v17
    v_lshl_add_u32 v55, v18, 1, s14
    v_add_u32 v17, 3, v16
    v_cvt_f32_u32 v18, v17
    v_min_u32 v17, 0x80, v17
    v_cvt_pk_bf16_f32 v18, v18, v18
    v_sub_u32_sdwa v18, v18, v19 dst_sel:DWORD dst_unused:UNUSED_PAD src0_sel:WORD_0 src1_sel:DWORD
    v_max_i32 v18, v18, v17
    v_lshl_add_u32 v56, v18, 1, s14
    v_add_u32 v17, -1, v16
    v_cvt_f32_u32 v18, v17
    v_min_u32 v17, 0x80, v17
    v_cvt_pk_bf16_f32 v18, v18, v18
    v_sub_u32_sdwa v18, v18, v19 dst_sel:DWORD dst_unused:UNUSED_PAD src0_sel:WORD_0 src1_sel:DWORD
    v_max_i32 v18, v18, v17
    v_lshl_add_u32 v57, v18, 1, s14
    v_add_u32 v17, -5, v16
    v_cvt_f32_u32 v18, v17
    v_min_u32 v17, 0x80, v17
    v_cvt_pk_bf16_f32 v18, v18, v18
    v_sub_u32_sdwa v18, v18, v19 dst_sel:DWORD dst_unused:UNUSED_PAD src0_sel:WORD_0 src1_sel:DWORD
    v_max_i32 v18, v18, v17
    v_lshl_add_u32 v58, v18, 1, s14
    v_add_u32 v17, -9, v16
    v_cvt_f32_u32 v18, v17
    v_min_u32 v17, 0x80, v17
    v_cvt_pk_bf16_f32 v18, v18, v18
    v_sub_u32_sdwa v18, v18, v19 dst_sel:DWORD dst_unused:UNUSED_PAD src0_sel:WORD_0 src1_sel:DWORD
    v_max_i32 v18, v18, v17
    v_lshl_add_u32 v59, v18, 1, s14
    v_add_u32 v17, -13, v16
    v_cvt_f32_u32 v18, v17
    v_min_u32 v17, 0x80, v17
    v_cvt_pk_bf16_f32 v18, v18, v18
    v_sub_u32_sdwa v18, v18, v19 dst_sel:DWORD dst_unused:UNUSED_PAD src0_sel:WORD_0 src1_sel:DWORD
    v_max_i32 v18, v18, v17
    v_lshl_add_u32 v60, v18, 1, s14
    v_add_u32 v17, -17, v16
    v_cvt_f32_u32 v18, v17
    v_min_u32 v17, 0x80, v17
    v_cvt_pk_bf16_f32 v18, v18, v18
    v_sub_u32_sdwa v18, v18, v19 dst_sel:DWORD dst_unused:UNUSED_PAD src0_sel:WORD_0 src1_sel:DWORD
    v_max_i32 v18, v18, v17
    v_lshl_add_u32 v61, v18, 1, s14
    v_add_u32 v17, -21, v16
    v_cvt_f32_u32 v18, v17
    v_min_u32 v17, 0x80, v17
    v_cvt_pk_bf16_f32 v18, v18, v18
    v_sub_u32_sdwa v18, v18, v19 dst_sel:DWORD dst_unused:UNUSED_PAD src0_sel:WORD_0 src1_sel:DWORD
    v_max_i32 v18, v18, v17
    v_lshl_add_u32 v62, v18, 1, s14
    v_add_u32 v17, -25, v16
    v_cvt_f32_u32 v18, v17
    v_min_u32 v17, 0x80, v17
    v_cvt_pk_bf16_f32 v18, v18, v18
    v_sub_u32_sdwa v18, v18, v19 dst_sel:DWORD dst_unused:UNUSED_PAD src0_sel:WORD_0 src1_sel:DWORD
    v_max_i32 v18, v18, v17
    v_lshl_add_u32 v63, v18, 1, s14
    v_lshlrev_b32 v16, 2, v0
    v_add_u32 v16, s73, v16
    v_add_u32 v218, 0, v16
    v_add_u32 v219, 1088, v16
    v_add_u32 v220, 2176, v16
    v_add_u32 v221, 3264, v16
    v_add_u32 v222, 4352, v16
    v_add_u32 v223, 5440, v16
    v_add_u32 v224, 6528, v16
    v_add_u32 v225, 7616, v16
    v_and_b32 v17, 31, v0
    v_mul_u32_u24 v17, 272, v17
    v_lshrrev_b32 v18, 5, v0
    v_lshl_add_u32 v17, v18, 4, v17
    v_add_u32 v17, s73, v17
    s_bitcmp1_b32 s9, 0
    s_cselect_b32 s14, 0, 16
    s_lshl_b32 s81, s81, s14
    s_and_b32 s81, s81, s83
    s_lshl_b32 s82, s82, s14
    s_and_b32 s82, s82, s83
    v_mov_b32 v88, 0x3fb8aa3b
    v_mul_f32 v88, s81, v88
    v_exp_f32 v88, v88
    s_nop 0
    v_cvt_pk_bf16_f32 v88, v88, v88
    v_lshlrev_b32 v88, 16, v88
    s_barrier
    s_waitcnt vmcnt(12)
    v_mov_b32 v116, 0
    v_mov_b32 v118, 0
    v_mov_b32 v117, 0x3f803f80
    v_dot2c_f32_bf16 v116, v64, v117
    v_dot2c_f32_bf16 v118, v64, v64
    v_dot2c_f32_bf16 v116, v65, v117
    v_dot2c_f32_bf16 v118, v65, v65
    v_dot2c_f32_bf16 v116, v66, v117
    v_dot2c_f32_bf16 v118, v66, v66
    v_dot2c_f32_bf16 v116, v67, v117
    v_dot2c_f32_bf16 v118, v67, v67
    v_dot2c_f32_bf16 v116, v68, v117
    v_dot2c_f32_bf16 v118, v68, v68
    v_dot2c_f32_bf16 v116, v69, v117
    v_dot2c_f32_bf16 v118, v69, v69
    v_dot2c_f32_bf16 v116, v70, v117
    v_dot2c_f32_bf16 v118, v70, v70
    v_dot2c_f32_bf16 v116, v71, v117
    v_dot2c_f32_bf16 v118, v71, v71
    v_dot2c_f32_bf16 v116, v72, v117
    v_dot2c_f32_bf16 v118, v72, v72
    v_dot2c_f32_bf16 v116, v73, v117
    v_dot2c_f32_bf16 v118, v73, v73
    v_lshlrev_b32 v96, 16, v64
    v_and_b32 v97, s83, v64
    v_lshlrev_b32 v98, 16, v65
    v_add_f32_dpp v116, v116, v116 row_ror:8 row_mask:0xf bank_mask:0xf
    v_add_f32_dpp v118, v118, v118 row_ror:8 row_mask:0xf bank_mask:0xf
    v_and_b32 v99, s83, v65
    v_add_f32_dpp v116, v116, v116 row_ror:4 row_mask:0xf bank_mask:0xf
    v_add_f32_dpp v118, v118, v118 row_ror:4 row_mask:0xf bank_mask:0xf
    v_lshlrev_b32 v100, 16, v66
    v_add_f32_dpp v116, v116, v116 row_ror:2 row_mask:0xf bank_mask:0xf
    v_add_f32_dpp v118, v118, v118 row_ror:2 row_mask:0xf bank_mask:0xf
    v_and_b32 v101, s83, v66
    v_add_f32_dpp v116, v116, v116 row_ror:1 row_mask:0xf bank_mask:0xf
    v_add_f32_dpp v118, v118, v118 row_ror:1 row_mask:0xf bank_mask:0xf
    v_lshlrev_b32 v102, 16, v67
    v_mov_b32 v117, v116
    v_mov_b32 v119, v118
    v_and_b32 v103, s83, v67
    v_lshlrev_b32 v104, 16, v68
    v_permlane16_swap_b32 v116, v117
    v_permlane16_swap_b32 v118, v119
    v_add_f32 v116, v116, v117
    v_add_f32 v118, v118, v119
    v_mul_f32 v116, 0x3acccccd, v116
    v_mul_f32 v118, 0x3acccccd, v118
    v_mul_f32 v119, v116, v116
    v_and_b32 v105, s83, v68
    v_lshlrev_b32 v106, 16, v69
    v_and_b32 v107, s83, v69
    v_lshlrev_b32 v108, 16, v70
    v_and_b32 v109, s83, v70
    v_lshlrev_b32 v110, 16, v71
    v_and_b32 v111, s83, v71
    v_lshlrev_b32 v112, 16, v72
    v_and_b32 v113, s83, v72
    v_lshlrev_b32 v114, 16, v73
    v_and_b32 v115, s83, v73
    v_mul_f32 v117, 0x3f7f0000, v118
    v_sub_f32 v118, v118, v119
    v_cmp_nle_f32 vcc, v119, v117
    s_cbranch_vccz L_lnok_1
    v_pk_add_f32 v[120:121], v[96:97], v[116:117] op_sel_hi:[1,0] neg_lo:[0,1] neg_hi:[0,1]
    v_pk_mul_f32 v[124:125], v[120:121], v[120:121]
    v_pk_add_f32 v[122:123], v[98:99], v[116:117] op_sel_hi:[1,0] neg_lo:[0,1] neg_hi:[0,1]
    v_pk_mul_f32 v[126:127], v[122:123], v[122:123]
    v_pk_add_f32 v[120:121], v[100:101], v[116:117] op_sel_hi:[1,0] neg_lo:[0,1] neg_hi:[0,1]
    v_pk_fma_f32 v[124:125], v[120:121], v[120:121], v[124:125]
    v_pk_add_f32 v[122:123], v[102:103], v[116:117] op_sel_hi:[1,0] neg_lo:[0,1] neg_hi:[0,1]
    v_pk_fma_f32 v[126:127], v[122:123], v[122:123], v[126:127]
    v_pk_add_f32 v[120:121], v[104:105], v[116:117] op_sel_hi:[1,0] neg_lo:[0,1] neg_hi:[0,1]
    v_pk_fma_f32 v[124:125], v[120:121], v[120:121], v[124:125]
    v_pk_add_f32 v[122:123], v[106:107], v[116:117] op_sel_hi:[1,0] neg_lo:[0,1] neg_hi:[0,1]
    v_pk_fma_f32 v[126:127], v[122:123], v[122:123], v[126:127]
    v_pk_add_f32 v[120:121], v[108:109], v[116:117] op_sel_hi:[1,0] neg_lo:[0,1] neg_hi:[0,1]
    v_pk_fma_f32 v[124:125], v[120:121], v[120:121], v[124:125]
    v_pk_add_f32 v[122:123], v[110:111], v[116:117] op_sel_hi:[1,0] neg_lo:[0,1] neg_hi:[0,1]
    v_pk_fma_f32 v[126:127], v[122:123], v[122:123], v[126:127]
    v_pk_add_f32 v[120:121], v[112:113], v[116:117] op_sel_hi:[1,0] neg_lo:[0,1] neg_hi:[0,1]
    v_pk_fma_f32 v[124:125], v[120:121], v[120:121], v[124:125]
    v_pk_add_f32 v[122:123], v[114:115], v[116:117] op_sel_hi:[1,0] neg_lo:[0,1] neg_hi:[0,1]
    v_pk_fma_f32 v[126:127], v[122:123], v[122:123], v[126:127]
    v_pk_add_f32 v[124:125], v[124:125], v[126:127]
    v_add_f32 v118, v124, v125
    s_nop 1
    v_add_f32_dpp v118, v118, v118 row_ror:8 row_mask:0xf bank_mask:0xf
    s_nop 1
    v_add_f32_dpp v118, v118, v118 row_ror:4 row_mask:0xf bank_mask:0xf
    s_nop 1
    v_add_f32_dpp v118, v118, v118 row_ror:2 row_mask:0xf bank_mask:0xf
    s_nop 1
    v_add_f32_dpp v118, v118, v118 row_ror:1 row_mask:0xf bank_mask:0xf
    v_mov_b32 v119, v118
    s_nop 1
    v_permlane16_swap_b32 v118, v119
    v_add_f32 v118, v118, v119
    v_mul_f32 v118, 0x3acccccd, v118
L_lnok_1:
    v_cvt_pk_bf16_f32 v119, v116, v118
    v_lshlrev_b32 v116, 16, v119
    v_and_b32 v118, s83, v119
    v_add_f32 v118, 0x3727c5ac, v118
    v_cvt_pk_bf16_f32 v118, v118, v118
    v_lshlrev_b32 v118, 16, v118
    v_sqrt_f32 v118, v118
    s_nop 0
    v_cvt_pk_bf16_f32 v118, v118, v118
    v_lshlrev_b32 v118, 16, v118
    v_rcp_f32 v118, v118
    s_nop 0
    v_mul_f32 v119, v116, v118
    v_pk_fma_f32 v[120:121], v[96:97], v[118:119], v[118:119] op_sel:[0,0,1] op_sel_hi:[1,0,1] neg_lo:[0,0,1] neg_hi:[0,0,1]
    v_cvt_pk_bf16_f32 v64, v120, v121
    v_pk_fma_f32 v[122:123], v[98:99], v[118:119], v[118:119] op_sel:[0,0,1] op_sel_hi:[1,0,1] neg_lo:[0,0,1] neg_hi:[0,0,1]
    v_cvt_pk_bf16_f32 v65, v122, v123
    ds_write_b64 v27, v[64:65] offset:0
    v_pk_fma_f32 v[124:125], v[100:101], v[118:119], v[118:119] op_sel:[0,0,1] op_sel_hi:[1,0,1] neg_lo:[0,0,1] neg_hi:[0,0,1]
    v_cvt_pk_bf16_f32 v66, v124, v125
    v_pk_fma_f32 v[126:127], v[102:103], v[118:119], v[118:119] op_sel:[0,0,1] op_sel_hi:[1,0,1] neg_lo:[0,0,1] neg_hi:[0,0,1]
    v_cvt_pk_bf16_f32 v67, v126, v127
    ds_write_b64 v27, v[66:67] offset:256
    v_pk_fma_f32 v[120:121], v[104:105], v[118:119], v[118:119] op_sel:[0,0,1] op_sel_hi:[1,0,1] neg_lo:[0,0,1] neg_hi:[0,0,1]
    v_cvt_pk_bf16_f32 v68, v120, v121
    v_pk_fma_f32 v[122:123], v[106:107], v[118:119], v[118:119] op_sel:[0,0,1] op_sel_hi:[1,0,1] neg_lo:[0,0,1] neg_hi:[0,0,1]
    v_cvt_pk_bf16_f32 v69, v122, v123
    ds_write_b64 v27, v[68:69] offset:512
    v_pk_fma_f32 v[124:125], v[108:109], v[118:119], v[118:119] op_sel:[0,0,1] op_sel_hi:[1,0,1] neg_lo:[0,0,1] neg_hi:[0,0,1]
    v_cvt_pk_bf16_f32 v70, v124, v125
    v_pk_fma_f32 v[126:127], v[110:111], v[118:119], v[118:119] op_sel:[0,0,1] op_sel_hi:[1,0,1] neg_lo:[0,0,1] neg_hi:[0,0,1]
    v_cvt_pk_bf16_f32 v71, v126, v127
    ds_write_b64 v27, v[70:71] offset:768
    v_pk_fma_f32 v[120:121], v[112:113], v[118:119], v[118:119] op_sel:[0,0,1] op_sel_hi:[1,0,1] neg_lo:[0,0,1] neg_hi:[0,0,1]
    v_cvt_pk_bf16_f32 v72, v120, v121
    v_pk_fma_f32 v[122:123], v[114:115], v[118:119], v[118:119] op_sel:[0,0,1] op_sel_hi:[1,0,1] neg_lo:[0,0,1] neg_hi:[0,0,1]
    v_cvt_pk_bf16_f32 v73, v122, v123
    ds_write_b64 v27, v[72:73] offset:1024
    s_waitcnt lgkmcnt(0)
    v_mov_b32 v20, 157296
    v_mov_b32 v21, 1
    s_mov_b64 exec, 1
    ds_add_u32 v20, v21
    s_mov_b64 exec, -1
    s_cmp_eq_u32 s10, 0
    s_cbranch_scc1 L_idle1
    s_waitcnt vmcnt(0)
    v_lshlrev_b32 v76, 16, v84
    v_lshlrev_b32 v77, 16, v85
    v_lshlrev_b32 v78, 16, v86
    v_lshlrev_b32 v79, 16, v87
    v_mul_f32 v76, 0x3fb8aa3b, v76
    v_exp_f32 v76, v76
    v_mul_f32 v77, v77, v88
    v_mul_f32 v74, v78, v88
    v_mul_f32 v75, v79, v88
    v_cvt_pk_bf16_f32 v76, v76, v76
    v_lshlrev_b32 v76, 16, v76
    v_mul_f32 v76, v76, v88
    v_mul_f32 v76, 0xbfb8aa3b, v76
    v_mul_f32 v77, 0.15915494, v77
    v_add_f32 v74, v74, v74
    v_mul_f32 v75, -2.0, v75
    v_mul_f32 v78, 0x3f800000, v76
    v_mul_f32 v79, 0x3f800000, v77
    v_exp_f32 v78, v78
    v_fract_f32 v79, v79
    v_cos_f32 v64, v79
    v_sin_f32 v65, v79
    v_mul_f32 v64, v64, v78
    v_mul_f32 v65, v65, v78
    v_mul_f32 v78, 0x41000000, v76
    v_mul_f32 v79, 0x41000000, v77
    v_exp_f32 v78, v78
    v_fract_f32 v79, v79
    v_cos_f32 v66, v79
    v_sin_f32 v67, v79
    v_mul_f32 v66, v66, v78
    v_mul_f32 v67, v67, v78
    v_mul_f32 v78, 0x43800000, v76
    v_mul_f32 v79, 0x43800000, v77
    v_exp_f32 v78, v78
    v_fract_f32 v79, v79
    v_cos_f32 v68, v79
    v_sin_f32 v69, v79
    v_mul_f32 v68, v68, v78
    v_mul_f32 v69, v69, v78
    v_pk_mul_f32 v[78:79], v[64:65], v[64:65] op_sel_hi:[1,0]
    v_pk_fma_f32 v[70:71], v[64:65], v[64:65], v[78:79] op_sel:[1,1,0] op_sel_hi:[0,1,1] neg_lo:[1,0,0]
    v_pk_mul_f32 v[78:79], v[70:71], v[70:71] op_sel_hi:[1,0]
    v_pk_fma_f32 v[72:73], v[70:71], v[70:71], v[78:79] op_sel:[1,1,0] op_sel_hi:[0,1,1] neg_lo:[1,0,0]
    v_cvt_pk_bf16_f32 v227, v74, v75
    v_pk_mul_f32 v[78:79], v[74:75], v[64:65] op_sel_hi:[1,0]
    v_pk_fma_f32 v[76:77], v[74:75], v[64:65], v[78:79] op_sel:[1,1,0] op_sel_hi:[0,1,1] neg_hi:[1,0,0]
    v_pk_mul_f32 v[82:83], v[74:75], v[68:69] op_sel_hi:[1,0]
    v_pk_fma_f32 v[80:81], v[74:75], v[68:69], v[82:83] op_sel:[1,1,0] op_sel_hi:[0,1,1] neg_hi:[1,0,0]
    v_cvt_pk_bf16_f32 v229, v76, v77
    ds_write2_b32 v218, v227, v229 offset0:0 offset1:68
    v_cvt_pk_bf16_f32 v229, v80, v81
    v_pk_mul_f32 v[82:83], v[80:81], v[70:71] op_sel_hi:[1,0]
    v_pk_fma_f32 v[92:93], v[80:81], v[70:71], v[82:83] op_sel:[1,1,0] op_sel_hi:[0,1,1] neg_hi:[1,0,0]
    v_pk_mul_f32 v[78:79], v[76:77], v[64:65] op_sel_hi:[1,0]
    v_pk_fma_f32 v[76:77], v[76:77], v[64:65], v[78:79] op_sel:[1,1,0] op_sel_hi:[0,1,1] neg_hi:[1,0,0]
    v_cvt_pk_bf16_f32 v231, v92, v93
    ds_write2_b32 v220, v229, v231 offset0:0 offset1:68
    v_cvt_pk_bf16_f32 v231, v76, v77
    v_pk_mul_f32 v[82:83], v[92:93], v[70:71] op_sel_hi:[1,0]
    v_pk_fma_f32 v[92:93], v[92:93], v[70:71], v[82:83] op_sel:[1,1,0] op_sel_hi:[0,1,1] neg_hi:[1,0,0]
    v_pk_mul_f32 v[78:79], v[76:77], v[64:65] op_sel_hi:[1,0]
    v_pk_fma_f32 v[76:77], v[76:77], v[64:65], v[78:79] op_sel:[1,1,0] op_sel_hi:[0,1,1] neg_hi:[1,0,0]
    v_cvt_pk_bf16_f32 v227, v92, v93
    v_cvt_pk_bf16_f32 v229, v76, v77
    ds_write2_b32 v218, v231, v229 offset0:136 offset1:204
    v_pk_mul_f32 v[82:83], v[92:93], v[70:71] op_sel_hi:[1,0]
    v_pk_fma_f32 v[92:93], v[92:93], v[70:71], v[82:83] op_sel:[1,1,0] op_sel_hi:[0,1,1] neg_hi:[1,0,0]
    v_pk_mul_f32 v[78:79], v[80:81], v[68:69] op_sel_hi:[1,0]
    v_pk_fma_f32 v[80:81], v[80:81], v[68:69], v[78:79] op_sel:[1,1,0] op_sel_hi:[0,1,1] neg_hi:[1,0,0]
    v_cvt_pk_bf16_f32 v230, v92, v93
    ds_write2_b32 v220, v227, v230 offset0:136 offset1:204
    v_cvt_pk_bf16_f32 v230, v80, v81
    v_pk_mul_f32 v[82:83], v[80:81], v[72:73] op_sel_hi:[1,0]
    v_pk_fma_f32 v[92:93], v[80:81], v[72:73], v[82:83] op_sel:[1,1,0] op_sel_hi:[0,1,1] neg_hi:[1,0,0]
    v_pk_mul_f32 v[78:79], v[76:77], v[64:65] op_sel_hi:[1,0]
    v_pk_fma_f32 v[76:77], v[76:77], v[64:65], v[78:79] op_sel:[1,1,0] op_sel_hi:[0,1,1] neg_hi:[1,0,0]
    v_cvt_pk_bf16_f32 v226, v92, v93
    ds_write2_b32 v221, v230, v226 offset0:0 offset1:68
    v_cvt_pk_bf16_f32 v227, v76, v77
    v_pk_mul_f32 v[82:83], v[80:81], v[68:69] op_sel_hi:[1,0]
    v_pk_fma_f32 v[80:81], v[80:81], v[68:69], v[82:83] op_sel:[1,1,0] op_sel_hi:[0,1,1] neg_hi:[1,0,0]
    v_pk_mul_f32 v[78:79], v[76:77], v[64:65] op_sel_hi:[1,0]
    v_pk_fma_f32 v[76:77], v[76:77], v[64:65], v[78:79] op_sel:[1,1,0] op_sel_hi:[0,1,1] neg_hi:[1,0,0]
    v_cvt_pk_bf16_f32 v229, v80, v81
    v_cvt_pk_bf16_f32 v231, v76, v77
    ds_write2_b32 v219, v227, v231 offset0:0 offset1:68
    v_pk_mul_f32 v[82:83], v[80:81], v[72:73] op_sel_hi:[1,0]
    v_pk_fma_f32 v[92:93], v[80:81], v[72:73], v[82:83] op_sel:[1,1,0] op_sel_hi:[0,1,1] neg_hi:[1,0,0]
    v_pk_mul_f32 v[78:79], v[80:81], v[68:69] op_sel_hi:[1,0]
    v_pk_fma_f32 v[80:81], v[80:81], v[68:69], v[78:79] op_sel:[1,1,0] op_sel_hi:[0,1,1] neg_hi:[1,0,0]
    v_cvt_pk_bf16_f32 v231, v92, v93
    ds_write2_b32 v221, v229, v231 offset0:136 offset1:204
    v_cvt_pk_bf16_f32 v231, v80, v81
    v_pk_mul_f32 v[78:79], v[76:77], v[64:65] op_sel_hi:[1,0]
    v_pk_fma_f32 v[76:77], v[76:77], v[64:65], v[78:79] op_sel:[1,1,0] op_sel_hi:[0,1,1] neg_hi:[1,0,0]
    v_pk_mul_f32 v[82:83], v[80:81], v[68:69] op_sel_hi:[1,0]
    v_pk_fma_f32 v[80:81], v[80:81], v[68:69], v[82:83] op_sel:[1,1,0] op_sel_hi:[0,1,1] neg_hi:[1,0,0]
    v_cvt_pk_bf16_f32 v227, v76, v77
    v_cvt_pk_bf16_f32 v229, v80, v81
    ds_write2_b32 v222, v231, v229 offset0:0 offset1:68
    v_pk_mul_f32 v[78:79], v[76:77], v[64:65] op_sel_hi:[1,0]
    v_pk_fma_f32 v[76:77], v[76:77], v[64:65], v[78:79] op_sel:[1,1,0] op_sel_hi:[0,1,1] neg_hi:[1,0,0]
    v_pk_mul_f32 v[82:83], v[80:81], v[68:69] op_sel_hi:[1,0]
    v_pk_fma_f32 v[80:81], v[80:81], v[68:69], v[82:83] op_sel:[1,1,0] op_sel_hi:[0,1,1] neg_hi:[1,0,0]
    v_cvt_pk_bf16_f32 v230, v76, v77
    ds_write2_b32 v219, v227, v230 offset0:136 offset1:204
    v_cvt_pk_bf16_f32 v230, v80, v81
    v_pk_mul_f32 v[82:83], v[80:81], v[68:69] op_sel_hi:[1,0]
    v_pk_fma_f32 v[80:81], v[80:81], v[68:69], v[82:83] op_sel:[1,1,0] op_sel_hi:[0,1,1] neg_hi:[1,0,0]
    v_cvt_pk_bf16_f32 v226, v80, v81
    ds_write2_b32 v222, v230, v226 offset0:136 offset1:204
    v_pk_mul_f32 v[82:83], v[80:81], v[68:69] op_sel_hi:[1,0]
    v_pk_fma_f32 v[80:81], v[80:81], v[68:69], v[82:83] op_sel:[1,1,0] op_sel_hi:[0,1,1] neg_hi:[1,0,0]
    v_cvt_pk_bf16_f32 v227, v80, v81
    ds_write_b32 v223, v227
    ds_read_b128 v[144:147], v17 offset:0
    ds_read_b128 v[148:151], v17 offset:32
    ds_read_b128 v[152:155], v17 offset:64
    ds_read_b128 v[156:159], v17 offset:96
    ds_read_b128 v[160:163], v17 offset:128
    ds_read_b128 v[164:167], v17 offset:160
    ds_read_b128 v[168:171], v17 offset:192
    ds_read_b128 v[172:175], v17 offset:224
    v_pk_mul_f32 v[78:79], v[66:67], v[66:67] op_sel_hi:[1,0]
    v_pk_fma_f32 v[70:71], v[66:67], v[66:67], v[78:79] op_sel:[1,1,0] op_sel_hi:[0,1,1] neg_lo:[1,0,0]
    v_mov_b32 v228, 0x3f80
    v_cvt_pk_bf16_f32 v230, v66, v67
    ds_write2_b32 v218, v228, v230 offset0:0 offset1:68
    v_cvt_pk_bf16_f32 v230, v70, v71
    v_pk_mul_f32 v[82:83], v[66:67], v[70:71] op_sel_hi:[1,0]
    v_pk_fma_f32 v[80:81], v[66:67], v[70:71], v[82:83] op_sel:[1,1,0] op_sel_hi:[0,1,1] neg_lo:[1,0,0]
    v_pk_mul_f32 v[78:79], v[70:71], v[70:71] op_sel_hi:[1,0]
    v_pk_fma_f32 v[76:77], v[70:71], v[70:71], v[78:79] op_sel:[1,1,0] op_sel_hi:[0,1,1] neg_lo:[1,0,0]
    v_cvt_pk_bf16_f32 v226, v80, v81
    ds_write2_b32 v218, v230, v226 offset0:136 offset1:204
    v_cvt_pk_bf16_f32 v227, v76, v77
    v_pk_mul_f32 v[82:83], v[80:81], v[70:71] op_sel_hi:[1,0]
    v_pk_fma_f32 v[80:81], v[80:81], v[70:71], v[82:83] op_sel:[1,1,0] op_sel_hi:[0,1,1] neg_lo:[1,0,0]
    v_pk_mul_f32 v[78:79], v[76:77], v[70:71] op_sel_hi:[1,0]
    v_pk_fma_f32 v[76:77], v[76:77], v[70:71], v[78:79] op_sel:[1,1,0] op_sel_hi:[0,1,1] neg_lo:[1,0,0]
    v_cvt_pk_bf16_f32 v229, v80, v81
    ds_write2_b32 v219, v227, v229 offset0:0 offset1:68
    v_cvt_pk_bf16_f32 v229, v76, v77
    v_pk_mul_f32 v[82:83], v[80:81], v[70:71] op_sel_hi:[1,0]
    v_pk_fma_f32 v[80:81], v[80:81], v[70:71], v[82:83] op_sel:[1,1,0] op_sel_hi:[0,1,1] neg_lo:[1,0,0]
    v_pk_mul_f32 v[78:79], v[76:77], v[70:71] op_sel_hi:[1,0]
    v_pk_fma_f32 v[76:77], v[76:77], v[70:71], v[78:79] op_sel:[1,1,0] op_sel_hi:[0,1,1] neg_lo:[1,0,0]
    v_cvt_pk_bf16_f32 v231, v80, v81
    ds_write2_b32 v219, v229, v231 offset0:136 offset1:204
    v_cvt_pk_bf16_f32 v231, v76, v77
    v_pk_mul_f32 v[82:83], v[80:81], v[70:71] op_sel_hi:[1,0]
    v_pk_fma_f32 v[80:81], v[80:81], v[70:71], v[82:83] op_sel:[1,1,0] op_sel_hi:[0,1,1] neg_lo:[1,0,0]
    v_pk_mul_f32 v[78:79], v[76:77], v[70:71] op_sel_hi:[1,0]
    v_pk_fma_f32 v[76:77], v[76:77], v[70:71], v[78:79] op_sel:[1,1,0] op_sel_hi:[0,1,1] neg_lo:[1,0,0]
    v_cvt_pk_bf16_f32 v227, v80, v81
    ds_write2_b32 v220, v231, v227 offset0:0 offset1:68
    v_cvt_pk_bf16_f32 v228, v76, v77
    v_pk_mul_f32 v[82:83], v[80:81], v[70:71] op_sel_hi:[1,0]
    v_pk_fma_f32 v[80:81], v[80:81], v[70:71], v[82:83] op_sel:[1,1,0] op_sel_hi:[0,1,1] neg_lo:[1,0,0]
    v_pk_mul_f32 v[78:79], v[76:77], v[70:71] op_sel_hi:[1,0]
    v_pk_fma_f32 v[76:77], v[76:77], v[70:71], v[78:79] op_sel:[1,1,0] op_sel_hi:[0,1,1] neg_lo:[1,0,0]
    v_cvt_pk_bf16_f32 v230, v80, v81
    ds_write2_b32 v220, v228, v230 offset0:136 offset1:204
    v_cvt_pk_bf16_f32 v230, v76, v77
    v_pk_mul_f32 v[82:83], v[80:81], v[70:71] op_sel_hi:[1,0]
    v_pk_fma_f32 v[80:81], v[80:81], v[70:71], v[82:83] op_sel:[1,1,0] op_sel_hi:[0,1,1] neg_lo:[1,0,0]
    v_pk_mul_f32 v[78:79], v[76:77], v[70:71] op_sel_hi:[1,0]
    v_pk_fma_f32 v[76:77], v[76:77], v[70:71], v[78:79] op_sel:[1,1,0] op_sel_hi:[0,1,1] neg_lo:[1,0,0]
    v_cvt_pk_bf16_f32 v226, v80, v81
    ds_write2_b32 v221, v230, v226 offset0:0 offset1:68
    v_cvt_pk_bf16_f32 v227, v76, v77
    v_pk_mul_f32 v[82:83], v[80:81], v[70:71] op_sel_hi:[1,0]
    v_pk_fma_f32 v[80:81], v[80:81], v[70:71], v[82:83] op_sel:[1,1,0] op_sel_hi:[0,1,1] neg_lo:[1,0,0]
    v_pk_mul_f32 v[78:79], v[76:77], v[70:71] op_sel_hi:[1,0]
    v_pk_fma_f32 v[76:77], v[76:77], v[70:71], v[78:79] op_sel:[1,1,0] op_sel_hi:[0,1,1] neg_lo:[1,0,0]
    v_cvt_pk_bf16_f32 v229, v80, v81
    ds_write2_b32 v221, v227, v229 offset0:136 offset1:204
    v_cvt_pk_bf16_f32 v229, v76, v77
    v_pk_mul_f32 v[82:83], v[80:81], v[70:71] op_sel_hi:[1,0]
    v_pk_fma_f32 v[80:81], v[80:81], v[70:71], v[82:83] op_sel:[1,1,0] op_sel_hi:[0,1,1] neg_lo:[1,0,0]
    v_pk_mul_f32 v[78:79], v[76:77], v[70:71] op_sel_hi:[1,0]
    v_pk_fma_f32 v[76:77], v[76:77], v[70:71], v[78:79] op_sel:[1,1,0] op_sel_hi:[0,1,1] neg_lo:[1,0,0]
    v_cvt_pk_bf16_f32 v231, v80, v81
    ds_write2_b32 v222, v229, v231 offset0:0 offset1:68
    v_cvt_pk_bf16_f32 v231, v76, v77
    v_pk_mul_f32 v[82:83], v[80:81], v[70:71] op_sel_hi:[1,0]
    v_pk_fma_f32 v[80:81], v[80:81], v[70:71], v[82:83] op_sel:[1,1,0] op_sel_hi:[0,1,1] neg_lo:[1,0,0]
    v_pk_mul_f32 v[78:79], v[76:77], v[70:71] op_sel_hi:[1,0]
    v_pk_fma_f32 v[76:77], v[76:77], v[70:71], v[78:79] op_sel:[1,1,0] op_sel_hi:[0,1,1] neg_lo:[1,0,0]
    v_cvt_pk_bf16_f32 v227, v80, v81
    ds_write2_b32 v222, v231, v227 offset0:136 offset1:204
    v_cvt_pk_bf16_f32 v228, v76, v77
    v_pk_mul_f32 v[82:83], v[80:81], v[70:71] op_sel_hi:[1,0]
    v_pk_fma_f32 v[80:81], v[80:81], v[70:71], v[82:83] op_sel:[1,1,0] op_sel_hi:[0,1,1] neg_lo:[1,0,0]
    v_pk_mul_f32 v[78:79], v[76:77], v[70:71] op_sel_hi:[1,0]
    v_pk_fma_f32 v[76:77], v[76:77], v[70:71], v[78:79] op_sel:[1,1,0] op_sel_hi:[0,1,1] neg_lo:[1,0,0]
    v_cvt_pk_bf16_f32 v230, v80, v81
    ds_write2_b32 v223, v228, v230 offset0:0 offset1:68
    v_cvt_pk_bf16_f32 v230, v76, v77
    v_pk_mul_f32 v[82:83], v[80:81], v[70:71] op_sel_hi:[1,0]
    v_pk_fma_f32 v[80:81], v[80:81], v[70:71], v[82:83] op_sel:[1,1,0] op_sel_hi:[0,1,1] neg_lo:[1,0,0]
    v_pk_mul_f32 v[78:79], v[76:77], v[70:71] op_sel_hi:[1,0]
    v_pk_fma_f32 v[76:77], v[76:77], v[70:71], v[78:79] op_sel:[1,1,0] op_sel_hi:[0,1,1] neg_lo:[1,0,0]
    v_cvt_pk_bf16_f32 v226, v80, v81
    ds_write2_b32 v223, v230, v226 offset0:136 offset1:204
    v_cvt_pk_bf16_f32 v227, v76, v77
    v_pk_mul_f32 v[82:83], v[80:81], v[70:71] op_sel_hi:[1,0]
    v_pk_fma_f32 v[80:81], v[80:81], v[70:71], v[82:83] op_sel:[1,1,0] op_sel_hi:[0,1,1] neg_lo:[1,0,0]
    v_pk_mul_f32 v[78:79], v[76:77], v[70:71] op_sel_hi:[1,0]
    v_pk_fma_f32 v[76:77], v[76:77], v[70:71], v[78:79] op_sel:[1,1,0] op_sel_hi:[0,1,1] neg_lo:[1,0,0]
    v_cvt_pk_bf16_f32 v229, v80, v81
    ds_write2_b32 v224, v227, v229 offset0:0 offset1:68
    v_cvt_pk_bf16_f32 v229, v76, v77
    v_pk_mul_f32 v[82:83], v[80:81], v[70:71] op_sel_hi:[1,0]
    v_pk_fma_f32 v[80:81], v[80:81], v[70:71], v[82:83] op_sel:[1,1,0] op_sel_hi:[0,1,1] neg_lo:[1,0,0]
    v_pk_mul_f32 v[78:79], v[76:77], v[70:71] op_sel_hi:[1,0]
    v_pk_fma_f32 v[76:77], v[76:77], v[70:71], v[78:79] op_sel:[1,1,0] op_sel_hi:[0,1,1] neg_lo:[1,0,0]
    v_cvt_pk_bf16_f32 v231, v80, v81
    ds_write2_b32 v224, v229, v231 offset0:136 offset1:204
    v_cvt_pk_bf16_f32 v231, v76, v77
    v_pk_mul_f32 v[82:83], v[80:81], v[70:71] op_sel_hi:[1,0]
    v_pk_fma_f32 v[80:81], v[80:81], v[70:71], v[82:83] op_sel:[1,1,0] op_sel_hi:[0,1,1] neg_lo:[1,0,0]
    v_pk_mul_f32 v[78:79], v[76:77], v[70:71] op_sel_hi:[1,0]
    v_pk_fma_f32 v[76:77], v[76:77], v[70:71], v[78:79] op_sel:[1,1,0] op_sel_hi:[0,1,1] neg_lo:[1,0,0]
    v_cvt_pk_bf16_f32 v227, v80, v81
    ds_write2_b32 v225, v231, v227 offset0:0 offset1:68
    v_cvt_pk_bf16_f32 v228, v76, v77
    v_pk_mul_f32 v[82:83], v[80:81], v[70:71] op_sel_hi:[1,0]
    v_pk_fma_f32 v[80:81], v[80:81], v[70:71], v[82:83] op_sel:[1,1,0] op_sel_hi:[0,1,1] neg_lo:[1,0,0]
    v_cvt_pk_bf16_f32 v230, v80, v81
    ds_write2_b32 v225, v228, v230 offset0:136 offset1:204
    ds_read_b128 v[176:179], v17 offset:0
    ds_read_b128 v[180:183], v17 offset:32
    ds_read_b128 v[184:187], v17 offset:64
    ds_read_b128 v[188:191], v17 offset:96
    ds_read_b128 v[192:195], v17 offset:128
    ds_read_b128 v[196:199], v17 offset:160
    ds_read_b128 v[200:203], v17 offset:192
    ds_read_b128 v[204:207], v17 offset:224
    v_and_b32 v76, s83, v84
    v_and_b32 v77, s83, v85
    v_and_b32 v78, s83, v86
    v_and_b32 v79, s83, v87
    v_mul_f32 v76, 0x3fb8aa3b, v76
    v_exp_f32 v76, v76
    v_mul_f32 v77, v77, v88
    v_mul_f32 v74, v78, v88
    v_mul_f32 v75, v79, v88
    v_cvt_pk_bf16_f32 v76, v76, v76
    v_lshlrev_b32 v76, 16, v76
    v_mul_f32 v76, v76, v88
    v_mul_f32 v76, 0xbfb8aa3b, v76
    v_mul_f32 v77, 0.15915494, v77
    v_add_f32 v74, v74, v74
    v_mul_f32 v75, -2.0, v75
    v_mul_f32 v78, 0x3f800000, v76
    v_mul_f32 v79, 0x3f800000, v77
    v_exp_f32 v78, v78
    v_fract_f32 v79, v79
    v_cos_f32 v64, v79
    v_sin_f32 v65, v79
    v_mul_f32 v64, v64, v78
    v_mul_f32 v65, v65, v78
    v_mul_f32 v78, 0x41000000, v76
    v_mul_f32 v79, 0x41000000, v77
    v_exp_f32 v78, v78
    v_fract_f32 v79, v79
    v_cos_f32 v66, v79
    v_sin_f32 v67, v79
    v_mul_f32 v66, v66, v78
    v_mul_f32 v67, v67, v78
    v_mul_f32 v78, 0x43800000, v76
    v_mul_f32 v79, 0x43800000, v77
    v_exp_f32 v78, v78
    v_fract_f32 v79, v79
    v_cos_f32 v68, v79
    v_sin_f32 v69, v79
    v_mul_f32 v68, v68, v78
    v_mul_f32 v69, v69, v78
    v_pk_mul_f32 v[78:79], v[64:65], v[64:65] op_sel_hi:[1,0]
    v_pk_fma_f32 v[70:71], v[64:65], v[64:65], v[78:79] op_sel:[1,1,0] op_sel_hi:[0,1,1] neg_lo:[1,0,0]
    v_pk_mul_f32 v[78:79], v[70:71], v[70:71] op_sel_hi:[1,0]
    v_pk_fma_f32 v[72:73], v[70:71], v[70:71], v[78:79] op_sel:[1,1,0] op_sel_hi:[0,1,1] neg_lo:[1,0,0]
    v_cvt_pk_bf16_f32 v230, v74, v75
    v_pk_mul_f32 v[78:79], v[74:75], v[64:65] op_sel_hi:[1,0]
    v_pk_fma_f32 v[76:77], v[74:75], v[64:65], v[78:79] op_sel:[1,1,0] op_sel_hi:[0,1,1] neg_hi:[1,0,0]
    v_pk_mul_f32 v[82:83], v[74:75], v[68:69] op_sel_hi:[1,0]
    v_pk_fma_f32 v[80:81], v[74:75], v[68:69], v[82:83] op_sel:[1,1,0] op_sel_hi:[0,1,1] neg_hi:[1,0,0]
    v_cvt_pk_bf16_f32 v226, v76, v77
    ds_write2_b32 v218, v230, v226 offset0:0 offset1:68
    v_cvt_pk_bf16_f32 v227, v80, v81
    v_pk_mul_f32 v[82:83], v[80:81], v[70:71] op_sel_hi:[1,0]
    s_waitcnt lgkmcnt(8)
    v_mfma_f32_32x32x16_bf16 v[128:143], v[144:147], v[176:179], 0
    v_pk_fma_f32 v[92:93], v[80:81], v[70:71], v[82:83] op_sel:[1,1,0] op_sel_hi:[0,1,1] neg_hi:[1,0,0]
    v_pk_mul_f32 v[78:79], v[76:77], v[64:65] op_sel_hi:[1,0]
    v_pk_fma_f32 v[76:77], v[76:77], v[64:65], v[78:79] op_sel:[1,1,0] op_sel_hi:[0,1,1] neg_hi:[1,0,0]
    v_cvt_pk_bf16_f32 v229, v92, v93
    ds_write2_b32 v220, v227, v229 offset0:0 offset1:68
    v_cvt_pk_bf16_f32 v229, v76, v77
    v_pk_mul_f32 v[82:83], v[92:93], v[70:71] op_sel_hi:[1,0]
    v_pk_fma_f32 v[92:93], v[92:93], v[70:71], v[82:83] op_sel:[1,1,0] op_sel_hi:[0,1,1] neg_hi:[1,0,0]
    v_pk_mul_f32 v[78:79], v[76:77], v[64:65] op_sel_hi:[1,0]
    s_waitcnt lgkmcnt(8)
    v_mfma_f32_32x32x16_bf16 v[128:143], v[148:151], v[180:183], v[128:143]
    v_pk_fma_f32 v[76:77], v[76:77], v[64:65], v[78:79] op_sel:[1,1,0] op_sel_hi:[0,1,1] neg_hi:[1,0,0]
    v_cvt_pk_bf16_f32 v231, v92, v93
    v_cvt_pk_bf16_f32 v227, v76, v77
    ds_write2_b32 v218, v229, v227 offset0:136 offset1:204
    v_pk_mul_f32 v[82:83], v[92:93], v[70:71] op_sel_hi:[1,0]
    v_pk_fma_f32 v[92:93], v[92:93], v[70:71], v[82:83] op_sel:[1,1,0] op_sel_hi:[0,1,1] neg_hi:[1,0,0]
    v_pk_mul_f32 v[78:79], v[80:81], v[68:69] op_sel_hi:[1,0]
    v_pk_fma_f32 v[80:81], v[80:81], v[68:69], v[78:79] op_sel:[1,1,0] op_sel_hi:[0,1,1] neg_hi:[1,0,0]
    v_cvt_pk_bf16_f32 v228, v92, v93
    s_waitcnt lgkmcnt(8)
    v_mfma_f32_32x32x16_bf16 v[128:143], v[152:155], v[184:187], v[128:143]
    ds_write2_b32 v220, v231, v228 offset0:136 offset1:204
    v_cvt_pk_bf16_f32 v229, v80, v81
    v_pk_mul_f32 v[82:83], v[80:81], v[72:73] op_sel_hi:[1,0]
    v_pk_fma_f32 v[92:93], v[80:81], v[72:73], v[82:83] op_sel:[1,1,0] op_sel_hi:[0,1,1] neg_hi:[1,0,0]
    v_pk_mul_f32 v[78:79], v[76:77], v[64:65] op_sel_hi:[1,0]
    v_pk_fma_f32 v[76:77], v[76:77], v[64:65], v[78:79] op_sel:[1,1,0] op_sel_hi:[0,1,1] neg_hi:[1,0,0]
    v_cvt_pk_bf16_f32 v231, v92, v93
    ds_write2_b32 v221, v229, v231 offset0:0 offset1:68
    v_cvt_pk_bf16_f32 v231, v76, v77
    s_waitcnt lgkmcnt(9)
    v_mfma_f32_32x32x16_bf16 v[128:143], v[156:159], v[188:191], v[128:143]
    v_pk_mul_f32 v[82:83], v[80:81], v[68:69] op_sel_hi:[1,0]
    v_pk_fma_f32 v[80:81], v[80:81], v[68:69], v[82:83] op_sel:[1,1,0] op_sel_hi:[0,1,1] neg_hi:[1,0,0]
    v_pk_mul_f32 v[78:79], v[76:77], v[64:65] op_sel_hi:[1,0]
    v_pk_fma_f32 v[76:77], v[76:77], v[64:65], v[78:79] op_sel:[1,1,0] op_sel_hi:[0,1,1] neg_hi:[1,0,0]
    v_cvt_pk_bf16_f32 v227, v80, v81
    v_cvt_pk_bf16_f32 v229, v76, v77
    ds_write2_b32 v219, v231, v229 offset0:0 offset1:68
    v_pk_mul_f32 v[82:83], v[80:81], v[72:73] op_sel_hi:[1,0]
    v_pk_fma_f32 v[92:93], v[80:81], v[72:73], v[82:83] op_sel:[1,1,0] op_sel_hi:[0,1,1] neg_hi:[1,0,0]
    s_waitcnt lgkmcnt(9)
    v_mfma_f32_32x32x16_bf16 v[128:143], v[160:163], v[192:195], v[128:143]
    v_pk_mul_f32 v[78:79], v[80:81], v[68:69] op_sel_hi:[1,0]
    v_pk_fma_f32 v[80:81], v[80:81], v[68:69], v[78:79] op_sel:[1,1,0] op_sel_hi:[0,1,1] neg_hi:[1,0,0]
    v_cvt_pk_bf16_f32 v230, v92, v93
    ds_write2_b32 v221, v227, v230 offset0:136 offset1:204
    v_cvt_pk_bf16_f32 v230, v80, v81
    v_pk_mul_f32 v[78:79], v[76:77], v[64:65] op_sel_hi:[1,0]
    v_pk_fma_f32 v[76:77], v[76:77], v[64:65], v[78:79] op_sel:[1,1,0] op_sel_hi:[0,1,1] neg_hi:[1,0,0]
    v_pk_mul_f32 v[82:83], v[80:81], v[68:69] op_sel_hi:[1,0]
    v_pk_fma_f32 v[80:81], v[80:81], v[68:69], v[82:83] op_sel:[1,1,0] op_sel_hi:[0,1,1] neg_hi:[1,0,0]
    s_waitcnt lgkmcnt(9)
    v_mfma_f32_32x32x16_bf16 v[128:143], v[164:167], v[196:199], v[128:143]
    v_cvt_pk_bf16_f32 v226, v76, v77
    v_cvt_pk_bf16_f32 v228, v80, v81
    ds_write2_b32 v222, v230, v228 offset0:0 offset1:68
    v_pk_mul_f32 v[78:79], v[76:77], v[64:65] op_sel_hi:[1,0]
    v_pk_fma_f32 v[76:77], v[76:77], v[64:65], v[78:79] op_sel:[1,1,0] op_sel_hi:[0,1,1] neg_hi:[1,0,0]
    v_pk_mul_f32 v[82:83], v[80:81], v[68:69] op_sel_hi:[1,0]
    v_pk_fma_f32 v[80:81], v[80:81], v[68:69], v[82:83] op_sel:[1,1,0] op_sel_hi:[0,1,1] neg_hi:[1,0,0]
    v_cvt_pk_bf16_f32 v229, v76, v77
    ds_write2_b32 v219, v226, v229 offset0:136 offset1:204
    s_waitcnt lgkmcnt(10)
    v_mfma_f32_32x32x16_bf16 v[128:143], v[168:171], v[200:203], v[128:143]
    v_cvt_pk_bf16_f32 v229, v80, v81
    v_pk_mul_f32 v[82:83], v[80:81], v[68:69] op_sel_hi:[1,0]
    v_pk_fma_f32 v[80:81], v[80:81], v[68:69], v[82:83] op_sel:[1,1,0] op_sel_hi:[0,1,1] neg_hi:[1,0,0]
    v_cvt_pk_bf16_f32 v231, v80, v81
    ds_write2_b32 v222, v229, v231 offset0:136 offset1:204
    v_pk_mul_f32 v[82:83], v[80:81], v[68:69] op_sel_hi:[1,0]
    v_pk_fma_f32 v[80:81], v[80:81], v[68:69], v[82:83] op_sel:[1,1,0] op_sel_hi:[0,1,1] neg_hi:[1,0,0]
    v_cvt_pk_bf16_f32 v231, v80, v81
    ds_write_b32 v223, v231
    s_waitcnt lgkmcnt(11)
    v_mfma_f32_32x32x16_bf16 v[128:143], v[172:175], v[204:207], v[128:143]
    ds_read_b128 v[144:147], v17 offset:0
    ds_read_b128 v[148:151], v17 offset:32
    ds_read_b128 v[152:155], v17 offset:64
    ds_read_b128 v[156:159], v17 offset:96
    ds_read_b128 v[160:163], v17 offset:128
    ds_read_b128 v[164:167], v17 offset:160
    ds_read_b128 v[168:171], v17 offset:192
    ds_read_b128 v[172:175], v17 offset:224
    v_pk_mul_f32 v[78:79], v[66:67], v[66:67] op_sel_hi:[1,0]
    v_pk_fma_f32 v[70:71], v[66:67], v[66:67], v[78:79] op_sel:[1,1,0] op_sel_hi:[0,1,1] neg_lo:[1,0,0]
    v_mov_b32 v226, 0x3f80
    v_cvt_pk_bf16_f32 v228, v66, v67
    ds_write2_b32 v218, v226, v228 offset0:0 offset1:68
    v_cvt_pk_bf16_f32 v228, v70, v71
    v_pk_mul_f32 v[82:83], v[66:67], v[70:71] op_sel_hi:[1,0]
    v_pk_fma_f32 v[80:81], v[66:67], v[70:71], v[82:83] op_sel:[1,1,0] op_sel_hi:[0,1,1] neg_lo:[1,0,0]
    v_pk_mul_f32 v[78:79], v[70:71], v[70:71] op_sel_hi:[1,0]
    v_pk_fma_f32 v[76:77], v[70:71], v[70:71], v[78:79] op_sel:[1,1,0] op_sel_hi:[0,1,1] neg_lo:[1,0,0]
    v_cvt_pk_bf16_f32 v230, v80, v81
    ds_write2_b32 v218, v228, v230 offset0:136 offset1:204
    v_cvt_pk_bf16_f32 v230, v76, v77
    v_pk_mul_f32 v[82:83], v[80:81], v[70:71] op_sel_hi:[1,0]
    v_pk_fma_f32 v[80:81], v[80:81], v[70:71], v[82:83] op_sel:[1,1,0] op_sel_hi:[0,1,1] neg_lo:[1,0,0]
    v_pk_mul_f32 v[78:79], v[76:77], v[70:71] op_sel_hi:[1,0]
    v_pk_fma_f32 v[76:77], v[76:77], v[70:71], v[78:79] op_sel:[1,1,0] op_sel_hi:[0,1,1] neg_lo:[1,0,0]
    v_cvt_pk_bf16_f32 v226, v80, v81
    ds_write2_b32 v219, v230, v226 offset0:0 offset1:68
    v_cvt_pk_bf16_f32 v227, v76, v77
    v_pk_mul_f32 v[82:83], v[80:81], v[70:71] op_sel_hi:[1,0]
    v_pk_fma_f32 v[80:81], v[80:81], v[70:71], v[82:83] op_sel:[1,1,0] op_sel_hi:[0,1,1] neg_lo:[1,0,0]
    v_pk_mul_f32 v[78:79], v[76:77], v[70:71] op_sel_hi:[1,0]
    v_pk_fma_f32 v[76:77], v[76:77], v[70:71], v[78:79] op_sel:[1,1,0] op_sel_hi:[0,1,1] neg_lo:[1,0,0]
    v_cvt_pk_bf16_f32 v229, v80, v81
    ds_write2_b32 v219, v227, v229 offset0:136 offset1:204
    v_cvt_pk_bf16_f32 v229, v76, v77
    v_pk_mul_f32 v[82:83], v[80:81], v[70:71] op_sel_hi:[1,0]
    v_pk_fma_f32 v[80:81], v[80:81], v[70:71], v[82:83] op_sel:[1,1,0] op_sel_hi:[0,1,1] neg_lo:[1,0,0]
    v_pk_mul_f32 v[78:79], v[76:77], v[70:71] op_sel_hi:[1,0]
    v_pk_fma_f32 v[76:77], v[76:77], v[70:71], v[78:79] op_sel:[1,1,0] op_sel_hi:[0,1,1] neg_lo:[1,0,0]
    v_cvt_pk_bf16_f32 v231, v80, v81
    ds_write2_b32 v220, v229, v231 offset0:0 offset1:68
    v_cvt_pk_bf16_f32 v231, v76, v77
    v_pk_mul_f32 v[82:83], v[80:81], v[70:71] op_sel_hi:[1,0]
    v_pk_fma_f32 v[80:81], v[80:81], v[70:71], v[82:83] op_sel:[1,1,0] op_sel_hi:[0,1,1] neg_lo:[1,0,0]
    v_pk_mul_f32 v[78:79], v[76:77], v[70:71] op_sel_hi:[1,0]
    v_pk_fma_f32 v[76:77], v[76:77], v[70:71], v[78:79] op_sel:[1,1,0] op_sel_hi:[0,1,1] neg_lo:[1,0,0]
    v_cvt_pk_bf16_f32 v227, v80, v81
    ds_write2_b32 v220, v231, v227 offset0:136 offset1:204
    v_cvt_pk_bf16_f32 v228, v76, v77
    v_pk_mul_f32 v[82:83], v[80:81], v[70:71] op_sel_hi:[1,0]
    v_pk_fma_f32 v[80:81], v[80:81], v[70:71], v[82:83] op_sel:[1,1,0] op_sel_hi:[0,1,1] neg_lo:[1,0,0]
    v_pk_mul_f32 v[78:79], v[76:77], v[70:71] op_sel_hi:[1,0]
    v_pk_fma_f32 v[76:77], v[76:77], v[70:71], v[78:79] op_sel:[1,1,0] op_sel_hi:[0,1,1] neg_lo:[1,0,0]
    v_cvt_pk_bf16_f32 v230, v80, v81
    ds_write2_b32 v221, v228, v230 offset0:0 offset1:68
    v_cvt_pk_bf16_f32 v230, v76, v77
    v_pk_mul_f32 v[82:83], v[80:81], v[70:71] op_sel_hi:[1,0]
    v_pk_fma_f32 v[80:81], v[80:81], v[70:71], v[82:83] op_sel:[1,1,0] op_sel_hi:[0,1,1] neg_lo:[1,0,0]
    v_pk_mul_f32 v[78:79], v[76:77], v[70:71] op_sel_hi:[1,0]
    v_pk_fma_f32 v[76:77], v[76:77], v[70:71], v[78:79] op_sel:[1,1,0] op_sel_hi:[0,1,1] neg_lo:[1,0,0]
    v_cvt_pk_bf16_f32 v226, v80, v81
    ds_write2_b32 v221, v230, v226 offset0:136 offset1:204
    v_cvt_pk_bf16_f32 v227, v76, v77
    v_pk_mul_f32 v[82:83], v[80:81], v[70:71] op_sel_hi:[1,0]
    v_pk_fma_f32 v[80:81], v[80:81], v[70:71], v[82:83] op_sel:[1,1,0] op_sel_hi:[0,1,1] neg_lo:[1,0,0]
    v_pk_mul_f32 v[78:79], v[76:77], v[70:71] op_sel_hi:[1,0]
    v_pk_fma_f32 v[76:77], v[76:77], v[70:71], v[78:79] op_sel:[1,1,0] op_sel_hi:[0,1,1] neg_lo:[1,0,0]
    v_cvt_pk_bf16_f32 v229, v80, v81
    ds_write2_b32 v222, v227, v229 offset0:0 offset1:68
    v_cvt_pk_bf16_f32 v229, v76, v77
    v_pk_mul_f32 v[82:83], v[80:81], v[70:71] op_sel_hi:[1,0]
    v_pk_fma_f32 v[80:81], v[80:81], v[70:71], v[82:83] op_sel:[1,1,0] op_sel_hi:[0,1,1] neg_lo:[1,0,0]
    v_pk_mul_f32 v[78:79], v[76:77], v[70:71] op_sel_hi:[1,0]
    v_pk_fma_f32 v[76:77], v[76:77], v[70:71], v[78:79] op_sel:[1,1,0] op_sel_hi:[0,1,1] neg_lo:[1,0,0]
    v_cvt_pk_bf16_f32 v231, v80, v81
    ds_write2_b32 v222, v229, v231 offset0:136 offset1:204
    v_cvt_pk_bf16_f32 v231, v76, v77
    v_pk_mul_f32 v[82:83], v[80:81], v[70:71] op_sel_hi:[1,0]
    v_pk_fma_f32 v[80:81], v[80:81], v[70:71], v[82:83] op_sel:[1,1,0] op_sel_hi:[0,1,1] neg_lo:[1,0,0]
    v_pk_mul_f32 v[78:79], v[76:77], v[70:71] op_sel_hi:[1,0]
    v_pk_fma_f32 v[76:77], v[76:77], v[70:71], v[78:79] op_sel:[1,1,0] op_sel_hi:[0,1,1] neg_lo:[1,0,0]
    v_cvt_pk_bf16_f32 v227, v80, v81
    ds_write2_b32 v223, v231, v227 offset0:0 offset1:68
    v_cvt_pk_bf16_f32 v228, v76, v77
    v_pk_mul_f32 v[82:83], v[80:81], v[70:71] op_sel_hi:[1,0]
    v_pk_fma_f32 v[80:81], v[80:81], v[70:71], v[82:83] op_sel:[1,1,0] op_sel_hi:[0,1,1] neg_lo:[1,0,0]
    v_pk_mul_f32 v[78:79], v[76:77], v[70:71] op_sel_hi:[1,0]
    v_pk_fma_f32 v[76:77], v[76:77], v[70:71], v[78:79] op_sel:[1,1,0] op_sel_hi:[0,1,1] neg_lo:[1,0,0]
    v_cvt_pk_bf16_f32 v230, v80, v81
    ds_write2_b32 v223, v228, v230 offset0:136 offset1:204
    v_cvt_pk_bf16_f32 v230, v76, v77
    v_pk_mul_f32 v[82:83], v[80:81], v[70:71] op_sel_hi:[1,0]
    v_pk_fma_f32 v[80:81], v[80:81], v[70:71], v[82:83] op_sel:[1,1,0] op_sel_hi:[0,1,1] neg_lo:[1,0,0]
    v_pk_mul_f32 v[78:79], v[76:77], v[70:71] op_sel_hi:[1,0]
    v_pk_fma_f32 v[76:77], v[76:77], v[70:71], v[78:79] op_sel:[1,1,0] op_sel_hi:[0,1,1] neg_lo:[1,0,0]
    v_cvt_pk_bf16_f32 v226, v80, v81
    ds_write2_b32 v224, v230, v226 offset0:0 offset1:68
    v_cvt_pk_bf16_f32 v227, v76, v77
    v_pk_mul_f32 v[82:83], v[80:81], v[70:71] op_sel_hi:[1,0]
    v_pk_fma_f32 v[80:81], v[80:81], v[70:71], v[82:83] op_sel:[1,1,0] op_sel_hi:[0,1,1] neg_lo:[1,0,0]
    v_pk_mul_f32 v[78:79], v[76:77], v[70:71] op_sel_hi:[1,0]
    v_pk_fma_f32 v[76:77], v[76:77], v[70:71], v[78:79] op_sel:[1,1,0] op_sel_hi:[0,1,1] neg_lo:[1,0,0]
    v_cvt_pk_bf16_f32 v229, v80, v81
    ds_write2_b32 v224, v227, v229 offset0:136 offset1:204
    v_cvt_pk_bf16_f32 v229, v76, v77
    v_pk_mul_f32 v[82:83], v[80:81], v[70:71] op_sel_hi:[1,0]
    v_pk_fma_f32 v[80:81], v[80:81], v[70:71], v[82:83] op_sel:[1,1,0] op_sel_hi:[0,1,1] neg_lo:[1,0,0]
    v_pk_mul_f32 v[78:79], v[76:77], v[70:71] op_sel_hi:[1,0]
    v_pk_fma_f32 v[76:77], v[76:77], v[70:71], v[78:79] op_sel:[1,1,0] op_sel_hi:[0,1,1] neg_lo:[1,0,0]
    v_cvt_pk_bf16_f32 v231, v80, v81
    ds_write2_b32 v225, v229, v231 offset0:0 offset1:68
    v_cvt_pk_bf16_f32 v231, v76, v77
    v_pk_mul_f32 v[82:83], v[80:81], v[70:71] op_sel_hi:[1,0]
    v_pk_fma_f32 v[80:81], v[80:81], v[70:71], v[82:83] op_sel:[1,1,0] op_sel_hi:[0,1,1] neg_lo:[1,0,0]
    v_cvt_pk_bf16_f32 v227, v80, v81
    ds_write2_b32 v225, v231, v227 offset0:136 offset1:204
    ds_read_b128 v[176:179], v17 offset:0
    ds_read_b128 v[180:183], v17 offset:32
    ds_read_b128 v[184:187], v17 offset:64
    ds_read_b128 v[188:191], v17 offset:96
    ds_read_b128 v[192:195], v17 offset:128
    ds_read_b128 v[196:199], v17 offset:160
    ds_read_b128 v[200:203], v17 offset:192
    ds_read_b128 v[204:207], v17 offset:224
    v_and_b32 v64, 31, v0
    v_lshrrev_b32 v65, 5, v0
    s_add_u32 s14, s73, 4640
    v_lshlrev_b32 v66, 4, v64
    s_waitcnt lgkmcnt(7)
    v_mfma_f32_32x32x16_bf16 v[128:143], v[144:147], v[176:179], v[128:143]
    v_lshl_add_u32 v66, v65, 3, v66
    v_add_u32 v66, s14, v66
    v_cmp_eq_u32 vcc, 1, v65
    v_lshlrev_b32 v67, 3, v64
    s_waitcnt lgkmcnt(6)
    v_mfma_f32_32x32x16_bf16 v[128:143], v[148:151], v[180:183], v[128:143]
    v_lshlrev_b32 v68, 2, v64
    v_add_u32 v69, 512, v67
    v_add_u32 v70, 768, v68
    v_cndmask_b32 v69, v69, v70, vcc
    s_waitcnt lgkmcnt(5)
    v_mfma_f32_32x32x16_bf16 v[128:143], v[152:155], v[184:187], v[128:143]
    v_add_u32 v69, s14, v69
    v_add_u32 v71, 516, v67
    v_add_u32 v70, 896, v68
    v_cndmask_b32 v71, v71, v70, vcc
    s_waitcnt lgkmcnt(4)
    v_mfma_f32_32x32x16_bf16 v[128:143], v[156:159], v[188:191], v[128:143]
    v_add_u32 v71, s14, v71
    v_lshlrev_b32 v72, 1, v64
    v_lshl_add_u32 v72, v65, 8, v72
    v_add_u32 v72, 1024, v72
    s_waitcnt lgkmcnt(3)
    v_mfma_f32_32x32x16_bf16 v[128:143], v[160:163], v[192:195], v[128:143]
    v_add_u32 v72, s14, v72
    v_mov_b32 v80, 0
    v_mov_b32 v81, 0
    v_mov_b32 v82, 0
    s_waitcnt lgkmcnt(2)
    v_mfma_f32_32x32x16_bf16 v[128:143], v[164:167], v[196:199], v[128:143]
    v_mov_b32 v83, 0
    v_lshrrev_b32 v64, 3, v0
    v_mul_u32_u24 v64, 1152, v64
    v_and_b32 v65, 7, v0
    s_waitcnt lgkmcnt(1)
    v_mfma_f32_32x32x16_bf16 v[128:143], v[168:171], v[200:203], v[128:143]
    v_lshl_add_u32 v64, v65, 4, v64
    v_add_u32 v64, s73, v64
    v_add_u32 v65, s73, v1
    s_waitcnt lgkmcnt(0)
    v_mfma_f32_32x32x16_bf16 v[128:143], v[172:175], v[204:207], v[128:143]
    s_mov_b64 exec, 1
    s_nop 10
    v_add_f32 v128, s82, v128
    s_mov_b64 exec, -1
    v_cvt_pk_bf16_f32 v74, v128, v129
    v_cvt_pk_bf16_f32 v75, v130, v131
    v_cvt_pk_bf16_f32 v76, v132, v133
    v_cvt_pk_bf16_f32 v77, v134, v135
    v_cvt_pk_bf16_f32 v78, v136, v137
    v_cvt_pk_bf16_f32 v79, v138, v139
    ds_write_b64 v66, v[74:75]
    ds_write_b32 v69, v76
    ds_write_b32 v71, v77
    ds_write_b16 v72, v78
    ds_write_b16_d16_hi v72, v78 offset:64
    ds_write_b16 v72, v79 offset:128
    ds_write_b16_d16_hi v72, v79 offset:192
    ds_read_u16 v144, v32
    ds_read_u16_d16_hi v145, v33
    ds_read_u16 v146, v34
    ds_read_u16_d16_hi v147, v35
    ds_read_u16 v148, v36
    ds_read_u16_d16_hi v149, v37
    ds_read_u16 v150, v38
    ds_read_u16_d16_hi v151, v39
    ds_read_u16 v152, v40
    ds_read_u16_d16_hi v153, v41
    ds_read_u16 v154, v42
    ds_read_u16_d16_hi v155, v43
    ds_read_u16 v156, v44
    ds_read_u16_d16_hi v157, v45
    ds_read_u16 v158, v46
    ds_read_u16_d16_hi v159, v47
    ds_read_u16 v160, v48
    ds_read_u16_d16_hi v161, v49
    ds_read_u16 v162, v50
    ds_read_u16_d16_hi v163, v51
    ds_read_u16 v164, v52
    ds_read_u16_d16_hi v165, v53
    ds_read_u16 v166, v54
    ds_read_u16_d16_hi v167, v55
    ds_read_u16 v168, v56
    ds_read_u16_d16_hi v169, v57
    ds_read_u16 v170, v58
    ds_read_u16_d16_hi v171, v59
    ds_read_u16 v172, v60
    ds_read_u16_d16_hi v173, v61
    ds_read_u16 v174, v62
    ds_read_u16_d16_hi v175, v63
    s_waitcnt lgkmcnt(15)
    v_or_b32 v128, v144, v145
    v_or_b32 v129, v146, v147
    v_or_b32 v130, v148, v149
    v_or_b32 v131, v150, v151
    ds_write_b128 v65, v[128:131] offset:0
    v_or_b32 v132, v152, v153
    v_or_b32 v133, v154, v155
    v_or_b32 v134, v156, v157
    v_or_b32 v135, v158, v159
    ds_write_b128 v65, v[132:135] offset:1152
    s_waitcnt lgkmcnt(10)
    v_or_b32 v136, v160, v161
    v_or_b32 v137, v162, v163
    v_or_b32 v138, v164, v165
    v_or_b32 v139, v166, v167
    ds_write_b128 v65, v[136:139] offset:2304
    s_waitcnt lgkmcnt(3)
    v_or_b32 v140, v168, v169
    v_or_b32 v141, v170, v171
    v_or_b32 v142, v172, v173
    v_or_b32 v143, v174, v175
    ds_write_b128 v65, v[140:143] offset:3456
    s_mov_b64 exec, 0xffffffff
    ds_write_b128 v64, v[80:83] offset:1024
    s_mov_b64 exec, 3
    ds_write_b128 v65, v[80:83] offset:4608
    s_mov_b64 exec, -1
    s_cmp_ge_u32 s12, 7
    s_cselect_b32 s78, s75, 0
    s_add_u32 s78, s78, s74
    s_add_u32 s78, s78, 884736
    buffer_load_dwordx4 a[40:43], v2, s[52:55], s78 offen
    buffer_load_dwordx4 a[44:47], v3, s[52:55], s78 offen offset:1024
    buffer_load_dwordx4 a[48:51], v4, s[52:55], s78 offen offset:2048
    buffer_load_dwordx4 a[52:55], v5, s[52:55], s78 offen offset:3072
    s_add_u32 s78, s78, 110592
    buffer_load_dwordx4 a[56:59], v2, s[52:55], s78 offen
    buffer_load_dwordx4 a[60:63], v3, s[52:55], s78 offen offset:1024
    buffer_load_dwordx4 a[64:67], v4, s[52:55], s78 offen offset:2048
    buffer_load_dwordx4 a[68:71], v5, s[52:55], s78 offen offset:3072
    v_and_b32 v18, 3, v0
    v_bfe_u32 v19, v0, 2, 2
    v_add_u32 v18, v18, v19
    v_lshrrev_b32 v19, 4, v0
    v_lshlrev_b32 v16, 3, v18
    v_lshl_add_u32 v16, v19, 6, v16
    s_add_u32 s14, s73, 4616
    v_add_u32 v16, s14, v16
    v_and_b32 v18, 15, v0
    v_lshlrev_b32 v18, 3, v18
    v_lshlrev_b32 v17, 4, v19
    v_sub_u32 v17, v17, v18
    s_add_u32 s14, s73, 120
    v_add_u32 v17, s14, v17
    v_add_u32 v18, s73, v1
    v_add_u32 v32, 1152, v17
    v_add_u32 v33, 2304, v17
    v_add_u32 v34, 3456, v17
    s_cmp_eq_u32 s11, 0
    s_cbranch_scc1 L_skip1
    s_branch L_idle1b
L_idle1:
    s_waitcnt vmcnt(0)
    s_cmp_ge_u32 s12, 7
    s_cselect_b32 s78, s75, 0
    s_add_u32 s78, s78, s74
    s_add_u32 s78, s78, 884736
    buffer_load_dwordx4 a[40:43], v2, s[52:55], s78 offen
    buffer_load_dwordx4 a[44:47], v3, s[52:55], s78 offen offset:1024
    buffer_load_dwordx4 a[48:51], v4, s[52:55], s78 offen offset:2048
    buffer_load_dwordx4 a[52:55], v5, s[52:55], s78 offen offset:3072
    s_add_u32 s78, s78, 110592
    buffer_load_dwordx4 a[56:59], v2, s[52:55], s78 offen
    buffer_load_dwordx4 a[60:63], v3, s[52:55], s78 offen offset:1024
    buffer_load_dwordx4 a[64:67], v4, s[52:55], s78 offen offset:2048
    buffer_load_dwordx4 a[68:71], v5, s[52:55], s78 offen offset:3072
L_idle1b:
    s_nop 11
    v_mov_b32 v20, 157308
    s_mov_b32 s84, 0
L_cnt1:
    ds_read_b32 v21, v20
    s_waitcnt lgkmcnt(0)
    v_readfirstlane_b32 s14, v21
    s_nop 0
    s_cmp_ge_u32 s14, 1
    s_cbranch_scc1 L_cnt1_ok
    s_sleep 1
    s_add_u32 s84, s84, 1
    s_cmp_lt_u32 s84, 0x80000
    s_cbranch_scc1 L_cnt1
L_cnt1_ok:
    s_branch L_join1
L_ld0:
    s_movk_i32 s85, 6554
    v_add_u32 v21, 0, v0
    v_mul_lo_u32 v22, v21, s85
    v_lshrrev_b32 v22, 16, v22
    v_mul_u32_u24 v23, 10, v22
    v_sub_u32 v21, v21, v23
    v_mul_u32_u24 v22, 1280, v22
    v_lshl_add_u32 v44, v21, 4, v22
    v_add_u32 v21, 64, v0
    v_mul_lo_u32 v22, v21, s85
    v_lshrrev_b32 v22, 16, v22
    v_mul_u32_u24 v23, 10, v22
    v_sub_u32 v21, v21, v23
    v_mul_u32_u24 v22, 1280, v22
    v_lshl_add_u32 v45, v21, 4, v22
    v_add_u32 v21, 128, v0
    v_mul_lo_u32 v22, v21, s85
    v_lshrrev_b32 v22, 16, v22
    v_mul_u32_u24 v23, 10, v22
    v_sub_u32 v21, v21, v23
    v_mul_u32_u24 v22, 1280, v22
    v_lshl_add_u32 v46, v21, 4, v22
    v_add_u32 v21, 192, v0
    v_mul_lo_u32 v22, v21, s85
    v_lshrrev_b32 v22, 16, v22
    v_mul_u32_u24 v23, 10, v22
    v_sub_u32 v21, v21, v23
    v_mul_u32_u24 v22, 1280, v22
    v_lshl_add_u32 v47, v21, 4, v22
    v_add_u32 v21, 256, v0
    v_mul_lo_u32 v22, v21, s85
    v_lshrrev_b32 v22, 16, v22
    v_mul_u32_u24 v23, 10, v22
    v_sub_u32 v21, v21, v23
    v_mul_u32_u24 v22, 1280, v22
    v_lshl_add_u32 v48, v21, 4, v22
    s_mul_i32 s14, s8, 81920
    s_mul_i32 s15, s90, 160
    s_add_u32 s14, s14, s15
    s_add_u32 s15, s14, 40960
    s_mov_b32 m0, 86016
    s_nop 0
    buffer_load_dwordx4 v44, s[48:51], s14 offen nt lds
    s_mov_b32 m0, 91136
    s_nop 0
    buffer_load_dwordx4 v44, s[48:51], s15 offen nt lds
    s_mov_b32 m0, 87040
    s_nop 0
    buffer_load_dwordx4 v45, s[48:51], s14 offen nt lds
    s_mov_b32 m0, 92160
    s_nop 0
    buffer_load_dwordx4 v45, s[48:51], s15 offen nt lds
    s_mov_b32 m0, 88064
    s_nop 0
    buffer_load_dwordx4 v46, s[48:51], s14 offen nt lds
    s_mov_b32 m0, 93184
    s_nop 0
    buffer_load_dwordx4 v46, s[48:51], s15 offen nt lds
    s_mov_b32 m0, 89088
    s_nop 0
    buffer_load_dwordx4 v47, s[48:51], s14 offen nt lds
    s_mov_b32 m0, 94208
    s_nop 0
    buffer_load_dwordx4 v47, s[48:51], s15 offen nt lds
    s_mov_b32 m0, 90112
    s_nop 0
    buffer_load_dwordx4 v48, s[48:51], s14 offen nt lds
    s_mov_b32 m0, 95232
    s_nop 0
    buffer_load_dwordx4 v48, s[48:51], s15 offen nt lds
    v_lshrrev_b32 v20, 3, v0
    v_mul_u32_u24 v20, 3456, v20
    v_and_b32 v21, 7, v0
    v_bfe_u32 v22, v0, 4, 1
    v_lshlrev_b32 v22, 1, v22
    v_xor_b32 v21, v21, v22
    v_xor_b32 v22, 0, v21
    v_lshl_add_u32 v2, v22, 4, v20
    v_xor_b32 v22, 4, v21
    v_lshl_add_u32 v3, v22, 4, v20
    v_add_u32 v3, 26624, v3
    v_xor_b32 v22, 0, v21
    v_lshl_add_u32 v4, v22, 4, v20
    v_add_u32 v4, 53248, v4
    v_xor_b32 v22, 4, v21
    v_lshl_add_u32 v5, v22, 4, v20
    v_add_u32 v5, 79872, v5
    s_cmp_ge_u32 s98, 15
    s_cselect_b32 s78, s97, 0
    s_add_u32 s78, s78, s96
    s_mov_b32 m0, 0
    s_nop 0
    buffer_load_dwordx4 v2, s[52:55], s78 offen lds
    buffer_load_dwordx4 v3, s[52:55], s78 offen offset:1024 lds
    buffer_load_dwordx4 v4, s[52:55], s78 offen offset:2048 lds
    buffer_load_dwordx4 v5, s[52:55], s78 offen offset:3072 lds
    s_add_u32 s78, s78, 1658880
    s_mov_b32 m0, 32768
    s_nop 0
    buffer_load_dwordx4 v2, s[52:55], s78 offen lds
    buffer_load_dwordx4 v3, s[52:55], s78 offen offset:1024 lds
    v_lshrrev_b32 v20, 4, v0
    v_lshlrev_b32 v20, 3, v20
    s_lshl_b32 s14, s7, 7
    s_lshl_b32 s15, s3, 5
    s_add_u32 s14, s14, s15
    v_add_u32 v20, s14, v20
    global_load_dwordx2 v[28:29], v20, s[34:35]
    v_and_b32 v20, 15, v0
    s_lshl_b32 s14, s8, 6
    s_lshl_b32 s15, s3, 4
    s_add_u32 s14, s14, s15
    v_add_u32 v30, s14, v20
    v_lshlrev_b32 v30, 1, v30
    global_load_ushort v15, v30, s[38:39]
    global_load_dwordx2 v[208:209], v25, s[40:41] offset:0
    global_load_dwordx2 v[210:211], v25, s[40:41] offset:256
    global_load_dwordx2 v[212:213], v25, s[40:41] offset:512
    global_load_dwordx2 v[214:215], v25, s[40:41] offset:768
    global_load_dwordx2 v[216:217], v25, s[40:41] offset:1024
    s_mov_b32 s56, s36
    s_and_b32 s57, s37, 0xffff
    s_mov_b32 s58, 0x6c0000
    s_mov_b32 s59, 0x20000
    s_mov_b32 s60, s46
    s_and_b32 s61, s47, 0xffff
    s_mov_b32 s62, 0x1000000
    s_mov_b32 s63, 0x20000
    s_mov_b32 s68, s42
    s_and_b32 s69, s43, 0xffff
    s_mov_b32 s70, 0x280000
    s_mov_b32 s71, 0x20000
    s_add_u32 s64, s46, 0x700000
    s_addc_u32 s65, s47, 0
    s_and_b32 s65, s65, 0xffff
    s_mov_b32 s66, 0x21c000
    s_mov_b32 s67, 0x20000
    s_lshl_b32 s14, s3, 1
    v_add_u32 v26, s14, v24
    v_mul_u32_u24 v27, 1344, v26
    v_add_u32 v27, v27, v25
    v_add_u32 v27, 118784, v27
    v_lshrrev_b32 v20, 4, v0
    v_bfe_u32 v21, v0, 2, 2
    v_lshl_add_u32 v22, v20, 3, v21
    v_lshlrev_b32 v22, 7, v22
    v_and_b32 v23, 3, v0
    v_lshl_add_u32 v22, v23, 3, v22
    v_add_u32 v22, s72, v22
    v_lshrrev_b32 v21, 1, v21
    v_and_b32 v23, 1, v20
    v_lshl_or_b32 v21, v23, 1, v21
    v_xor_b32 v21, s3, v21
    v_xor_b32 v23, 0, v21
    v_lshl_add_u32 v6, v23, 5, v22
    v_xor_b32 v23, 1, v21
    v_lshl_add_u32 v7, v23, 5, v22
    v_xor_b32 v23, 2, v21
    v_lshl_add_u32 v8, v23, 5, v22
    v_xor_b32 v23, 3, v21
    v_lshl_add_u32 v9, v23, 5, v22
    v_mul_u32_u24 v10, 10240, v20
    v_and_b32 v21, 15, v0
    v_lshl_add_u32 v10, v21, 4, v10
    v_add_u32 v11, s72, v1
    s_xor_b32 s14, s3, 1
    s_lshl_b32 s14, s14, 15
    v_add_u32 v12, s14, v1
    s_xor_b32 s14, s3, 2
    s_lshl_b32 s14, s14, 15
    v_add_u32 v13, s14, v1
    s_xor_b32 s14, s3, 3
    s_lshl_b32 s14, s14, 15
    v_add_u32 v14, s14, v1
    s_waitcnt lgkmcnt(0)
    s_mul_i32 s4, s4, 1664525
    s_add_u32 s4, s4, 1013904223
    v_bfe_u32 v16, v0, 2, 2
    v_lshrrev_b32 v17, 4, v0
    v_and_b32 v22, 3, v0
    v_mul_u32_u24 v18, 1344, v16
    v_lshl_add_u32 v18, v17, 5, v18
    v_lshl_add_u32 v18, v22, 3, v18
    v_add_u32 v18, 118784, v18
    v_lshl_add_u32 v23, v17, 3, v16
    v_mul_u32_u24 v23, 160, v23
    v_lshl_add_u32 v23, v22, 3, v23
    v_add_u32 v23, 86016, v23
    v_and_b32 v20, 15, v0
    v_and_b32 v21, 7, v0
    v_xor_b32 v22, v17, v21
    v_lshlrev_b32 v22, 4, v22
    v_lshl_add_u32 v32, v20, 7, v22
    v_add_u32 v32, 86016, v32
    v_xor_b32 v33, 64, v32
    v_lshrrev_b32 v20, 3, v0
    v_xor_b32 v22, v20, v21
    v_lshlrev_b32 v22, 4, v22
    v_lshl_add_u32 v34, v20, 7, v22
    v_add_u32 v34, 86016, v34
    v_lshlrev_b32 v35, 12, v20
    v_lshl_add_u32 v35, v21, 4, v35
    s_barrier
    s_waitcnt vmcnt(24)
    v_mov_b32 v116, 0
    v_mov_b32 v118, 0
    v_mov_b32 v117, 0x3f803f80
    v_dot2c_f32_bf16 v116, v64, v117
    v_dot2c_f32_bf16 v118, v64, v64
    s_cmp_ge_u32 s98, 15
    s_cselect_b32 s78, s97, 0
    s_add_u32 s78, s78, s96
    s_add_u32 s78, s78, 1658880
    s_mov_b32 m0, 32768
    s_nop 0
    buffer_load_dwordx4 v4, s[52:55], s78 offen offset:2048 lds
    v_dot2c_f32_bf16 v116, v65, v117
    v_dot2c_f32_bf16 v118, v65, v65
    v_dot2c_f32_bf16 v116, v66, v117
    v_dot2c_f32_bf16 v118, v66, v66
    v_dot2c_f32_bf16 v116, v67, v117
    buffer_load_dwordx4 v5, s[52:55], s78 offen offset:3072 lds
    v_dot2c_f32_bf16 v118, v67, v67
    v_dot2c_f32_bf16 v116, v68, v117
    v_dot2c_f32_bf16 v118, v68, v68
    v_dot2c_f32_bf16 v116, v69, v117
    v_dot2c_f32_bf16 v118, v69, v69
    s_add_u32 s78, s78, 1658880
    s_mov_b32 m0, 65536
    s_nop 0
    buffer_load_dwordx4 v2, s[52:55], s78 offen lds
    v_dot2c_f32_bf16 v116, v70, v117
    v_dot2c_f32_bf16 v118, v70, v70
    v_dot2c_f32_bf16 v116, v71, v117
    v_dot2c_f32_bf16 v118, v71, v71
    v_dot2c_f32_bf16 v116, v72, v117
    buffer_load_dwordx4 v3, s[52:55], s78 offen offset:1024 lds
    v_dot2c_f32_bf16 v118, v72, v72
    v_dot2c_f32_bf16 v116, v73, v117
    v_dot2c_f32_bf16 v118, v73, v73
    v_lshlrev_b32 v96, 16, v64
    v_and_b32 v97, s83, v64
    buffer_load_dwordx4 v4, s[52:55], s78 offen offset:2048 lds
    v_lshlrev_b32 v98, 16, v65
    v_add_f32_dpp v116, v116, v116 row_ror:8 row_mask:0xf bank_mask:0xf
    v_add_f32_dpp v118, v118, v118 row_ror:8 row_mask:0xf bank_mask:0xf
    v_and_b32 v99, s83, v65
    v_add_f32_dpp v116, v116, v116 row_ror:4 row_mask:0xf bank_mask:0xf
    buffer_load_dwordx4 v5, s[52:55], s78 offen offset:3072 lds
    v_add_f32_dpp v118, v118, v118 row_ror:4 row_mask:0xf bank_mask:0xf
    v_lshlrev_b32 v100, 16, v66
    v_add_f32_dpp v116, v116, v116 row_ror:2 row_mask:0xf bank_mask:0xf
    v_add_f32_dpp v118, v118, v118 row_ror:2 row_mask:0xf bank_mask:0xf
    v_and_b32 v101, s83, v66
    s_cmp_ge_u32 s12, 19
    s_cselect_b32 s78, s75, 0
    s_add_u32 s78, s78, s74
    s_mov_b32 m0, 98304
    s_nop 0
    buffer_load_dwordx4 v2, s[52:55], s78 offen lds
    v_add_f32_dpp v116, v116, v116 row_ror:1 row_mask:0xf bank_mask:0xf
    v_add_f32_dpp v118, v118, v118 row_ror:1 row_mask:0xf bank_mask:0xf
    v_lshlrev_b32 v102, 16, v67
    v_mov_b32 v117, v116
    v_mov_b32 v119, v118
    buffer_load_dwordx4 v3, s[52:55], s78 offen offset:1024 lds
    v_and_b32 v103, s83, v67
    v_lshlrev_b32 v104, 16, v68
    v_permlane16_swap_b32 v116, v117
    v_permlane16_swap_b32 v118, v119
    v_add_f32 v116, v116, v117
    buffer_load_dwordx4 v4, s[52:55], s78 offen offset:2048 lds
    v_add_f32 v118, v118, v119
    v_mul_f32 v116, 0x3acccccd, v116
    v_mul_f32 v118, 0x3acccccd, v118
    v_mul_f32 v119, v116, v116
    v_and_b32 v105, s83, v68
    buffer_load_dwordx4 v5, s[52:55], s78 offen offset:3072 lds
    v_lshlrev_b32 v106, 16, v69
    v_and_b32 v107, s83, v69
    v_lshlrev_b32 v108, 16, v70
    v_and_b32 v109, s83, v70
    v_lshlrev_b32 v110, 16, v71
    s_cmp_ge_u32 s98, 14
    s_cselect_b32 s78, s97, 0
    s_add_u32 s78, s78, s96
    s_add_u32 s78, s78, 110592
    s_mov_b32 m0, 4096
    s_nop 0
    buffer_load_dwordx4 v2, s[52:55], s78 offen lds
    v_and_b32 v111, s83, v71
    v_lshlrev_b32 v112, 16, v72
    v_and_b32 v113, s83, v72
    v_lshlrev_b32 v114, 16, v73
    v_and_b32 v115, s83, v73
    buffer_load_dwordx4 v3, s[52:55], s78 offen offset:1024 lds
    v_mul_f32 v117, 0x3f7f0000, v118
    v_sub_f32 v118, v118, v119
    v_cmp_nle_f32 vcc, v119, v117
    s_cbranch_vccz L_lnok_2
    v_pk_add_f32 v[120:121], v[96:97], v[116:117] op_sel_hi:[1,0] neg_lo:[0,1] neg_hi:[0,1]
    v_pk_mul_f32 v[124:125], v[120:121], v[120:121]
    v_pk_add_f32 v[122:123], v[98:99], v[116:117] op_sel_hi:[1,0] neg_lo:[0,1] neg_hi:[0,1]
    v_pk_mul_f32 v[126:127], v[122:123], v[122:123]
    v_pk_add_f32 v[120:121], v[100:101], v[116:117] op_sel_hi:[1,0] neg_lo:[0,1] neg_hi:[0,1]
    v_pk_fma_f32 v[124:125], v[120:121], v[120:121], v[124:125]
    v_pk_add_f32 v[122:123], v[102:103], v[116:117] op_sel_hi:[1,0] neg_lo:[0,1] neg_hi:[0,1]
    v_pk_fma_f32 v[126:127], v[122:123], v[122:123], v[126:127]
    v_pk_add_f32 v[120:121], v[104:105], v[116:117] op_sel_hi:[1,0] neg_lo:[0,1] neg_hi:[0,1]
    v_pk_fma_f32 v[124:125], v[120:121], v[120:121], v[124:125]
    v_pk_add_f32 v[122:123], v[106:107], v[116:117] op_sel_hi:[1,0] neg_lo:[0,1] neg_hi:[0,1]
    v_pk_fma_f32 v[126:127], v[122:123], v[122:123], v[126:127]
    v_pk_add_f32 v[120:121], v[108:109], v[116:117] op_sel_hi:[1,0] neg_lo:[0,1] neg_hi:[0,1]
    v_pk_fma_f32 v[124:125], v[120:121], v[120:121], v[124:125]
    v_pk_add_f32 v[122:123], v[110:111], v[116:117] op_sel_hi:[1,0] neg_lo:[0,1] neg_hi:[0,1]
    v_pk_fma_f32 v[126:127], v[122:123], v[122:123], v[126:127]
    v_pk_add_f32 v[120:121], v[112:113], v[116:117] op_sel_hi:[1,0] neg_lo:[0,1] neg_hi:[0,1]
    v_pk_fma_f32 v[124:125], v[120:121], v[120:121], v[124:125]
    v_pk_add_f32 v[122:123], v[114:115], v[116:117] op_sel_hi:[1,0] neg_lo:[0,1] neg_hi:[0,1]
    v_pk_fma_f32 v[126:127], v[122:123], v[122:123], v[126:127]
    v_pk_add_f32 v[124:125], v[124:125], v[126:127]
    v_add_f32 v118, v124, v125
    s_nop 1
    v_add_f32_dpp v118, v118, v118 row_ror:8 row_mask:0xf bank_mask:0xf
    s_nop 1
    v_add_f32_dpp v118, v118, v118 row_ror:4 row_mask:0xf bank_mask:0xf
    s_nop 1
    v_add_f32_dpp v118, v118, v118 row_ror:2 row_mask:0xf bank_mask:0xf
    s_nop 1
    v_add_f32_dpp v118, v118, v118 row_ror:1 row_mask:0xf bank_mask:0xf
    v_mov_b32 v119, v118
    s_nop 1
    v_permlane16_swap_b32 v118, v119
    v_add_f32 v118, v118, v119
    v_mul_f32 v118, 0x3acccccd, v118
L_lnok_2:
    v_cvt_pk_bf16_f32 v119, v116, v118
    v_lshlrev_b32 v116, 16, v119
    v_and_b32 v118, s83, v119
    v_add_f32 v118, 0x3727c5ac, v118
    v_cvt_pk_bf16_f32 v118, v118, v118
    buffer_load_dwordx4 v4, s[52:55], s78 offen offset:2048 lds
    v_lshlrev_b32 v118, 16, v118
    v_sqrt_f32 v118, v118
    s_nop 0
    v_cvt_pk_bf16_f32 v118, v118, v118
    v_lshlrev_b32 v118, 16, v118
    v_rcp_f32 v118, v118
    buffer_load_dwordx4 v5, s[52:55], s78 offen offset:3072 lds
    v_mul_f32 v119, v116, v118
    v_pk_fma_f32 v[120:121], v[96:97], v[118:119], v[118:119] op_sel:[0,0,1] op_sel_hi:[1,0,1] neg_lo:[0,0,1] neg_hi:[0,0,1]
    v_cvt_pk_bf16_f32 v64, v120, v121
    v_pk_fma_f32 v[122:123], v[98:99], v[118:119], v[118:119] op_sel:[0,0,1] op_sel_hi:[1,0,1] neg_lo:[0,0,1] neg_hi:[0,0,1]
    v_cvt_pk_bf16_f32 v65, v122, v123
    s_add_u32 s78, s78, 1658880
    s_mov_b32 m0, 36864
    s_nop 0
    buffer_load_dwordx4 v2, s[52:55], s78 offen lds
    ds_write_b64 v27, v[64:65] offset:0
    v_pk_fma_f32 v[124:125], v[100:101], v[118:119], v[118:119] op_sel:[0,0,1] op_sel_hi:[1,0,1] neg_lo:[0,0,1] neg_hi:[0,0,1]
    v_cvt_pk_bf16_f32 v66, v124, v125
    v_pk_fma_f32 v[126:127], v[102:103], v[118:119], v[118:119] op_sel:[0,0,1] op_sel_hi:[1,0,1] neg_lo:[0,0,1] neg_hi:[0,0,1]
    v_cvt_pk_bf16_f32 v67, v126, v127
    buffer_load_dwordx4 v3, s[52:55], s78 offen offset:1024 lds
    ds_write_b64 v27, v[66:67] offset:256
    v_pk_fma_f32 v[120:121], v[104:105], v[118:119], v[118:119] op_sel:[0,0,1] op_sel_hi:[1,0,1] neg_lo:[0,0,1] neg_hi:[0,0,1]
    v_cvt_pk_bf16_f32 v68, v120, v121
    v_pk_fma_f32 v[122:123], v[106:107], v[118:119], v[118:119] op_sel:[0,0,1] op_sel_hi:[1,0,1] neg_lo:[0,0,1] neg_hi:[0,0,1]
    v_cvt_pk_bf16_f32 v69, v122, v123
    buffer_load_dwordx4 v4, s[52:55], s78 offen offset:2048 lds
    ds_write_b64 v27, v[68:69] offset:512
    v_pk_fma_f32 v[124:125], v[108:109], v[118:119], v[118:119] op_sel:[0,0,1] op_sel_hi:[1,0,1] neg_lo:[0,0,1] neg_hi:[0,0,1]
    v_cvt_pk_bf16_f32 v70, v124, v125
    v_pk_fma_f32 v[126:127], v[110:111], v[118:119], v[118:119] op_sel:[0,0,1] op_sel_hi:[1,0,1] neg_lo:[0,0,1] neg_hi:[0,0,1]
    v_cvt_pk_bf16_f32 v71, v126, v127
    buffer_load_dwordx4 v5, s[52:55], s78 offen offset:3072 lds
    ds_write_b64 v27, v[70:71] offset:768
    v_pk_fma_f32 v[120:121], v[112:113], v[118:119], v[118:119] op_sel:[0,0,1] op_sel_hi:[1,0,1] neg_lo:[0,0,1] neg_hi:[0,0,1]
    v_cvt_pk_bf16_f32 v72, v120, v121
    v_pk_fma_f32 v[122:123], v[114:115], v[118:119], v[118:119] op_sel:[0,0,1] op_sel_hi:[1,0,1] neg_lo:[0,0,1] neg_hi:[0,0,1]
    v_cvt_pk_bf16_f32 v73, v122, v123
    s_add_u32 s78, s78, 1658880
    s_mov_b32 m0, 69632
    s_nop 0
    buffer_load_dwordx4 v2, s[52:55], s78 offen lds
    ds_write_b64 v27, v[72:73] offset:1024
    v_mov_b32 v20, 157296
    s_mov_b32 s84, 0
L_cnt:
    ds_read_b32 v21, v20
    s_waitcnt lgkmcnt(0)
    v_readfirstlane_b32 s14, v21
    s_nop 0
    s_cmp_ge_u32 s14, 3
    s_cbranch_scc1 L_cnt_ok
    s_sleep 1
    s_add_u32 s84, s84, 1
    s_cmp_lt_u32 s84, 0x80000
    s_cbranch_scc1 L_cnt
L_cnt_ok:
    ds_read_b64_tr_b16 v[128:129], v18 offset:0
    ds_read_b64_tr_b16 v[130:131], v18 offset:5376
    ds_read_b64_tr_b16 v[132:133], v18 offset:128
    ds_read_b64_tr_b16 v[134:135], v18 offset:5504
    ds_read_b64_tr_b16 v[136:137], v18 offset:256
    ds_read_b64_tr_b16 v[138:139], v18 offset:5632
    ds_read_b64_tr_b16 v[140:141], v18 offset:384
    ds_read_b64_tr_b16 v[142:143], v18 offset:5760
    ds_read_b64_tr_b16 v[144:145], v18 offset:512
    ds_read_b64_tr_b16 v[146:147], v18 offset:5888
    ds_read_b64_tr_b16 v[148:149], v18 offset:640
    ds_read_b64_tr_b16 v[150:151], v18 offset:6016
    ds_read_b64_tr_b16 v[152:153], v18 offset:768
    ds_read_b64_tr_b16 v[154:155], v18 offset:6144
    ds_read_b64_tr_b16 v[156:157], v18 offset:896
    ds_read_b64_tr_b16 v[158:159], v18 offset:6272
    ds_read_b64_tr_b16 v[160:161], v18 offset:1024
    ds_read_b64_tr_b16 v[162:163], v18 offset:6400
    ds_read_b64_tr_b16 v[164:165], v18 offset:1152
    ds_read_b64_tr_b16 v[166:167], v18 offset:6528
    s_mul_i32 s14, s2, 10240
    s_add_u32 s14, s14, 0x100000
    s_waitcnt lgkmcnt(15)
    buffer_store_dwordx4 v[128:131], v1, s[60:63], s14 offen sc1
    buffer_store_dwordx4 v[132:135], v1, s[60:63], s14 offen offset:1024 sc1
    s_waitcnt lgkmcnt(14)
    buffer_store_dwordx4 v[136:139], v1, s[60:63], s14 offen offset:2048 sc1
    s_waitcnt lgkmcnt(12)
    buffer_store_dwordx4 v[140:143], v1, s[60:63], s14 offen offset:3072 sc1
    s_waitcnt lgkmcnt(10)
    s_add_u32 s14, s14, 4096
    buffer_store_dwordx4 v[144:147], v1, s[60:63], s14 offen sc1
    s_waitcnt lgkmcnt(8)
    buffer_store_dwordx4 v[148:151], v1, s[60:63], s14 offen offset:1024 sc1
    s_waitcnt lgkmcnt(6)
    buffer_store_dwordx4 v[152:155], v1, s[60:63], s14 offen offset:2048 sc1
    s_waitcnt lgkmcnt(4)
    buffer_store_dwordx4 v[156:159], v1, s[60:63], s14 offen offset:3072 sc1
    s_waitcnt lgkmcnt(2)
    s_add_u32 s14, s14, 4096
    buffer_store_dwordx4 v[160:163], v1, s[60:63], s14 offen sc1
    s_waitcnt lgkmcnt(0)
    buffer_store_dwordx4 v[164:167], v1, s[60:63], s14 offen offset:1024 sc1
    s_mul_i32 s14, s90, 327680
    s_lshl_b32 s15, s8, 7
    s_add_u32 s14, s14, s15
    s_add_u32 s14, s14, 0x400000
    s_waitcnt vmcnt(42)
    ds_read_b64_tr_b16 v[168:169], v23 offset:0
    ds_read_b64_tr_b16 v[170:171], v23 offset:640
    ds_read_b64_tr_b16 v[172:173], v23 offset:5120
    ds_read_b64_tr_b16 v[174:175], v23 offset:5760
    ds_read_b64_tr_b16 v[176:177], v23 offset:32
    ds_read_b64_tr_b16 v[178:179], v23 offset:672
    ds_read_b64_tr_b16 v[180:181], v23 offset:5152
    ds_read_b64_tr_b16 v[182:183], v23 offset:5792
    ds_read_b64_tr_b16 v[184:185], v23 offset:64
    ds_read_b64_tr_b16 v[186:187], v23 offset:704
    ds_read_b64_tr_b16 v[188:189], v23 offset:5184
    ds_read_b64_tr_b16 v[190:191], v23 offset:5824
    ds_read_b64_tr_b16 v[192:193], v23 offset:96
    ds_read_b64_tr_b16 v[194:195], v23 offset:736
    ds_read_b64_tr_b16 v[196:197], v23 offset:5216
    ds_read_b64_tr_b16 v[198:199], v23 offset:5856
    ds_read_b64_tr_b16 v[200:201], v23 offset:128
    ds_read_b64_tr_b16 v[202:203], v23 offset:768
    ds_read_b64_tr_b16 v[204:205], v23 offset:5248
    ds_read_b64_tr_b16 v[206:207], v23 offset:5888
    s_waitcnt lgkmcnt(0)
    ds_write_b128 v32, v[168:171] offset:0
    ds_write_b128 v33, v[172:175] offset:0
    ds_write_b128 v32, v[176:179] offset:2048
    ds_write_b128 v33, v[180:183] offset:2048
    ds_write_b128 v32, v[184:187] offset:4096
    ds_write_b128 v33, v[188:191] offset:4096
    ds_write_b128 v32, v[192:195] offset:6144
    ds_write_b128 v33, v[196:199] offset:6144
    ds_write_b128 v32, v[200:203] offset:8192
    ds_write_b128 v33, v[204:207] offset:8192
    ds_read_b128 v[168:171], v34 offset:0
    ds_read_b128 v[172:175], v34 offset:1024
    ds_read_b128 v[176:179], v34 offset:2048
    ds_read_b128 v[180:183], v34 offset:3072
    ds_read_b128 v[184:187], v34 offset:4096
    ds_read_b128 v[188:191], v34 offset:5120
    ds_read_b128 v[192:195], v34 offset:6144
    ds_read_b128 v[196:199], v34 offset:7168
    ds_read_b128 v[200:203], v34 offset:8192
    ds_read_b128 v[204:207], v34 offset:9216
    s_waitcnt lgkmcnt(9)
    buffer_store_dwordx4 v[168:171], v35, s[60:63], s14 offen sc1
    s_add_u32 s14, s14, 0x8000
    s_waitcnt lgkmcnt(8)
    buffer_store_dwordx4 v[172:175], v35, s[60:63], s14 offen sc1
    s_add_u32 s14, s14, 0x8000
    s_waitcnt lgkmcnt(7)
    buffer_store_dwordx4 v[176:179], v35, s[60:63], s14 offen sc1
    s_add_u32 s14, s14, 0x8000
    s_waitcnt lgkmcnt(6)
    buffer_store_dwordx4 v[180:183], v35, s[60:63], s14 offen sc1
    s_add_u32 s14, s14, 0x8000
    s_waitcnt lgkmcnt(5)
    buffer_store_dwordx4 v[184:187], v35, s[60:63], s14 offen sc1
    s_add_u32 s14, s14, 0x8000
    s_waitcnt lgkmcnt(4)
    buffer_store_dwordx4 v[188:191], v35, s[60:63], s14 offen sc1
    s_add_u32 s14, s14, 0x8000
    s_waitcnt lgkmcnt(3)
    buffer_store_dwordx4 v[192:195], v35, s[60:63], s14 offen sc1
    s_add_u32 s14, s14, 0x8000
    s_waitcnt lgkmcnt(2)
    buffer_store_dwordx4 v[196:199], v35, s[60:63], s14 offen sc1
    s_add_u32 s14, s14, 0x8000
    s_waitcnt lgkmcnt(1)
    buffer_store_dwordx4 v[200:203], v35, s[60:63], s14 offen sc1
    s_add_u32 s14, s14, 0x8000
    s_waitcnt lgkmcnt(0)
    buffer_store_dwordx4 v[204:207], v35, s[60:63], s14 offen sc1
    buffer_load_dwordx4 v3, s[52:55], s78 offen offset:1024 lds
    buffer_load_dwordx4 v4, s[52:55], s78 offen offset:2048 lds
    buffer_load_dwordx4 v5, s[52:55], s78 offen offset:3072 lds
    s_cmp_ge_u32 s12, 18
    s_cselect_b32 s78, s75, 0
    s_add_u32 s78, s78, s74
    s_add_u32 s78, s78, 110592
    s_mov_b32 m0, 102400
    s_nop 0
    buffer_load_dwordx4 v2, s[52:55], s78 offen lds
    buffer_load_dwordx4 v3, s[52:55], s78 offen offset:1024 lds
    buffer_load_dwordx4 v4, s[52:55], s78 offen offset:2048 lds
    buffer_load_dwordx4 v5, s[52:55], s78 offen offset:3072 lds
    s_cmp_ge_u32 s98, 13
    s_cselect_b32 s78, s97, 0
    s_add_u32 s78, s78, s96
    s_add_u32 s78, s78, 221184
    s_mov_b32 m0, 8192
    s_nop 0
    buffer_load_dwordx4 v2, s[52:55], s78 offen lds
    buffer_load_dwordx4 v3, s[52:55], s78 offen offset:1024 lds
    buffer_load_dwordx4 v4, s[52:55], s78 offen offset:2048 lds
    buffer_load_dwordx4 v5, s[52:55], s78 offen offset:3072 lds
    s_add_u32 s78, s78, 1658880
    s_mov_b32 m0, 40960
    s_nop 0
    buffer_load_dwordx4 v2, s[52:55], s78 offen lds
    buffer_load_dwordx4 v3, s[52:55], s78 offen offset:1024 lds
    buffer_load_dwordx4 v4, s[52:55], s78 offen offset:2048 lds
    buffer_load_dwordx4 v5, s[52:55], s78 offen offset:3072 lds
    s_add_u32 s78, s78, 1658880
    s_mov_b32 m0, 73728
    s_nop 0
    buffer_load_dwordx4 v2, s[52:55], s78 offen lds
    buffer_load_dwordx4 v3, s[52:55], s78 offen offset:1024 lds
    buffer_load_dwordx4 v4, s[52:55], s78 offen offset:2048 lds
    buffer_load_dwordx4 v5, s[52:55], s78 offen offset:3072 lds
    s_cmp_ge_u32 s12, 17
    s_cselect_b32 s78, s75, 0
    s_add_u32 s78, s78, s74
    s_add_u32 s78, s78, 221184
    s_mov_b32 m0, 106496
    s_nop 0
    buffer_load_dwordx4 v2, s[52:55], s78 offen lds
    s_waitcnt vmcnt(20)
    v_mov_b32 v40, s4
    v_mov_b32 v41, s4
    v_mov_b32 v42, s4
    v_mov_b32 v43, s4
    v_mul_u32_u24 v44, 4096, v0
    s_lshl_b32 s85, s2, 4
    s_add_u32 s85, s85, 0x10000
    s_mov_b64 exec, 0xff
    buffer_store_dwordx4 v[40:43], v44, s[60:63], s85 offen sc1
    s_mov_b64 exec, -1
    s_cmp_eq_u32 s11, 0
    s_cbranch_scc1 L_skip1w
    buffer_load_dwordx4 v3, s[52:55], s78 offen offset:1024 lds
    buffer_load_dwordx4 v4, s[52:55], s78 offen offset:2048 lds
    buffer_load_dwordx4 v5, s[52:55], s78 offen offset:3072 lds
    s_cmp_ge_u32 s98, 12
    s_cselect_b32 s78, s97, 0
    s_add_u32 s78, s78, s96
    s_add_u32 s78, s78, 331776
    s_mov_b32 m0, 12288
    s_nop 0
    buffer_load_dwordx4 v2, s[52:55], s78 offen lds
    buffer_load_dwordx4 v3, s[52:55], s78 offen offset:1024 lds
    buffer_load_dwordx4 v4, s[52:55], s78 offen offset:2048 lds
    buffer_load_dwordx4 v5, s[52:55], s78 offen offset:3072 lds
    s_add_u32 s78, s78, 1658880
    s_mov_b32 m0, 45056
    s_nop 0
    buffer_load_dwordx4 v2, s[52:55], s78 offen lds
    buffer_load_dwordx4 v3, s[52:55], s78 offen offset:1024 lds
    buffer_load_dwordx4 v4, s[52:55], s78 offen offset:2048 lds
    buffer_load_dwordx4 v5, s[52:55], s78 offen offset:3072 lds
    s_add_u32 s78, s78, 1658880
    s_mov_b32 m0, 77824
    s_nop 0
    buffer_load_dwordx4 v2, s[52:55], s78 offen lds
    buffer_load_dwordx4 v3, s[52:55], s78 offen offset:1024 lds
    buffer_load_dwordx4 v4, s[52:55], s78 offen offset:2048 lds
    buffer_load_dwordx4 v5, s[52:55], s78 offen offset:3072 lds
    s_cmp_ge_u32 s12, 16
    s_cselect_b32 s78, s75, 0
    s_add_u32 s78, s78, s74
    s_add_u32 s78, s78, 331776
    s_mov_b32 m0, 110592
    s_nop 0
    buffer_load_dwordx4 v2, s[52:55], s78 offen lds
    buffer_load_dwordx4 v3, s[52:55], s78 offen offset:1024 lds
    buffer_load_dwordx4 v4, s[52:55], s78 offen offset:2048 lds
    buffer_load_dwordx4 v5, s[52:55], s78 offen offset:3072 lds
    s_cmp_ge_u32 s98, 11
    s_cselect_b32 s78, s97, 0
    s_add_u32 s78, s78, s96
    s_add_u32 s78, s78, 442368
    s_mov_b32 m0, 16384
    s_nop 0
    buffer_load_dwordx4 v2, s[52:55], s78 offen lds
    buffer_load_dwordx4 v3, s[52:55], s78 offen offset:1024 lds
    buffer_load_dwordx4 v4, s[52:55], s78 offen offset:2048 lds
    buffer_load_dwordx4 v5, s[52:55], s78 offen offset:3072 lds
    s_add_u32 s78, s78, 1658880
    s_mov_b32 m0, 49152
    s_nop 0
    buffer_load_dwordx4 v2, s[52:55], s78 offen lds
    buffer_load_dwordx4 v3, s[52:55], s78 offen offset:1024 lds
    buffer_load_dwordx4 v4, s[52:55], s78 offen offset:2048 lds
    buffer_load_dwordx4 v5, s[52:55], s78 offen offset:3072 lds
    s_add_u32 s78, s78, 1658880
    s_mov_b32 m0, 81920
    s_nop 0
    buffer_load_dwordx4 v2, s[52:55], s78 offen lds
    buffer_load_dwordx4 v3, s[52:55], s78 offen offset:1024 lds
    buffer_load_dwordx4 v4, s[52:55], s78 offen offset:2048 lds
    buffer_load_dwordx4 v5, s[52:55], s78 offen offset:3072 lds
    s_cmp_ge_u32 s12, 15
    s_cselect_b32 s78, s75, 0
    s_add_u32 s78, s78, s74
    s_add_u32 s78, s78, 442368
    s_mov_b32 m0, 114688
    s_nop 0
    buffer_load_dwordx4 v2, s[52:55], s78 offen lds
    buffer_load_dwordx4 v3, s[52:55], s78 offen offset:1024 lds
    buffer_load_dwordx4 v4, s[52:55], s78 offen offset:2048 lds
    buffer_load_dwordx4 v5, s[52:55], s78 offen offset:3072 lds
    s_cmp_ge_u32 s98, 10
    s_cselect_b32 s78, s97, 0
    s_add_u32 s78, s78, s96
    s_add_u32 s78, s78, 552960
    s_mov_b32 m0, 20480
    s_nop 0
    buffer_load_dwordx4 v2, s[52:55], s78 offen lds
    buffer_load_dwordx4 v3, s[52:55], s78 offen offset:1024 lds
    buffer_load_dwordx4 v4, s[52:55], s78 offen offset:2048 lds
    buffer_load_dwordx4 v5, s[52:55], s78 offen offset:3072 lds
    s_add_u32 s78, s78, 1658880
    s_mov_b32 m0, 53248
    s_nop 0
    buffer_load_dwordx4 v2, s[52:55], s78 offen lds
    buffer_load_dwordx4 v3, s[52:55], s78 offen offset:1024 lds
    buffer_load_dwordx4 v4, s[52:55], s78 offen offset:2048 lds
    buffer_load_dwordx4 v5, s[52:55], s78 offen offset:3072 lds
    s_cmp_ge_u32 s98, 9
    s_cselect_b32 s78, s97, 0
    s_add_u32 s78, s78, s96
    s_add_u32 s78, s78, 663552
    s_mov_b32 m0, 24576
    s_nop 0
    buffer_load_dwordx4 v2, s[52:55], s78 offen lds
    buffer_load_dwordx4 v3, s[52:55], s78 offen offset:1024 lds
    buffer_load_dwordx4 v4, s[52:55], s78 offen offset:2048 lds
    buffer_load_dwordx4 v5, s[52:55], s78 offen offset:3072 lds
    s_add_u32 s78, s78, 1658880
    s_mov_b32 m0, 57344
    s_nop 0
    buffer_load_dwordx4 v2, s[52:55], s78 offen lds
    buffer_load_dwordx4 v3, s[52:55], s78 offen offset:1024 lds
    buffer_load_dwordx4 v4, s[52:55], s78 offen offset:2048 lds
    buffer_load_dwordx4 v5, s[52:55], s78 offen offset:3072 lds
    s_cmp_ge_u32 s98, 8
    s_cselect_b32 s78, s97, 0
    s_add_u32 s78, s78, s96
    s_add_u32 s78, s78, 774144
    s_mov_b32 m0, 28672
    s_nop 0
    buffer_load_dwordx4 v2, s[52:55], s78 offen lds
    buffer_load_dwordx4 v3, s[52:55], s78 offen offset:1024 lds
    buffer_load_dwordx4 v4, s[52:55], s78 offen offset:2048 lds
    buffer_load_dwordx4 v5, s[52:55], s78 offen offset:3072 lds
    s_add_u32 s78, s78, 1658880
    s_mov_b32 m0, 61440
    s_nop 0
    buffer_load_dwordx4 v2, s[52:55], s78 offen lds
    buffer_load_dwordx4 v3, s[52:55], s78 offen offset:1024 lds
    buffer_load_dwordx4 v4, s[52:55], s78 offen offset:2048 lds
    buffer_load_dwordx4 v5, s[52:55], s78 offen offset:3072 lds
    s_cmp_ge_u32 s98, 10
    s_cselect_b32 s78, s97, 0
    s_add_u32 s78, s78, s96
    s_add_u32 s78, s78, 3870720
    s_mov_b32 m0, 86016
    s_nop 0
    buffer_load_dwordx4 v2, s[52:55], s78 offen lds
    buffer_load_dwordx4 v3, s[52:55], s78 offen offset:1024 lds
    buffer_load_dwordx4 v4, s[52:55], s78 offen offset:2048 lds
    buffer_load_dwordx4 v5, s[52:55], s78 offen offset:3072 lds
    s_cmp_ge_u32 s12, 14
    s_cselect_b32 s78, s75, 0
    s_add_u32 s78, s78, s74
    s_add_u32 s78, s78, 552960
    s_mov_b32 m0, 118784
    s_nop 0
    buffer_load_dwordx4 v2, s[52:55], s78 offen lds
    buffer_load_dwordx4 v3, s[52:55], s78 offen offset:1024 lds
    buffer_load_dwordx4 v4, s[52:55], s78 offen offset:2048 lds
    buffer_load_dwordx4 v5, s[52:55], s78 offen offset:3072 lds
    v_add_u32 v40, 1024, v1
    v_add_u32 v41, 2048, v1
    v_add_u32 v42, 3072, v1
    s_lshl_b32 s80, s5, 12
    s_add_u32 s80, s80, 0x10000
    buffer_load_dword v36, v1, s[60:63], s80 offen sc1
    buffer_load_dword v37, v40, s[60:63], s80 offen sc1
    buffer_load_dword v38, v41, s[60:63], s80 offen sc1
    buffer_load_dword v39, v42, s[60:63], s80 offen sc1
    s_cmp_ge_u32 s98, 9
    s_cselect_b32 s78, s97, 0
    s_add_u32 s78, s78, s96
    s_add_u32 s78, s78, 3981312
    s_mov_b32 m0, 90112
    s_nop 0
    buffer_load_dwordx4 v2, s[52:55], s78 offen lds
    buffer_load_dwordx4 v3, s[52:55], s78 offen offset:1024 lds
    buffer_load_dwordx4 v4, s[52:55], s78 offen offset:2048 lds
    buffer_load_dwordx4 v5, s[52:55], s78 offen offset:3072 lds
    s_cmp_ge_u32 s12, 13
    s_cselect_b32 s78, s75, 0
    s_add_u32 s78, s78, s74
    s_add_u32 s78, s78, 663552
    s_mov_b32 m0, 122880
    s_nop 0
    buffer_load_dwordx4 v2, s[52:55], s78 offen lds
    buffer_load_dwordx4 v3, s[52:55], s78 offen offset:1024 lds
    buffer_load_dwordx4 v4, s[52:55], s78 offen offset:2048 lds
    buffer_load_dwordx4 v5, s[52:55], s78 offen offset:3072 lds
    s_cmp_ge_u32 s98, 8
    s_cselect_b32 s78, s97, 0
    s_add_u32 s78, s78, s96
    s_add_u32 s78, s78, 4091904
    s_mov_b32 m0, 94208
    s_nop 0
    buffer_load_dwordx4 v2, s[52:55], s78 offen lds
    buffer_load_dwordx4 v3, s[52:55], s78 offen offset:1024 lds
    buffer_load_dwordx4 v4, s[52:55], s78 offen offset:2048 lds
    buffer_load_dwordx4 v5, s[52:55], s78 offen offset:3072 lds
    s_cmp_ge_u32 s12, 12
    s_cselect_b32 s78, s75, 0
    s_add_u32 s78, s78, s74
    s_add_u32 s78, s78, 774144
    s_mov_b32 m0, 126976
    s_nop 0
    buffer_load_dwordx4 v2, s[52:55], s78 offen lds
    buffer_load_dwordx4 v3, s[52:55], s78 offen offset:1024 lds
    buffer_load_dwordx4 v4, s[52:55], s78 offen offset:2048 lds
    buffer_load_dwordx4 v5, s[52:55], s78 offen offset:3072 lds
    s_cmp_ge_u32 s12, 11
    s_cselect_b32 s78, s75, 0
    s_add_u32 s78, s78, s74
    s_add_u32 s78, s78, 884736
    buffer_load_dwordx4 a[40:43], v2, s[52:55], s78 offen
    buffer_load_dwordx4 a[44:47], v3, s[52:55], s78 offen offset:1024
    buffer_load_dwordx4 a[48:51], v4, s[52:55], s78 offen offset:2048
    buffer_load_dwordx4 a[52:55], v5, s[52:55], s78 offen offset:3072
    s_cmp_ge_u32 s12, 10
    s_cselect_b32 s78, s75, 0
    s_add_u32 s78, s78, s74
    s_add_u32 s78, s78, 995328
    buffer_load_dwordx4 a[56:59], v2, s[52:55], s78 offen
    buffer_load_dwordx4 a[60:63], v3, s[52:55], s78 offen offset:1024
    buffer_load_dwordx4 a[64:67], v4, s[52:55], s78 offen offset:2048
    buffer_load_dwordx4 a[68:71], v5, s[52:55], s78 offen offset:3072
    s_waitcnt vmcnt(24)
    v_xor_b32 v36, s4, v36
    v_xor_b32 v37, s4, v37
    v_xor_b32 v38, s4, v38
    v_xor_b32 v39, s4, v39
    v_or3_b32 v36, v36, v37, v38
    v_or_b32 v36, v36, v39
    v_cmp_ne_u32 vcc, 0, v36
    s_cbranch_vccz L_p1ok
    s_sleep 8
    s_mov_b32 s84, 0
Lpoll_3:
    buffer_load_dword v36, v1, s[60:63], s80 offen sc1
    buffer_load_dword v37, v40, s[60:63], s80 offen sc1
    buffer_load_dword v38, v41, s[60:63], s80 offen sc1
    buffer_load_dword v39, v42, s[60:63], s80 offen sc1
    s_waitcnt vmcnt(0)
    v_xor_b32 v37, s4, v37
    v_xor_b32 v38, s4, v38
    v_xor_b32 v39, s4, v39
    v_xor_b32 v36, s4, v36
    v_or_b32 v36, v36, v37
    v_or_b32 v36, v36, v38
    v_or_b32 v36, v36, v39
    v_cmp_ne_u32 vcc, 0, v36
    s_cbranch_vccz Lpolled_4
    s_sleep 8
    s_add_u32 s84, s84, 1
    s_cmp_lt_u32 s84, 0x4000
    s_cbranch_scc1 Lpoll_3
Lpolled_4:
L_p1ok:
    v_mov_b32 v20, 157308
    v_mov_b32 v21, 1
    s_mov_b64 exec, 1
    ds_add_u32 v20, v21
    s_mov_b64 exec, -1
L_join1:
    s_nop 1
    s_add_u32 s79, s76, 0
    buffer_load_dwordx4 a[0:3], v10, s[60:63], s79 offen sc1
    buffer_load_dwordx4 a[4:7], v10, s[60:63], s79 offen offset:256 sc1
    buffer_load_dwordx4 a[8:11], v10, s[60:63], s79 offen offset:512 sc1
    buffer_load_dwordx4 a[12:15], v10, s[60:63], s79 offen offset:768 sc1
    buffer_load_dwordx4 a[16:19], v10, s[60:63], s79 offen offset:1024 sc1
    s_add_u32 s79, s76, 40960
    s_add_u32 s85, s12, 1
    s_mul_i32 s85, s85, 40960
    s_add_u32 s85, s85, s77
    s_cmp_eq_u32 s85, 0
    s_cselect_b32 s85, s77, 0
    s_add_u32 s79, s79, s85
    buffer_load_dwordx4 a[20:23], v10, s[60:63], s79 offen sc1
    buffer_load_dwordx4 a[24:27], v10, s[60:63], s79 offen offset:256 sc1
    buffer_load_dwordx4 a[28:31], v10, s[60:63], s79 offen offset:512 sc1
    buffer_load_dwordx4 a[32:35], v10, s[60:63], s79 offen offset:768 sc1
    buffer_load_dwordx4 a[36:39], v10, s[60:63], s79 offen offset:1024 sc1
    v_mov_b32 v116, 0
    v_mov_b32 v117, 0x3f803f80
    v_lshlrev_b32 v120, 16, v208
    v_and_b32 v121, s83, v208
    v_pk_mul_f32 v[120:121], v[120:121], v[96:97]
    v_cvt_pk_bf16_f32 v122, v120, v121
    v_dot2c_f32_bf16 v116, v122, v117
    v_lshlrev_b32 v124, 16, v209
    v_and_b32 v125, s83, v209
    v_pk_mul_f32 v[124:125], v[124:125], v[98:99]
    v_cvt_pk_bf16_f32 v126, v124, v125
    v_dot2c_f32_bf16 v116, v126, v117
    v_lshlrev_b32 v120, 16, v210
    v_and_b32 v121, s83, v210
    v_pk_mul_f32 v[120:121], v[120:121], v[100:101]
    v_cvt_pk_bf16_f32 v122, v120, v121
    v_dot2c_f32_bf16 v116, v122, v117
    v_lshlrev_b32 v124, 16, v211
    v_and_b32 v125, s83, v211
    v_pk_mul_f32 v[124:125], v[124:125], v[102:103]
    v_cvt_pk_bf16_f32 v126, v124, v125
    v_dot2c_f32_bf16 v116, v126, v117
    v_lshlrev_b32 v120, 16, v212
    v_and_b32 v121, s83, v212
    v_pk_mul_f32 v[120:121], v[120:121], v[104:105]
    v_cvt_pk_bf16_f32 v122, v120, v121
    v_dot2c_f32_bf16 v116, v122, v117
    v_lshlrev_b32 v124, 16, v213
    v_and_b32 v125, s83, v213
    v_pk_mul_f32 v[124:125], v[124:125], v[106:107]
    v_cvt_pk_bf16_f32 v126, v124, v125
    v_dot2c_f32_bf16 v116, v126, v117
    v_lshlrev_b32 v120, 16, v214
    v_and_b32 v121, s83, v214
    v_pk_mul_f32 v[120:121], v[120:121], v[108:109]
    v_cvt_pk_bf16_f32 v122, v120, v121
    v_dot2c_f32_bf16 v116, v122, v117
    v_lshlrev_b32 v124, 16, v215
    v_and_b32 v125, s83, v215
    v_pk_mul_f32 v[124:125], v[124:125], v[110:111]
    v_cvt_pk_bf16_f32 v126, v124, v125
    v_dot2c_f32_bf16 v116, v126, v117
    v_lshlrev_b32 v120, 16, v216
    v_and_b32 v121, s83, v216
    v_pk_mul_f32 v[120:121], v[120:121], v[112:113]
    v_cvt_pk_bf16_f32 v122, v120, v121
    v_dot2c_f32_bf16 v116, v122, v117
    v_lshlrev_b32 v124, 16, v217
    v_and_b32 v125, s83, v217
    v_pk_mul_f32 v[124:125], v[124:125], v[114:115]
    v_cvt_pk_bf16_f32 v126, v124, v125
    v_dot2c_f32_bf16 v116, v126, v117
    s_nop 2
    v_add_f32_dpp v116, v116, v116 row_ror:8 row_mask:0xf bank_mask:0xf
    s_nop 1
    v_add_f32_dpp v116, v116, v116 row_ror:4 row_mask:0xf bank_mask:0xf
    s_nop 1
    v_add_f32_dpp v116, v116, v116 row_ror:2 row_mask:0xf bank_mask:0xf
    s_nop 1
    v_add_f32_dpp v116, v116, v116 row_ror:1 row_mask:0xf bank_mask:0xf
    v_mov_b32 v117, v116
    s_nop 1
    v_permlane16_swap_b32 v116, v117
    v_add_f32 v116, v116, v117
    v_cvt_pk_bf16_f32 v116, v116, v116
    v_lshlrev_b32 v116, 16, v116
    v_mul_f32 v116, 0xbfb8aa3b, v116
    v_exp_f32 v116, v116
    s_nop 0
    v_add_f32 v116, 1.0, v116
    v_rcp_f32 v116, v116
    s_nop 0
    v_cvt_pk_bf16_f32 v116, v116, v116
    v_lshlrev_b32 v26, 1, v26
    v_add_u32 v26, 157280, v26
    s_mov_b32 exec_lo, 1
    s_mov_b32 exec_hi, 1
    ds_write_b16 v26, v116
    s_mov_b64 exec, -1
    v_lshlrev_b32 v24, 16, v28
    v_and_b32 v25, s83, v28
    v_lshlrev_b32 v26, 16, v29
    v_and_b32 v27, s83, v29
    s_mov_b32 s100, 0xbdd2d3e8
    s_mov_b32 s101, 0xc0135761
    v_lshrrev_b32 v28, 5, v0
    s_lshl_b32 s14, s3, 1
    v_add_u32 v28, s14, v28
    v_mul_u32_u24 v28, 10240, v28
    v_and_b32 v23, 31, v0
    v_lshl_add_u32 v28, v23, 4, v28
    s_cmp_lg_u32 s3, 3
    s_cbranch_scc1 L_j1a
    s_waitcnt vmcnt(10)
    v_mov_b32 v20, 157324
    v_mov_b32 v21, 1
    s_mov_b64 exec, 1
    ds_add_u32 v20, v21
    s_mov_b64 exec, -1
    s_branch L_j1b
L_j1a:
    s_waitcnt vmcnt(10)
    v_mov_b32 v20, 157324
    s_mov_b32 s84, 0
L_cntJ:
    ds_read_b32 v21, v20
    s_waitcnt lgkmcnt(0)
    v_readfirstlane_b32 s14, v21
    s_nop 0
    s_cmp_ge_u32 s14, 1
    s_cbranch_scc1 L_cntJ_ok
    s_sleep 1
    s_add_u32 s84, s84, 1
    s_cmp_lt_u32 s84, 0x80000
    s_cbranch_scc1 L_cntJ
L_cntJ_ok:
L_j1b:
    s_cmp_eq_u32 s10, 0
    s_cbranch_scc1 L_loop1b
    s_lshl_b32 s14, s9, 12
    s_add_u32 s14, s14, 0x400000
    buffer_load_dwordx4 v[48:51], v1, s[60:63], s14 offen sc1
    buffer_load_dwordx4 v[52:55], v1, s[60:63], s14 offen offset:1024 sc1
    buffer_load_dwordx4 v[56:59], v1, s[60:63], s14 offen offset:2048 sc1
    buffer_load_dwordx4 v[60:63], v1, s[60:63], s14 offen offset:3072 sc1
    ds_read_b64_tr_b16 v[96:97], v6 offset:0
    ds_read_b64_tr_b16 v[98:99], v6 offset:512
    ds_read_b64_tr_b16 v[100:101], v7 offset:0
    ds_read_b64_tr_b16 v[102:103], v7 offset:512
    ds_read_b64_tr_b16 v[104:105], v8 offset:0
    ds_read_b64_tr_b16 v[106:107], v8 offset:512
    ds_read_b64_tr_b16 v[108:109], v9 offset:0
    ds_read_b64_tr_b16 v[110:111], v9 offset:512
    s_waitcnt lgkmcnt(0)
    s_waitcnt vmcnt(13)
    v_mfma_f32_16x16x32_bf16 a[80:83], v[96:99], a[0:3], 0
    s_cmp_ge_u32 s12, 13
    s_cselect_b32 s79, s77, 0
    v_mfma_f32_16x16x32_bf16 a[100:103], v[100:103], a[0:3], 0
    s_add_u32 s79, s79, s76
    s_add_u32 s79, s79, 81920
    v_mfma_f32_16x16x32_bf16 a[120:123], v[104:107], a[0:3], 0
    ds_read_b64_tr_b16 v[112:113], v6 offset:4096
    ds_read_b64_tr_b16 v[114:115], v6 offset:4608
    v_mfma_f32_16x16x32_bf16 a[140:143], v[108:111], a[0:3], 0
    buffer_load_dwordx4 a[0:3], v10, s[60:63], s79 offen sc1
    s_waitcnt vmcnt(13)
    v_mfma_f32_16x16x32_bf16 a[84:87], v[96:99], a[4:7], 0
    ds_read_b64_tr_b16 v[116:117], v7 offset:4096
    ds_read_b64_tr_b16 v[118:119], v7 offset:4608
    v_mfma_f32_16x16x32_bf16 a[104:107], v[100:103], a[4:7], 0
    ds_read_b64_tr_b16 v[120:121], v8 offset:4096
    ds_read_b64_tr_b16 v[122:123], v8 offset:4608
    v_mfma_f32_16x16x32_bf16 a[124:127], v[104:107], a[4:7], 0
    v_mfma_f32_16x16x32_bf16 a[144:147], v[108:111], a[4:7], 0
    buffer_load_dwordx4 a[4:7], v10, s[60:63], s79 offen offset:256 sc1
    s_waitcnt vmcnt(13)
    v_mfma_f32_16x16x32_bf16 a[88:91], v[96:99], a[8:11], 0
    ds_read_b64_tr_b16 v[124:125], v9 offset:4096
    ds_read_b64_tr_b16 v[126:127], v9 offset:4608
    v_mfma_f32_16x16x32_bf16 a[108:111], v[100:103], a[8:11], 0
    ds_write_b128 v11, a[40:43] offset:0
    ds_write_b128 v11, a[44:47] offset:1024
    v_mfma_f32_16x16x32_bf16 a[128:131], v[104:107], a[8:11], 0
    v_mfma_f32_16x16x32_bf16 a[148:151], v[108:111], a[8:11], 0
    buffer_load_dwordx4 a[8:11], v10, s[60:63], s79 offen offset:512 sc1
    s_waitcnt vmcnt(13)
    v_mfma_f32_16x16x32_bf16 a[92:95], v[96:99], a[12:15], 0
    ds_write_b128 v11, a[48:51] offset:2048
    v_mfma_f32_16x16x32_bf16 a[112:115], v[100:103], a[12:15], 0
    v_mfma_f32_16x16x32_bf16 a[132:135], v[104:107], a[12:15], 0
    v_mfma_f32_16x16x32_bf16 a[152:155], v[108:111], a[12:15], 0
    buffer_load_dwordx4 a[12:15], v10, s[60:63], s79 offen offset:768 sc1
    s_waitcnt vmcnt(13)
    v_mfma_f32_16x16x32_bf16 a[96:99], v[96:99], a[16:19], 0
    ds_write_b128 v11, a[52:55] offset:3072
    v_mfma_f32_16x16x32_bf16 a[116:119], v[100:103], a[16:19], 0
    v_mfma_f32_16x16x32_bf16 a[136:139], v[104:107], a[16:19], 0
    v_mfma_f32_16x16x32_bf16 a[156:159], v[108:111], a[16:19], 0
    buffer_load_dwordx4 a[16:19], v10, s[60:63], s79 offen offset:1024 sc1
    s_waitcnt lgkmcnt(4)
    s_waitcnt vmcnt(13)
    v_mfma_f32_16x16x32_bf16 a[80:83], v[112:115], a[20:23], a[80:83]
    s_cmp_ge_u32 s12, 12
    s_cselect_b32 s79, s77, 0
    v_mfma_f32_16x16x32_bf16 a[100:103], v[116:119], a[20:23], a[100:103]
    s_add_u32 s79, s79, s76
    s_add_u32 s79, s79, 122880
    v_mfma_f32_16x16x32_bf16 a[120:123], v[120:123], a[20:23], a[120:123]
    ds_read_b64_tr_b16 v[96:97], v6 offset:8192
    ds_read_b64_tr_b16 v[98:99], v6 offset:8704
    v_mfma_f32_16x16x32_bf16 a[140:143], v[124:127], a[20:23], a[140:143]
    buffer_load_dwordx4 a[20:23], v10, s[60:63], s79 offen sc1
    s_waitcnt vmcnt(13)
    v_mfma_f32_16x16x32_bf16 a[84:87], v[112:115], a[24:27], a[84:87]
    ds_read_b64_tr_b16 v[100:101], v7 offset:8192
    ds_read_b64_tr_b16 v[102:103], v7 offset:8704
    v_mfma_f32_16x16x32_bf16 a[104:107], v[116:119], a[24:27], a[104:107]
    ds_read_b64_tr_b16 v[104:105], v8 offset:8192
    ds_read_b64_tr_b16 v[106:107], v8 offset:8704
    v_mfma_f32_16x16x32_bf16 a[124:127], v[120:123], a[24:27], a[124:127]
    v_mfma_f32_16x16x32_bf16 a[144:147], v[124:127], a[24:27], a[144:147]
    buffer_load_dwordx4 a[24:27], v10, s[60:63], s79 offen offset:256 sc1
    s_waitcnt vmcnt(7)
    v_mfma_f32_16x16x32_bf16 a[88:91], v[112:115], a[28:31], a[88:91]
    ds_write_b128 v18, v[48:51] offset:4640
    ds_write_b128 v18, v[52:55] offset:5664
    v_mfma_f32_16x16x32_bf16 a[108:111], v[116:119], a[28:31], a[108:111]
    ds_write_b128 v18, v[56:59] offset:6688
    ds_write_b128 v18, v[60:63] offset:7712
    v_mfma_f32_16x16x32_bf16 a[128:131], v[120:123], a[28:31], a[128:131]
    ds_read_b64_tr_b16 v[108:109], v9 offset:8192
    ds_read_b64_tr_b16 v[110:111], v9 offset:8704
    v_mfma_f32_16x16x32_bf16 a[148:151], v[124:127], a[28:31], a[148:151]
    buffer_load_dwordx4 a[28:31], v10, s[60:63], s79 offen offset:512 sc1
    v_mfma_f32_16x16x32_bf16 a[92:95], v[112:115], a[32:35], a[92:95]
    ds_write_b128 v11, a[56:59] offset:4096
    ds_write_b128 v11, a[60:63] offset:5120
    v_mfma_f32_16x16x32_bf16 a[112:115], v[116:119], a[32:35], a[112:115]
    ds_read_b64_tr_b16 a[164:165], v16 offset:256
    ds_read_b64_tr_b16 a[166:167], v16 offset:288
    v_mfma_f32_16x16x32_bf16 a[132:135], v[120:123], a[32:35], a[132:135]
    ds_read_b64_tr_b16 a[172:173], v16 offset:768
    ds_read_b64_tr_b16 a[174:175], v16 offset:800
    v_mfma_f32_16x16x32_bf16 a[152:155], v[124:127], a[32:35], a[152:155]
    buffer_load_dwordx4 a[32:35], v10, s[60:63], s79 offen offset:768 sc1
    v_mfma_f32_16x16x32_bf16 a[96:99], v[112:115], a[36:39], a[96:99]
    ds_write_b128 v11, a[64:67] offset:6144
    ds_read2_b64 v[64:67], v17 offset0:120 offset1:121
    v_mfma_f32_16x16x32_bf16 a[116:119], v[116:119], a[36:39], a[116:119]
    ds_read2_b64 v[68:71], v32 offset0:120 offset1:121
    ds_read2_b64 v[72:75], v33 offset0:120 offset1:121
    v_mfma_f32_16x16x32_bf16 a[136:139], v[120:123], a[36:39], a[136:139]
    ds_read2_b64 v[76:79], v34 offset0:120 offset1:121
    ds_read_b64_tr_b16 a[180:181], v16 offset:1280
    v_mfma_f32_16x16x32_bf16 a[156:159], v[124:127], a[36:39], a[156:159]
    buffer_load_dwordx4 a[36:39], v10, s[60:63], s79 offen offset:1024 sc1
    s_waitcnt lgkmcnt(12)
    s_waitcnt vmcnt(9)
    v_mfma_f32_16x16x32_bf16 a[80:83], v[96:99], a[0:3], a[80:83]
    ds_read_b64_tr_b16 a[182:183], v16 offset:1312
    ds_read_b64_tr_b16 a[188:189], v16 offset:1792
    v_mfma_f32_16x16x32_bf16 a[100:103], v[100:103], a[0:3], a[100:103]
    ds_read_b64_tr_b16 a[190:191], v16 offset:1824
    ds_write_b128 v11, a[68:71] offset:7168
    v_mfma_f32_16x16x32_bf16 a[120:123], v[104:107], a[0:3], a[120:123]
    ds_read_b64_tr_b16 a[196:197], v16 offset:2304
    ds_read_b64_tr_b16 a[198:199], v16 offset:2336
    v_mfma_f32_16x16x32_bf16 a[140:143], v[108:111], a[0:3], a[140:143]
    ds_read_b64_tr_b16 a[204:205], v16 offset:2816
    ds_read_b64_tr_b16 a[206:207], v16 offset:2848
    s_waitcnt vmcnt(8)
    v_mfma_f32_16x16x32_bf16 a[84:87], v[96:99], a[4:7], a[84:87]
    ds_read_b64_tr_b16 a[212:213], v16 offset:3328
    ds_read_b64_tr_b16 a[214:215], v16 offset:3360
    v_mfma_f32_16x16x32_bf16 a[104:107], v[100:103], a[4:7], a[104:107]
    ds_read_b64_tr_b16 a[220:221], v16 offset:3840
    ds_read_b64_tr_b16 a[222:223], v16 offset:3872
    v_mfma_f32_16x16x32_bf16 a[124:127], v[104:107], a[4:7], a[124:127]
    s_add_u32 s79, s79, 40960
    s_cmp_ge_u32 s12, 5
    v_mfma_f32_16x16x32_bf16 a[144:147], v[108:111], a[4:7], a[144:147]
    s_cselect_b32 s78, s75, 0
    s_add_u32 s78, s78, s74
    s_waitcnt lgkmcnt(13)
    v_mfma_f32_16x16x32_bf16 v[128:131], a[164:167], v[64:67], 0
    s_add_u32 s78, s78, 1105920
    s_add_u32 m0, s72, 8192
    v_mfma_f32_16x16x32_bf16 v[132:135], a[164:167], v[68:71], 0
    buffer_load_dwordx4 a[4:7], v10, s[60:63], s79 offen offset:256 sc1
    v_mfma_f32_16x16x32_bf16 v[136:139], a[164:167], v[72:75], 0
    buffer_load_dwordx4 a[0:3], v10, s[60:63], s79 offen sc1
    v_mfma_f32_16x16x32_bf16 v[140:143], a[164:167], v[76:79], 0
    ds_read_b64_tr_b16 v[112:113], v6 offset:12288
    s_waitcnt vmcnt(9)
    v_mfma_f32_16x16x32_bf16 a[88:91], v[96:99], a[8:11], a[88:91]
    buffer_load_dwordx4 v2, s[52:55], s78 offen lds
    v_mfma_f32_16x16x32_bf16 a[108:111], v[100:103], a[8:11], a[108:111]
    ds_read_b64_tr_b16 v[114:115], v6 offset:12800
    ds_read_b64_tr_b16 v[116:117], v7 offset:12288
    v_mfma_f32_16x16x32_bf16 a[128:131], v[104:107], a[8:11], a[128:131]
    ds_read_b64_tr_b16 a[160:161], v16 offset:0
    ds_read_b64_tr_b16 a[162:163], v16 offset:32
    v_mfma_f32_16x16x32_bf16 a[148:151], v[108:111], a[8:11], a[148:151]
    buffer_load_dwordx4 a[8:11], v10, s[60:63], s79 offen offset:512 sc1
    v_mfma_f32_16x16x32_bf16 v[144:147], a[172:175], v[64:67], 0
    ds_read_b64_tr_b16 a[168:169], v16 offset:512
    ds_read_b64_tr_b16 a[170:171], v16 offset:544
    v_mfma_f32_16x16x32_bf16 v[148:151], a[172:175], v[68:71], 0
    ds_read_b64_tr_b16 a[176:177], v16 offset:1024
    ds_read_b64_tr_b16 a[178:179], v16 offset:1056
    v_mfma_f32_16x16x32_bf16 v[152:155], a[172:175], v[72:75], 0
    ds_read_b64_tr_b16 a[184:185], v16 offset:1536
    ds_read_b64_tr_b16 a[186:187], v16 offset:1568
    v_mfma_f32_16x16x32_bf16 v[156:159], a[172:175], v[76:79], 0
    ds_read_b64_tr_b16 v[118:119], v7 offset:12800
    s_waitcnt vmcnt(10)
    v_mfma_f32_16x16x32_bf16 a[92:95], v[96:99], a[12:15], a[92:95]
    buffer_load_dwordx4 v3, s[52:55], s78 offen offset:1024 lds
    v_mfma_f32_16x16x32_bf16 a[112:115], v[100:103], a[12:15], a[112:115]
    ds_read2_b64 v[80:83], v17 offset0:112 offset1:113
    ds_read2_b64 v[84:87], v32 offset0:112 offset1:113
    v_mfma_f32_16x16x32_bf16 a[132:135], v[104:107], a[12:15], a[132:135]
    ds_read2_b64 v[88:91], v33 offset0:112 offset1:113
    ds_read2_b64 v[92:95], v34 offset0:112 offset1:113
    v_mfma_f32_16x16x32_bf16 a[152:155], v[108:111], a[12:15], a[152:155]
    buffer_load_dwordx4 a[12:15], v10, s[60:63], s79 offen offset:768 sc1
    s_waitcnt lgkmcnt(15)
    v_mfma_f32_16x16x32_bf16 v[160:163], a[180:183], v[64:67], 0
    ds_read_b64_tr_b16 v[120:121], v8 offset:12288
    ds_read_b64_tr_b16 v[122:123], v8 offset:12800
    v_mfma_f32_16x16x32_bf16 v[164:167], a[180:183], v[68:71], 0
    ds_read_b64_tr_b16 a[192:193], v16 offset:2048
    ds_read_b64_tr_b16 a[194:195], v16 offset:2080
    v_mfma_f32_16x16x32_bf16 v[168:171], a[180:183], v[72:75], 0
    ds_read_b64_tr_b16 a[200:201], v16 offset:2560
    ds_read_b64_tr_b16 a[202:203], v16 offset:2592
    v_mfma_f32_16x16x32_bf16 v[172:175], a[180:183], v[76:79], 0
    ds_read_b64_tr_b16 a[208:209], v16 offset:3072
    ds_read_b64_tr_b16 a[210:211], v16 offset:3104
    s_waitcnt vmcnt(11)
    v_mfma_f32_16x16x32_bf16 a[96:99], v[96:99], a[16:19], a[96:99]
    ds_read_b64_tr_b16 a[216:217], v16 offset:3584
    ds_read_b64_tr_b16 a[218:219], v16 offset:3616
    v_mfma_f32_16x16x32_bf16 a[116:119], v[100:103], a[16:19], a[116:119]
    ds_read_b64_tr_b16 v[124:125], v9 offset:12288
    v_mfma_f32_16x16x32_bf16 a[136:139], v[104:107], a[16:19], a[136:139]
    buffer_load_dwordx4 v4, s[52:55], s78 offen offset:2048 lds
    v_mfma_f32_16x16x32_bf16 a[156:159], v[108:111], a[16:19], a[156:159]
    buffer_load_dwordx4 a[16:19], v10, s[60:63], s79 offen offset:1024 sc1
    v_mfma_f32_16x16x32_bf16 v[176:179], a[188:191], v[64:67], 0
    ds_read_b64_tr_b16 v[126:127], v9 offset:12800
    v_mfma_f32_16x16x32_bf16 v[180:183], a[188:191], v[68:71], 0
    buffer_load_dwordx4 v5, s[52:55], s78 offen offset:3072 lds
    v_mfma_f32_16x16x32_bf16 v[184:187], a[188:191], v[72:75], 0
    v_mfma_f32_16x16x32_bf16 v[188:191], a[188:191], v[76:79], 0
    s_waitcnt lgkmcnt(0)
    s_waitcnt vmcnt(13)
    v_mfma_f32_16x16x32_bf16 a[80:83], v[112:115], a[20:23], a[80:83]
    s_add_u32 s79, s79, 40960
    s_cmp_ge_u32 s12, 4
    v_mfma_f32_16x16x32_bf16 a[100:103], v[116:119], a[20:23], a[100:103]
    s_cselect_b32 s78, s75, 0
    s_add_u32 s78, s78, s74
    v_mfma_f32_16x16x32_bf16 a[120:123], v[120:123], a[20:23], a[120:123]
    s_add_u32 s78, s78, 1216512
    s_add_u32 m0, s72, 12288
    v_mfma_f32_16x16x32_bf16 a[140:143], v[124:127], a[20:23], a[140:143]
    buffer_load_dwordx4 a[20:23], v10, s[60:63], s79 offen sc1
    v_mfma_f32_16x16x32_bf16 v[192:195], a[196:199], v[64:67], 0
    ds_read_b64_tr_b16 v[96:97], v6 offset:16384
    v_mfma_f32_16x16x32_bf16 v[196:199], a[196:199], v[68:71], 0
    buffer_load_dwordx4 v2, s[52:55], s78 offen lds
    v_mfma_f32_16x16x32_bf16 v[200:203], a[196:199], v[72:75], 0
    ds_read_b64_tr_b16 v[98:99], v6 offset:16896
    ds_read_b64_tr_b16 v[100:101], v7 offset:16384
    v_mfma_f32_16x16x32_bf16 v[204:207], a[196:199], v[76:79], 0
    s_waitcnt vmcnt(14)
    v_mfma_f32_16x16x32_bf16 a[84:87], v[112:115], a[24:27], a[84:87]
    ds_read_b64_tr_b16 v[102:103], v7 offset:16896
    v_mfma_f32_16x16x32_bf16 a[104:107], v[116:119], a[24:27], a[104:107]
    buffer_load_dwordx4 v3, s[52:55], s78 offen offset:1024 lds
    v_mfma_f32_16x16x32_bf16 a[124:127], v[120:123], a[24:27], a[124:127]
    ds_read_b64_tr_b16 v[104:105], v8 offset:16384
    ds_read_b64_tr_b16 v[106:107], v8 offset:16896
    v_mfma_f32_16x16x32_bf16 a[144:147], v[124:127], a[24:27], a[144:147]
    buffer_load_dwordx4 a[24:27], v10, s[60:63], s79 offen offset:256 sc1
    v_mfma_f32_16x16x32_bf16 v[208:211], a[204:207], v[64:67], 0
    v_mfma_f32_16x16x32_bf16 v[212:215], a[204:207], v[68:71], 0
    v_mfma_f32_16x16x32_bf16 v[216:219], a[204:207], v[72:75], 0
    v_mfma_f32_16x16x32_bf16 v[220:223], a[204:207], v[76:79], 0
    s_waitcnt vmcnt(15)
    v_mfma_f32_16x16x32_bf16 a[88:91], v[112:115], a[28:31], a[88:91]
    ds_read_b64_tr_b16 v[108:109], v9 offset:16384
    v_mfma_f32_16x16x32_bf16 a[108:111], v[116:119], a[28:31], a[108:111]
    buffer_load_dwordx4 v4, s[52:55], s78 offen offset:2048 lds
    v_mfma_f32_16x16x32_bf16 a[128:131], v[120:123], a[28:31], a[128:131]
    ds_read_b64_tr_b16 v[110:111], v9 offset:16896
    v_mfma_f32_16x16x32_bf16 a[148:151], v[124:127], a[28:31], a[148:151]
    buffer_load_dwordx4 a[28:31], v10, s[60:63], s79 offen offset:512 sc1
    v_mfma_f32_16x16x32_bf16 v[224:227], a[212:215], v[64:67], 0
    v_mfma_f32_16x16x32_bf16 v[228:231], a[212:215], v[68:71], 0
    v_mfma_f32_16x16x32_bf16 v[232:235], a[212:215], v[72:75], 0
    v_mfma_f32_16x16x32_bf16 v[236:239], a[212:215], v[76:79], 0
    s_waitcnt vmcnt(16)
    v_mfma_f32_16x16x32_bf16 a[92:95], v[112:115], a[32:35], a[92:95]
    buffer_load_dwordx4 v5, s[52:55], s78 offen offset:3072 lds
    v_mfma_f32_16x16x32_bf16 a[112:115], v[116:119], a[32:35], a[112:115]
    v_mfma_f32_16x16x32_bf16 a[132:135], v[120:123], a[32:35], a[132:135]
    v_mfma_f32_16x16x32_bf16 a[152:155], v[124:127], a[32:35], a[152:155]
    buffer_load_dwordx4 a[32:35], v10, s[60:63], s79 offen offset:768 sc1
    v_mfma_f32_16x16x32_bf16 v[240:243], a[220:223], v[64:67], 0
    v_mfma_f32_16x16x32_bf16 v[244:247], a[220:223], v[68:71], 0
    v_mfma_f32_16x16x32_bf16 v[248:251], a[220:223], v[72:75], 0
    v_mfma_f32_16x16x32_bf16 v[252:255], a[220:223], v[76:79], 0
    s_waitcnt vmcnt(17)
    v_mfma_f32_16x16x32_bf16 a[96:99], v[112:115], a[36:39], a[96:99]
    v_mfma_f32_16x16x32_bf16 a[116:119], v[116:119], a[36:39], a[116:119]
    v_mfma_f32_16x16x32_bf16 a[136:139], v[120:123], a[36:39], a[136:139]
    v_mfma_f32_16x16x32_bf16 a[156:159], v[124:127], a[36:39], a[156:159]
    buffer_load_dwordx4 a[36:39], v10, s[60:63], s79 offen offset:1024 sc1
    v_mfma_f32_16x16x32_bf16 v[128:131], a[160:163], v[80:83], v[128:131]
    ds_read2_b64 v[64:67], v17 offset0:104 offset1:105
    ds_read2_b64 v[68:71], v32 offset0:104 offset1:105
    v_mfma_f32_16x16x32_bf16 v[132:135], a[160:163], v[84:87], v[132:135]
    ds_read2_b64 v[72:75], v33 offset0:104 offset1:105
    ds_read2_b64 v[76:79], v34 offset0:104 offset1:105
    v_mfma_f32_16x16x32_bf16 v[136:139], a[160:163], v[88:91], v[136:139]
    v_mfma_f32_16x16x32_bf16 v[140:143], a[160:163], v[92:95], v[140:143]
    s_waitcnt lgkmcnt(4)
    s_waitcnt vmcnt(16)
    v_mfma_f32_16x16x32_bf16 a[80:83], v[96:99], a[0:3], a[80:83]
    s_cmp_ge_u32 s12, 9
    s_cselect_b32 s79, s77, 0
    v_mfma_f32_16x16x32_bf16 a[100:103], v[100:103], a[0:3], a[100:103]
    s_add_u32 s79, s79, s76
    s_add_u32 s79, s79, 245760
    v_mfma_f32_16x16x32_bf16 a[120:123], v[104:107], a[0:3], a[120:123]
    s_add_u32 s78, s78, 110592
    s_add_u32 m0, s72, 16384
    v_mfma_f32_16x16x32_bf16 a[140:143], v[108:111], a[0:3], a[140:143]
    buffer_load_dwordx4 a[0:3], v10, s[60:63], s79 offen sc1
    v_mfma_f32_16x16x32_bf16 v[144:147], a[168:171], v[80:83], v[144:147]
    ds_read_b64_tr_b16 v[112:113], v6 offset:20480
    v_mfma_f32_16x16x32_bf16 v[148:151], a[168:171], v[84:87], v[148:151]
    buffer_load_dwordx4 v2, s[52:55], s78 offen lds
    v_mfma_f32_16x16x32_bf16 v[152:155], a[168:171], v[88:91], v[152:155]
    ds_read_b64_tr_b16 v[114:115], v6 offset:20992
    ds_read_b64_tr_b16 v[116:117], v7 offset:20480
    v_mfma_f32_16x16x32_bf16 v[156:159], a[168:171], v[92:95], v[156:159]
    v_mfma_f32_16x16x32_bf16 a[84:87], v[96:99], a[4:7], a[84:87]
    ds_read_b64_tr_b16 v[118:119], v7 offset:20992
    v_mfma_f32_16x16x32_bf16 a[104:107], v[100:103], a[4:7], a[104:107]
    buffer_load_dwordx4 v3, s[52:55], s78 offen offset:1024 lds
    v_mfma_f32_16x16x32_bf16 a[124:127], v[104:107], a[4:7], a[124:127]
    ds_read_b64_tr_b16 v[120:121], v8 offset:20480
    ds_read_b64_tr_b16 v[122:123], v8 offset:20992
    v_mfma_f32_16x16x32_bf16 a[144:147], v[108:111], a[4:7], a[144:147]
    buffer_load_dwordx4 a[4:7], v10, s[60:63], s79 offen offset:256 sc1
    v_mfma_f32_16x16x32_bf16 v[160:163], a[176:179], v[80:83], v[160:163]
    v_mfma_f32_16x16x32_bf16 v[164:167], a[176:179], v[84:87], v[164:167]
    v_mfma_f32_16x16x32_bf16 v[168:171], a[176:179], v[88:91], v[168:171]
    v_mfma_f32_16x16x32_bf16 v[172:175], a[176:179], v[92:95], v[172:175]
    s_waitcnt vmcnt(18)
    v_mfma_f32_16x16x32_bf16 a[88:91], v[96:99], a[8:11], a[88:91]
    ds_read_b64_tr_b16 v[124:125], v9 offset:20480
    v_mfma_f32_16x16x32_bf16 a[108:111], v[100:103], a[8:11], a[108:111]
    buffer_load_dwordx4 v4, s[52:55], s78 offen offset:2048 lds
    v_mfma_f32_16x16x32_bf16 a[128:131], v[104:107], a[8:11], a[128:131]
    ds_read_b64_tr_b16 v[126:127], v9 offset:20992
    v_mfma_f32_16x16x32_bf16 a[148:151], v[108:111], a[8:11], a[148:151]
    buffer_load_dwordx4 a[8:11], v10, s[60:63], s79 offen offset:512 sc1
    v_mfma_f32_16x16x32_bf16 v[176:179], a[184:187], v[80:83], v[176:179]
    v_mfma_f32_16x16x32_bf16 v[180:183], a[184:187], v[84:87], v[180:183]
    v_mfma_f32_16x16x32_bf16 v[184:187], a[184:187], v[88:91], v[184:187]
    v_mfma_f32_16x16x32_bf16 v[188:191], a[184:187], v[92:95], v[188:191]
    s_waitcnt vmcnt(18)
    v_mfma_f32_16x16x32_bf16 a[92:95], v[96:99], a[12:15], a[92:95]
    buffer_load_dwordx4 v5, s[52:55], s78 offen offset:3072 lds
    v_mfma_f32_16x16x32_bf16 a[112:115], v[100:103], a[12:15], a[112:115]
    v_mfma_f32_16x16x32_bf16 a[132:135], v[104:107], a[12:15], a[132:135]
    v_mfma_f32_16x16x32_bf16 a[152:155], v[108:111], a[12:15], a[152:155]
    buffer_load_dwordx4 a[12:15], v10, s[60:63], s79 offen offset:768 sc1
    v_mfma_f32_16x16x32_bf16 v[192:195], a[192:195], v[80:83], v[192:195]
    v_mfma_f32_16x16x32_bf16 v[196:199], a[192:195], v[84:87], v[196:199]
    v_mfma_f32_16x16x32_bf16 v[200:203], a[192:195], v[88:91], v[200:203]
    v_mfma_f32_16x16x32_bf16 v[204:207], a[192:195], v[92:95], v[204:207]
    s_waitcnt vmcnt(18)
    v_mfma_f32_16x16x32_bf16 a[96:99], v[96:99], a[16:19], a[96:99]
    v_mfma_f32_16x16x32_bf16 a[116:119], v[100:103], a[16:19], a[116:119]
    v_mfma_f32_16x16x32_bf16 a[136:139], v[104:107], a[16:19], a[136:139]
    v_mfma_f32_16x16x32_bf16 a[156:159], v[108:111], a[16:19], a[156:159]
    buffer_load_dwordx4 a[16:19], v10, s[60:63], s79 offen offset:1024 sc1
    v_mfma_f32_16x16x32_bf16 v[208:211], a[200:203], v[80:83], v[208:211]
    v_mfma_f32_16x16x32_bf16 v[212:215], a[200:203], v[84:87], v[212:215]
    v_mfma_f32_16x16x32_bf16 v[216:219], a[200:203], v[88:91], v[216:219]
    v_mfma_f32_16x16x32_bf16 v[220:223], a[200:203], v[92:95], v[220:223]
    s_waitcnt lgkmcnt(0)
    s_waitcnt vmcnt(17)
    v_mfma_f32_16x16x32_bf16 a[80:83], v[112:115], a[20:23], a[80:83]
    s_cmp_ge_u32 s12, 8
    s_cselect_b32 s79, s77, 0
    v_mfma_f32_16x16x32_bf16 a[100:103], v[116:119], a[20:23], a[100:103]
    s_add_u32 s79, s79, s76
    s_add_u32 s79, s79, 286720
    v_mfma_f32_16x16x32_bf16 a[120:123], v[120:123], a[20:23], a[120:123]
    s_add_u32 s78, s78, 110592
    s_add_u32 m0, s72, 20480
    v_mfma_f32_16x16x32_bf16 a[140:143], v[124:127], a[20:23], a[140:143]
    buffer_load_dwordx4 a[20:23], v10, s[60:63], s79 offen sc1
    v_mfma_f32_16x16x32_bf16 v[224:227], a[208:211], v[80:83], v[224:227]
    ds_read_b64_tr_b16 v[96:97], v6 offset:24576
    v_mfma_f32_16x16x32_bf16 v[228:231], a[208:211], v[84:87], v[228:231]
    buffer_load_dwordx4 v2, s[52:55], s78 offen lds
    v_mfma_f32_16x16x32_bf16 v[232:235], a[208:211], v[88:91], v[232:235]
    ds_read_b64_tr_b16 v[98:99], v6 offset:25088
    ds_read_b64_tr_b16 v[100:101], v7 offset:24576
    v_mfma_f32_16x16x32_bf16 v[236:239], a[208:211], v[92:95], v[236:239]
    s_waitcnt vmcnt(16)
    v_mfma_f32_16x16x32_bf16 a[84:87], v[112:115], a[24:27], a[84:87]
    ds_read_b64_tr_b16 v[102:103], v7 offset:25088
    v_mfma_f32_16x16x32_bf16 a[104:107], v[116:119], a[24:27], a[104:107]
    buffer_load_dwordx4 v3, s[52:55], s78 offen offset:1024 lds
    v_mfma_f32_16x16x32_bf16 a[124:127], v[120:123], a[24:27], a[124:127]
    ds_read_b64_tr_b16 v[104:105], v8 offset:24576
    ds_read_b64_tr_b16 v[106:107], v8 offset:25088
    v_mfma_f32_16x16x32_bf16 a[144:147], v[124:127], a[24:27], a[144:147]
    buffer_load_dwordx4 a[24:27], v10, s[60:63], s79 offen offset:256 sc1
    v_mfma_f32_16x16x32_bf16 v[240:243], a[216:219], v[80:83], v[240:243]
    v_mfma_f32_16x16x32_bf16 v[244:247], a[216:219], v[84:87], v[244:247]
    v_mfma_f32_16x16x32_bf16 v[248:251], a[216:219], v[88:91], v[248:251]
    v_mfma_f32_16x16x32_bf16 v[252:255], a[216:219], v[92:95], v[252:255]
    s_waitcnt vmcnt(16)
    v_mfma_f32_16x16x32_bf16 a[88:91], v[112:115], a[28:31], a[88:91]
    ds_read_b64_tr_b16 v[108:109], v9 offset:24576
    v_mfma_f32_16x16x32_bf16 a[108:111], v[116:119], a[28:31], a[108:111]
    buffer_load_dwordx4 v4, s[52:55], s78 offen offset:2048 lds
    v_mfma_f32_16x16x32_bf16 a[128:131], v[120:123], a[28:31], a[128:131]
    ds_read_b64_tr_b16 v[110:111], v9 offset:25088
    v_mfma_f32_16x16x32_bf16 a[148:151], v[124:127], a[28:31], a[148:151]
    buffer_load_dwordx4 a[28:31], v10, s[60:63], s79 offen offset:512 sc1
    v_mfma_f32_16x16x32_bf16 v[144:147], a[164:167], v[64:67], v[144:147]
    ds_read2_b64 v[80:83], v17 offset0:96 offset1:97
    ds_read2_b64 v[84:87], v32 offset0:96 offset1:97
    v_mfma_f32_16x16x32_bf16 v[148:151], a[164:167], v[68:71], v[148:151]
    ds_read2_b64 v[88:91], v33 offset0:96 offset1:97
    ds_read2_b64 v[92:95], v34 offset0:96 offset1:97
    v_mfma_f32_16x16x32_bf16 v[152:155], a[164:167], v[72:75], v[152:155]
    v_mfma_f32_16x16x32_bf16 v[156:159], a[164:167], v[76:79], v[156:159]
    s_waitcnt vmcnt(16)
    v_mfma_f32_16x16x32_bf16 a[92:95], v[112:115], a[32:35], a[92:95]
    buffer_load_dwordx4 v5, s[52:55], s78 offen offset:3072 lds
    v_mfma_f32_16x16x32_bf16 a[112:115], v[116:119], a[32:35], a[112:115]
    v_mfma_f32_16x16x32_bf16 a[132:135], v[120:123], a[32:35], a[132:135]
    v_mfma_f32_16x16x32_bf16 a[152:155], v[124:127], a[32:35], a[152:155]
    buffer_load_dwordx4 a[32:35], v10, s[60:63], s79 offen offset:768 sc1
    v_mfma_f32_16x16x32_bf16 v[160:163], a[172:175], v[64:67], v[160:163]
    v_mfma_f32_16x16x32_bf16 v[164:167], a[172:175], v[68:71], v[164:167]
    v_mfma_f32_16x16x32_bf16 v[168:171], a[172:175], v[72:75], v[168:171]
    v_mfma_f32_16x16x32_bf16 v[172:175], a[172:175], v[76:79], v[172:175]
    s_waitcnt vmcnt(17)
    v_mfma_f32_16x16x32_bf16 a[96:99], v[112:115], a[36:39], a[96:99]
    v_mfma_f32_16x16x32_bf16 a[116:119], v[116:119], a[36:39], a[116:119]
    v_mfma_f32_16x16x32_bf16 a[136:139], v[120:123], a[36:39], a[136:139]
    v_mfma_f32_16x16x32_bf16 a[156:159], v[124:127], a[36:39], a[156:159]
    buffer_load_dwordx4 a[36:39], v10, s[60:63], s79 offen offset:1024 sc1
    v_mfma_f32_16x16x32_bf16 v[176:179], a[180:183], v[64:67], v[176:179]
    v_mfma_f32_16x16x32_bf16 v[180:183], a[180:183], v[68:71], v[180:183]
    v_mfma_f32_16x16x32_bf16 v[184:187], a[180:183], v[72:75], v[184:187]
    v_mfma_f32_16x16x32_bf16 v[188:191], a[180:183], v[76:79], v[188:191]
    s_waitcnt lgkmcnt(4)
    s_waitcnt vmcnt(17)
    v_mfma_f32_16x16x32_bf16 a[80:83], v[96:99], a[0:3], a[80:83]
    s_add_u32 s79, s79, 40960
    s_cmp_ge_u32 s12, 1
    v_mfma_f32_16x16x32_bf16 a[100:103], v[100:103], a[0:3], a[100:103]
    s_cselect_b32 s78, s75, 0
    s_add_u32 s78, s78, s74
    v_mfma_f32_16x16x32_bf16 a[120:123], v[104:107], a[0:3], a[120:123]
    s_add_u32 s78, s78, 1548288
    s_add_u32 m0, s72, 24576
    v_mfma_f32_16x16x32_bf16 a[140:143], v[108:111], a[0:3], a[140:143]
    buffer_load_dwordx4 a[0:3], v10, s[60:63], s79 offen sc1
    v_mfma_f32_16x16x32_bf16 v[192:195], a[188:191], v[64:67], v[192:195]
    ds_read_b64_tr_b16 v[112:113], v6 offset:28672
    v_mfma_f32_16x16x32_bf16 v[196:199], a[188:191], v[68:71], v[196:199]
    buffer_load_dwordx4 v2, s[52:55], s78 offen lds
    v_mfma_f32_16x16x32_bf16 v[200:203], a[188:191], v[72:75], v[200:203]
    ds_read_b64_tr_b16 v[114:115], v6 offset:29184
    ds_read_b64_tr_b16 v[116:117], v7 offset:28672
    v_mfma_f32_16x16x32_bf16 v[204:207], a[188:191], v[76:79], v[204:207]
    s_waitcnt vmcnt(16)
    v_mfma_f32_16x16x32_bf16 a[84:87], v[96:99], a[4:7], a[84:87]
    ds_read_b64_tr_b16 v[118:119], v7 offset:29184
    v_mfma_f32_16x16x32_bf16 a[104:107], v[100:103], a[4:7], a[104:107]
    buffer_load_dwordx4 v3, s[52:55], s78 offen offset:1024 lds
    v_mfma_f32_16x16x32_bf16 a[124:127], v[104:107], a[4:7], a[124:127]
    ds_read_b64_tr_b16 v[120:121], v8 offset:28672
    ds_read_b64_tr_b16 v[122:123], v8 offset:29184
    v_mfma_f32_16x16x32_bf16 a[144:147], v[108:111], a[4:7], a[144:147]
    buffer_load_dwordx4 a[4:7], v10, s[60:63], s79 offen offset:256 sc1
    v_mfma_f32_16x16x32_bf16 v[208:211], a[196:199], v[64:67], v[208:211]
    v_mfma_f32_16x16x32_bf16 v[212:215], a[196:199], v[68:71], v[212:215]
    v_mfma_f32_16x16x32_bf16 v[216:219], a[196:199], v[72:75], v[216:219]
    v_mfma_f32_16x16x32_bf16 v[220:223], a[196:199], v[76:79], v[220:223]
    s_waitcnt vmcnt(16)
    v_mfma_f32_16x16x32_bf16 a[88:91], v[96:99], a[8:11], a[88:91]
    ds_read_b64_tr_b16 v[124:125], v9 offset:28672
    v_mfma_f32_16x16x32_bf16 a[108:111], v[100:103], a[8:11], a[108:111]
    buffer_load_dwordx4 v4, s[52:55], s78 offen offset:2048 lds
    v_mfma_f32_16x16x32_bf16 a[128:131], v[104:107], a[8:11], a[128:131]
    ds_read_b64_tr_b16 v[126:127], v9 offset:29184
    v_mfma_f32_16x16x32_bf16 a[148:151], v[108:111], a[8:11], a[148:151]
    buffer_load_dwordx4 a[8:11], v10, s[60:63], s79 offen offset:512 sc1
    v_mfma_f32_16x16x32_bf16 v[224:227], a[204:207], v[64:67], v[224:227]
    v_mfma_f32_16x16x32_bf16 v[228:231], a[204:207], v[68:71], v[228:231]
    v_mfma_f32_16x16x32_bf16 v[232:235], a[204:207], v[72:75], v[232:235]
    v_mfma_f32_16x16x32_bf16 v[236:239], a[204:207], v[76:79], v[236:239]
    s_waitcnt vmcnt(16)
    v_mfma_f32_16x16x32_bf16 a[92:95], v[96:99], a[12:15], a[92:95]
    buffer_load_dwordx4 v5, s[52:55], s78 offen offset:3072 lds
    v_mfma_f32_16x16x32_bf16 a[112:115], v[100:103], a[12:15], a[112:115]
    v_mfma_f32_16x16x32_bf16 a[132:135], v[104:107], a[12:15], a[132:135]
    v_mfma_f32_16x16x32_bf16 a[152:155], v[108:111], a[12:15], a[152:155]
    buffer_load_dwordx4 a[12:15], v10, s[60:63], s79 offen offset:768 sc1
    v_mfma_f32_16x16x32_bf16 v[240:243], a[212:215], v[64:67], v[240:243]
    v_mfma_f32_16x16x32_bf16 v[244:247], a[212:215], v[68:71], v[244:247]
    v_mfma_f32_16x16x32_bf16 v[248:251], a[212:215], v[72:75], v[248:251]
    v_mfma_f32_16x16x32_bf16 v[252:255], a[212:215], v[76:79], v[252:255]
    s_waitcnt vmcnt(17)
    v_mfma_f32_16x16x32_bf16 a[96:99], v[96:99], a[16:19], a[96:99]
    v_mfma_f32_16x16x32_bf16 a[116:119], v[100:103], a[16:19], a[116:119]
    v_mfma_f32_16x16x32_bf16 a[136:139], v[104:107], a[16:19], a[136:139]
    v_mfma_f32_16x16x32_bf16 a[156:159], v[108:111], a[16:19], a[156:159]
    buffer_load_dwordx4 a[16:19], v10, s[60:63], s79 offen offset:1024 sc1
    s_waitcnt lgkmcnt(8)
    v_mfma_f32_16x16x32_bf16 v[144:147], a[160:163], v[80:83], v[144:147]
    ds_read2_b64 v[64:67], v17 offset0:88 offset1:89
    ds_read2_b64 v[68:71], v32 offset0:88 offset1:89
    v_mfma_f32_16x16x32_bf16 v[148:151], a[160:163], v[84:87], v[148:151]
    ds_read2_b64 v[72:75], v33 offset0:88 offset1:89
    ds_read2_b64 v[76:79], v34 offset0:88 offset1:89
    v_mfma_f32_16x16x32_bf16 v[152:155], a[160:163], v[88:91], v[152:155]
    v_mfma_f32_16x16x32_bf16 v[156:159], a[160:163], v[92:95], v[156:159]
    s_waitcnt lgkmcnt(4)
    s_waitcnt vmcnt(17)
    v_mfma_f32_16x16x32_bf16 a[80:83], v[112:115], a[20:23], a[80:83]
    s_add_u32 s79, s79, 40960
    ds_read_b64_tr_b16 v[96:97], v6 offset:0
    v_mfma_f32_16x16x32_bf16 a[100:103], v[116:119], a[20:23], a[100:103]
    ds_read_b64_tr_b16 v[98:99], v6 offset:512
    ds_read_b64_tr_b16 v[100:101], v7 offset:0
    v_mfma_f32_16x16x32_bf16 a[120:123], v[120:123], a[20:23], a[120:123]
    v_mfma_f32_16x16x32_bf16 a[140:143], v[124:127], a[20:23], a[140:143]
    buffer_load_dwordx4 a[20:23], v10, s[60:63], s79 offen sc1
    s_waitcnt vmcnt(15)
    v_mfma_f32_16x16x32_bf16 a[84:87], v[112:115], a[24:27], a[84:87]
    ds_read_b64_tr_b16 v[102:103], v7 offset:512
    ds_read_b64_tr_b16 v[104:105], v8 offset:0
    v_mfma_f32_16x16x32_bf16 a[104:107], v[116:119], a[24:27], a[104:107]
    ds_read_b64_tr_b16 v[106:107], v8 offset:512
    v_mfma_f32_16x16x32_bf16 a[124:127], v[120:123], a[24:27], a[124:127]
    v_mfma_f32_16x16x32_bf16 a[144:147], v[124:127], a[24:27], a[144:147]
    buffer_load_dwordx4 a[24:27], v10, s[60:63], s79 offen offset:256 sc1
    v_mfma_f32_16x16x32_bf16 v[160:163], a[168:171], v[80:83], v[160:163]
    v_mfma_f32_16x16x32_bf16 v[164:167], a[168:171], v[84:87], v[164:167]
    v_mfma_f32_16x16x32_bf16 v[168:171], a[168:171], v[88:91], v[168:171]
    v_mfma_f32_16x16x32_bf16 v[172:175], a[168:171], v[92:95], v[172:175]
    s_waitcnt vmcnt(14)
    v_mfma_f32_16x16x32_bf16 a[88:91], v[112:115], a[28:31], a[88:91]
    s_mul_i32 s74, s3, 1703936
    s_lshl_b32 s15, s8, 7
    v_mfma_f32_16x16x32_bf16 a[108:111], v[116:119], a[28:31], a[108:111]
    s_add_u32 s74, s74, s15
    v_lshrrev_b32 v20, 3, v0
    v_mfma_f32_16x16x32_bf16 a[128:131], v[120:123], a[28:31], a[128:131]
    v_mul_u32_u24 v20, 4096, v20
    v_and_b32 v21, 7, v0
    v_mfma_f32_16x16x32_bf16 a[148:151], v[124:127], a[28:31], a[148:151]
    buffer_load_dwordx4 a[28:31], v10, s[60:63], s79 offen offset:512 sc1
    s_waitcnt vmcnt(13)
    v_mfma_f32_16x16x32_bf16 a[92:95], v[112:115], a[32:35], a[92:95]
    v_bfe_u32 v22, v0, 4, 1
    v_lshlrev_b32 v22, 1, v22
    v_mfma_f32_16x16x32_bf16 a[112:115], v[116:119], a[32:35], a[112:115]
    v_xor_b32 v21, v21, v22
    v_xor_b32 v22, 0, v21
    v_mfma_f32_16x16x32_bf16 a[132:135], v[120:123], a[32:35], a[132:135]
    v_lshl_add_u32 v2, v22, 4, v20
    v_xor_b32 v22, 4, v21
    v_mfma_f32_16x16x32_bf16 a[152:155], v[124:127], a[32:35], a[152:155]
    buffer_load_dwordx4 a[32:35], v10, s[60:63], s79 offen offset:768 sc1
    s_waitcnt vmcnt(13)
    v_mfma_f32_16x16x32_bf16 a[96:99], v[112:115], a[36:39], a[96:99]
    v_lshl_add_u32 v3, v22, 4, v20
    v_add_u32 v3, 31744, v3
    v_mfma_f32_16x16x32_bf16 a[116:119], v[116:119], a[36:39], a[116:119]
    v_xor_b32 v22, 0, v21
    v_lshl_add_u32 v4, v22, 4, v20
    v_mfma_f32_16x16x32_bf16 a[136:139], v[120:123], a[36:39], a[136:139]
    v_add_u32 v4, 63488, v4
    v_xor_b32 v22, 4, v21
    v_mfma_f32_16x16x32_bf16 a[156:159], v[124:127], a[36:39], a[156:159]
    buffer_load_dwordx4 a[36:39], v10, s[60:63], s79 offen offset:1024 sc1
    v_mfma_f32_16x16x32_bf16 v[176:179], a[176:179], v[80:83], v[176:179]
    v_lshl_add_u32 v5, v22, 4, v20
    v_add_u32 v5, 95232, v5
    v_mfma_f32_16x16x32_bf16 v[180:183], a[176:179], v[84:87], v[180:183]
    ds_read_b64_tr_b16 v[108:109], v9 offset:0
    ds_read_b64_tr_b16 v[110:111], v9 offset:512
    v_mfma_f32_16x16x32_bf16 v[184:187], a[176:179], v[88:91], v[184:187]
    v_mfma_f32_16x16x32_bf16 v[188:191], a[176:179], v[92:95], v[188:191]
    s_waitcnt lgkmcnt(0)
    s_waitcnt vmcnt(13)
    v_mfma_f32_16x16x32_bf16 a[80:83], v[96:99], a[0:3], a[80:83]
    s_cmp_ge_u32 s12, 5
    s_cselect_b32 s79, s77, 0
    v_mfma_f32_16x16x32_bf16 a[100:103], v[100:103], a[0:3], a[100:103]
    s_add_u32 s79, s79, s76
    s_add_u32 s79, s79, 409600
    v_mfma_f32_16x16x32_bf16 a[120:123], v[104:107], a[0:3], a[120:123]
    ds_read_b64_tr_b16 v[112:113], v6 offset:4096
    ds_read_b64_tr_b16 v[114:115], v6 offset:4608
    v_mfma_f32_16x16x32_bf16 a[140:143], v[108:111], a[0:3], a[140:143]
    buffer_load_dwordx4 a[0:3], v10, s[60:63], s79 offen sc1
    s_waitcnt vmcnt(11)
    v_mfma_f32_16x16x32_bf16 a[84:87], v[96:99], a[4:7], a[84:87]
    ds_read_b64_tr_b16 v[116:117], v7 offset:4096
    ds_read_b64_tr_b16 v[118:119], v7 offset:4608
    v_mfma_f32_16x16x32_bf16 a[104:107], v[100:103], a[4:7], a[104:107]
    ds_read_b64_tr_b16 v[120:121], v8 offset:4096
    ds_read_b64_tr_b16 v[122:123], v8 offset:4608
    v_mfma_f32_16x16x32_bf16 a[124:127], v[104:107], a[4:7], a[124:127]
    v_mfma_f32_16x16x32_bf16 a[144:147], v[108:111], a[4:7], a[144:147]
    buffer_load_dwordx4 a[4:7], v10, s[60:63], s79 offen offset:256 sc1
    s_waitcnt vmcnt(10)
    v_mfma_f32_16x16x32_bf16 a[88:91], v[96:99], a[8:11], a[88:91]
    ds_read_b64_tr_b16 v[124:125], v9 offset:4096
    ds_read_b64_tr_b16 v[126:127], v9 offset:4608
    v_mfma_f32_16x16x32_bf16 a[108:111], v[100:103], a[8:11], a[108:111]
    v_mfma_f32_16x16x32_bf16 a[128:131], v[104:107], a[8:11], a[128:131]
    v_mfma_f32_16x16x32_bf16 a[148:151], v[108:111], a[8:11], a[148:151]
    buffer_load_dwordx4 a[8:11], v10, s[60:63], s79 offen offset:512 sc1
    v_mfma_f32_16x16x32_bf16 v[192:195], a[184:187], v[80:83], v[192:195]
    v_mfma_f32_16x16x32_bf16 v[196:199], a[184:187], v[84:87], v[196:199]
    v_mfma_f32_16x16x32_bf16 v[200:203], a[184:187], v[88:91], v[200:203]
    v_mfma_f32_16x16x32_bf16 v[204:207], a[184:187], v[92:95], v[204:207]
    s_waitcnt vmcnt(9)
    v_mfma_f32_16x16x32_bf16 a[92:95], v[96:99], a[12:15], a[92:95]
    v_mfma_f32_16x16x32_bf16 a[112:115], v[100:103], a[12:15], a[112:115]
    v_mfma_f32_16x16x32_bf16 a[132:135], v[104:107], a[12:15], a[132:135]
    v_mfma_f32_16x16x32_bf16 a[152:155], v[108:111], a[12:15], a[152:155]
    buffer_load_dwordx4 a[12:15], v10, s[60:63], s79 offen offset:768 sc1
    s_waitcnt vmcnt(9)
    v_mfma_f32_16x16x32_bf16 a[96:99], v[96:99], a[16:19], a[96:99]
    v_mfma_f32_16x16x32_bf16 a[116:119], v[100:103], a[16:19], a[116:119]
    v_mfma_f32_16x16x32_bf16 a[136:139], v[104:107], a[16:19], a[136:139]
    v_mfma_f32_16x16x32_bf16 a[156:159], v[108:111], a[16:19], a[156:159]
    buffer_load_dwordx4 a[16:19], v10, s[60:63], s79 offen offset:1024 sc1
    s_waitcnt lgkmcnt(0)
    s_waitcnt vmcnt(9)
    v_mfma_f32_16x16x32_bf16 a[80:83], v[112:115], a[20:23], a[80:83]
    s_cmp_ge_u32 s12, 4
    s_cselect_b32 s79, s77, 0
    v_mfma_f32_16x16x32_bf16 a[100:103], v[116:119], a[20:23], a[100:103]
    s_add_u32 s79, s79, s76
    s_add_u32 s79, s79, 450560
    v_mfma_f32_16x16x32_bf16 a[120:123], v[120:123], a[20:23], a[120:123]
    ds_read_b64_tr_b16 v[96:97], v6 offset:8192
    ds_read_b64_tr_b16 v[98:99], v6 offset:8704
    v_mfma_f32_16x16x32_bf16 a[140:143], v[124:127], a[20:23], a[140:143]
    buffer_load_dwordx4 a[20:23], v10, s[60:63], s79 offen sc1
    v_mfma_f32_16x16x32_bf16 v[208:211], a[192:195], v[80:83], v[208:211]
    ds_read_b64_tr_b16 v[100:101], v7 offset:8192
    v_mfma_f32_16x16x32_bf16 v[212:215], a[192:195], v[84:87], v[212:215]
    v_mfma_f32_16x16x32_bf16 v[216:219], a[192:195], v[88:91], v[216:219]
    v_mfma_f32_16x16x32_bf16 v[220:223], a[192:195], v[92:95], v[220:223]
    s_waitcnt vmcnt(9)
    v_mfma_f32_16x16x32_bf16 a[84:87], v[112:115], a[24:27], a[84:87]
    ds_read_b64_tr_b16 v[102:103], v7 offset:8704
    ds_read_b64_tr_b16 v[104:105], v8 offset:8192
    v_mfma_f32_16x16x32_bf16 a[104:107], v[116:119], a[24:27], a[104:107]
    ds_read_b64_tr_b16 v[106:107], v8 offset:8704
    v_mfma_f32_16x16x32_bf16 a[124:127], v[120:123], a[24:27], a[124:127]
    v_mfma_f32_16x16x32_bf16 a[144:147], v[124:127], a[24:27], a[144:147]
    buffer_load_dwordx4 a[24:27], v10, s[60:63], s79 offen offset:256 sc1
    s_waitcnt vmcnt(9)
    v_mfma_f32_16x16x32_bf16 a[88:91], v[112:115], a[28:31], a[88:91]
    ds_read_b64_tr_b16 v[108:109], v9 offset:8192
    ds_read_b64_tr_b16 v[110:111], v9 offset:8704
    v_mfma_f32_16x16x32_bf16 a[108:111], v[116:119], a[28:31], a[108:111]
    v_mfma_f32_16x16x32_bf16 a[128:131], v[120:123], a[28:31], a[128:131]
    v_mfma_f32_16x16x32_bf16 a[148:151], v[124:127], a[28:31], a[148:151]
    buffer_load_dwordx4 a[28:31], v10, s[60:63], s79 offen offset:512 sc1
    s_waitcnt vmcnt(9)
    v_mfma_f32_16x16x32_bf16 a[92:95], v[112:115], a[32:35], a[92:95]
    v_mfma_f32_16x16x32_bf16 a[112:115], v[116:119], a[32:35], a[112:115]
    v_mfma_f32_16x16x32_bf16 a[132:135], v[120:123], a[32:35], a[132:135]
    v_mfma_f32_16x16x32_bf16 a[152:155], v[124:127], a[32:35], a[152:155]
    buffer_load_dwordx4 a[32:35], v10, s[60:63], s79 offen offset:768 sc1
    v_mfma_f32_16x16x32_bf16 v[224:227], a[200:203], v[80:83], v[224:227]
    v_mfma_f32_16x16x32_bf16 v[228:231], a[200:203], v[84:87], v[228:231]
    v_mfma_f32_16x16x32_bf16 v[232:235], a[200:203], v[88:91], v[232:235]
    v_mfma_f32_16x16x32_bf16 v[236:239], a[200:203], v[92:95], v[236:239]
    s_waitcnt vmcnt(9)
    v_mfma_f32_16x16x32_bf16 a[96:99], v[112:115], a[36:39], a[96:99]
    v_mfma_f32_16x16x32_bf16 a[116:119], v[116:119], a[36:39], a[116:119]
    v_mfma_f32_16x16x32_bf16 a[136:139], v[120:123], a[36:39], a[136:139]
    v_mfma_f32_16x16x32_bf16 a[156:159], v[124:127], a[36:39], a[156:159]
    buffer_load_dwordx4 a[36:39], v10, s[60:63], s79 offen offset:1024 sc1
    s_waitcnt lgkmcnt(0)
    s_waitcnt vmcnt(9)
    v_mfma_f32_16x16x32_bf16 a[80:83], v[96:99], a[0:3], a[80:83]
    s_add_u32 s79, s79, 40960
    ds_read_b64_tr_b16 v[112:113], v6 offset:12288
    v_mfma_f32_16x16x32_bf16 a[100:103], v[100:103], a[0:3], a[100:103]
    ds_read_b64_tr_b16 v[114:115], v6 offset:12800
    ds_read_b64_tr_b16 v[116:117], v7 offset:12288
    v_mfma_f32_16x16x32_bf16 a[120:123], v[104:107], a[0:3], a[120:123]
    v_mfma_f32_16x16x32_bf16 a[140:143], v[108:111], a[0:3], a[140:143]
    buffer_load_dwordx4 a[0:3], v10, s[60:63], s79 offen sc1
    s_waitcnt vmcnt(9)
    v_mfma_f32_16x16x32_bf16 a[84:87], v[96:99], a[4:7], a[84:87]
    ds_read_b64_tr_b16 v[118:119], v7 offset:12800
    ds_read_b64_tr_b16 v[120:121], v8 offset:12288
    v_mfma_f32_16x16x32_bf16 a[104:107], v[100:103], a[4:7], a[104:107]
    ds_read_b64_tr_b16 v[122:123], v8 offset:12800
    v_mfma_f32_16x16x32_bf16 a[124:127], v[104:107], a[4:7], a[124:127]
    v_mfma_f32_16x16x32_bf16 a[144:147], v[108:111], a[4:7], a[144:147]
    buffer_load_dwordx4 a[4:7], v10, s[60:63], s79 offen offset:256 sc1
    v_mfma_f32_16x16x32_bf16 v[240:243], a[208:211], v[80:83], v[240:243]
    v_mfma_f32_16x16x32_bf16 v[244:247], a[208:211], v[84:87], v[244:247]
    v_mfma_f32_16x16x32_bf16 v[248:251], a[208:211], v[88:91], v[248:251]
    v_mfma_f32_16x16x32_bf16 v[252:255], a[208:211], v[92:95], v[252:255]
    s_waitcnt vmcnt(9)
    v_mfma_f32_16x16x32_bf16 a[88:91], v[96:99], a[8:11], a[88:91]
    ds_read_b64_tr_b16 v[124:125], v9 offset:12288
    ds_read_b64_tr_b16 v[126:127], v9 offset:12800
    v_mfma_f32_16x16x32_bf16 a[108:111], v[100:103], a[8:11], a[108:111]
    v_mfma_f32_16x16x32_bf16 a[128:131], v[104:107], a[8:11], a[128:131]
    v_mfma_f32_16x16x32_bf16 a[148:151], v[108:111], a[8:11], a[148:151]
    buffer_load_dwordx4 a[8:11], v10, s[60:63], s79 offen offset:512 sc1
    s_waitcnt vmcnt(9)
    v_mfma_f32_16x16x32_bf16 a[92:95], v[96:99], a[12:15], a[92:95]
    v_mfma_f32_16x16x32_bf16 a[112:115], v[100:103], a[12:15], a[112:115]
    v_mfma_f32_16x16x32_bf16 a[132:135], v[104:107], a[12:15], a[132:135]
    v_mfma_f32_16x16x32_bf16 a[152:155], v[108:111], a[12:15], a[152:155]
    buffer_load_dwordx4 a[12:15], v10, s[60:63], s79 offen offset:768 sc1
    s_waitcnt vmcnt(9)
    v_mfma_f32_16x16x32_bf16 a[96:99], v[96:99], a[16:19], a[96:99]
    v_mfma_f32_16x16x32_bf16 a[116:119], v[100:103], a[16:19], a[116:119]
    v_mfma_f32_16x16x32_bf16 a[136:139], v[104:107], a[16:19], a[136:139]
    v_mfma_f32_16x16x32_bf16 a[156:159], v[108:111], a[16:19], a[156:159]
    buffer_load_dwordx4 a[16:19], v10, s[60:63], s79 offen offset:1024 sc1
    v_mfma_f32_16x16x32_bf16 v[160:163], a[164:167], v[64:67], v[160:163]
    ds_read2_b64 v[80:83], v17 offset0:80 offset1:81
    ds_read2_b64 v[84:87], v32 offset0:80 offset1:81
    v_mfma_f32_16x16x32_bf16 v[164:167], a[164:167], v[68:71], v[164:167]
    ds_read2_b64 v[88:91], v33 offset0:80 offset1:81
    ds_read2_b64 v[92:95], v34 offset0:80 offset1:81
    v_mfma_f32_16x16x32_bf16 v[168:171], a[164:167], v[72:75], v[168:171]
    v_mfma_f32_16x16x32_bf16 v[172:175], a[164:167], v[76:79], v[172:175]
    s_waitcnt lgkmcnt(4)
    s_waitcnt vmcnt(9)
    v_mfma_f32_16x16x32_bf16 a[80:83], v[112:115], a[20:23], a[80:83]
    s_add_u32 s79, s79, 40960
    ds_read_b64_tr_b16 v[96:97], v6 offset:16384
    v_mfma_f32_16x16x32_bf16 a[100:103], v[116:119], a[20:23], a[100:103]
    ds_read_b64_tr_b16 v[98:99], v6 offset:16896
    ds_read_b64_tr_b16 v[100:101], v7 offset:16384
    v_mfma_f32_16x16x32_bf16 a[120:123], v[120:123], a[20:23], a[120:123]
    v_mfma_f32_16x16x32_bf16 a[140:143], v[124:127], a[20:23], a[140:143]
    buffer_load_dwordx4 a[20:23], v10, s[60:63], s79 offen sc1
    s_waitcnt vmcnt(9)
    v_mfma_f32_16x16x32_bf16 a[84:87], v[112:115], a[24:27], a[84:87]
    ds_read_b64_tr_b16 v[102:103], v7 offset:16896
    ds_read_b64_tr_b16 v[104:105], v8 offset:16384
    v_mfma_f32_16x16x32_bf16 a[104:107], v[116:119], a[24:27], a[104:107]
    ds_read_b64_tr_b16 v[106:107], v8 offset:16896
    v_mfma_f32_16x16x32_bf16 a[124:127], v[120:123], a[24:27], a[124:127]
    v_mfma_f32_16x16x32_bf16 a[144:147], v[124:127], a[24:27], a[144:147]
    buffer_load_dwordx4 a[24:27], v10, s[60:63], s79 offen offset:256 sc1
    s_waitcnt vmcnt(9)
    v_mfma_f32_16x16x32_bf16 a[88:91], v[112:115], a[28:31], a[88:91]
    ds_read_b64_tr_b16 v[108:109], v9 offset:16384
    ds_read_b64_tr_b16 v[110:111], v9 offset:16896
    v_mfma_f32_16x16x32_bf16 a[108:111], v[116:119], a[28:31], a[108:111]
    v_mfma_f32_16x16x32_bf16 a[128:131], v[120:123], a[28:31], a[128:131]
    v_mfma_f32_16x16x32_bf16 a[148:151], v[124:127], a[28:31], a[148:151]
    buffer_load_dwordx4 a[28:31], v10, s[60:63], s79 offen offset:512 sc1
    v_mfma_f32_16x16x32_bf16 v[176:179], a[172:175], v[64:67], v[176:179]
    v_mfma_f32_16x16x32_bf16 v[180:183], a[172:175], v[68:71], v[180:183]
    v_mfma_f32_16x16x32_bf16 v[184:187], a[172:175], v[72:75], v[184:187]
    v_mfma_f32_16x16x32_bf16 v[188:191], a[172:175], v[76:79], v[188:191]
    s_waitcnt vmcnt(9)
    v_mfma_f32_16x16x32_bf16 a[92:95], v[112:115], a[32:35], a[92:95]
    v_mfma_f32_16x16x32_bf16 a[112:115], v[116:119], a[32:35], a[112:115]
    v_mfma_f32_16x16x32_bf16 a[132:135], v[120:123], a[32:35], a[132:135]
    v_mfma_f32_16x16x32_bf16 a[152:155], v[124:127], a[32:35], a[152:155]
    buffer_load_dwordx4 a[32:35], v10, s[60:63], s79 offen offset:768 sc1
    s_waitcnt vmcnt(9)
    v_mfma_f32_16x16x32_bf16 a[96:99], v[112:115], a[36:39], a[96:99]
    v_mfma_f32_16x16x32_bf16 a[116:119], v[116:119], a[36:39], a[116:119]
    v_mfma_f32_16x16x32_bf16 a[136:139], v[120:123], a[36:39], a[136:139]
    v_mfma_f32_16x16x32_bf16 a[156:159], v[124:127], a[36:39], a[156:159]
    buffer_load_dwordx4 a[36:39], v10, s[60:63], s79 offen offset:1024 sc1
    s_waitcnt lgkmcnt(0)
    s_waitcnt vmcnt(9)
    v_mfma_f32_16x16x32_bf16 a[80:83], v[96:99], a[0:3], a[80:83]
    s_cmp_ge_u32 s12, 1
    s_cselect_b32 s79, s77, 0
    v_mfma_f32_16x16x32_bf16 a[100:103], v[100:103], a[0:3], a[100:103]
    s_add_u32 s79, s79, s76
    s_add_u32 s79, s79, 573440
    v_mfma_f32_16x16x32_bf16 a[120:123], v[104:107], a[0:3], a[120:123]
    ds_read_b64_tr_b16 v[112:113], v6 offset:20480
    ds_read_b64_tr_b16 v[114:115], v6 offset:20992
    v_mfma_f32_16x16x32_bf16 a[140:143], v[108:111], a[0:3], a[140:143]
    buffer_load_dwordx4 a[0:3], v10, s[60:63], s79 offen sc1
    v_mfma_f32_16x16x32_bf16 v[192:195], a[180:183], v[64:67], v[192:195]
    ds_read_b64_tr_b16 v[116:117], v7 offset:20480
    v_mfma_f32_16x16x32_bf16 v[196:199], a[180:183], v[68:71], v[196:199]
    v_mfma_f32_16x16x32_bf16 v[200:203], a[180:183], v[72:75], v[200:203]
    v_mfma_f32_16x16x32_bf16 v[204:207], a[180:183], v[76:79], v[204:207]
    s_waitcnt vmcnt(9)
    v_mfma_f32_16x16x32_bf16 a[84:87], v[96:99], a[4:7], a[84:87]
    ds_read_b64_tr_b16 v[118:119], v7 offset:20992
    ds_read_b64_tr_b16 v[120:121], v8 offset:20480
    v_mfma_f32_16x16x32_bf16 a[104:107], v[100:103], a[4:7], a[104:107]
    ds_read_b64_tr_b16 v[122:123], v8 offset:20992
    v_mfma_f32_16x16x32_bf16 a[124:127], v[104:107], a[4:7], a[124:127]
    v_mfma_f32_16x16x32_bf16 a[144:147], v[108:111], a[4:7], a[144:147]
    buffer_load_dwordx4 a[4:7], v10, s[60:63], s79 offen offset:256 sc1
    s_waitcnt vmcnt(9)
    v_mfma_f32_16x16x32_bf16 a[88:91], v[96:99], a[8:11], a[88:91]
    ds_read_b64_tr_b16 v[124:125], v9 offset:20480
    ds_read_b64_tr_b16 v[126:127], v9 offset:20992
    v_mfma_f32_16x16x32_bf16 a[108:111], v[100:103], a[8:11], a[108:111]
    v_mfma_f32_16x16x32_bf16 a[128:131], v[104:107], a[8:11], a[128:131]
    v_mfma_f32_16x16x32_bf16 a[148:151], v[108:111], a[8:11], a[148:151]
    buffer_load_dwordx4 a[8:11], v10, s[60:63], s79 offen offset:512 sc1
    s_waitcnt vmcnt(9)
    v_mfma_f32_16x16x32_bf16 a[92:95], v[96:99], a[12:15], a[92:95]
    v_mfma_f32_16x16x32_bf16 a[112:115], v[100:103], a[12:15], a[112:115]
    v_mfma_f32_16x16x32_bf16 a[132:135], v[104:107], a[12:15], a[132:135]
    v_mfma_f32_16x16x32_bf16 a[152:155], v[108:111], a[12:15], a[152:155]
    buffer_load_dwordx4 a[12:15], v10, s[60:63], s79 offen offset:768 sc1
    v_mfma_f32_16x16x32_bf16 v[208:211], a[188:191], v[64:67], v[208:211]
    v_mfma_f32_16x16x32_bf16 v[212:215], a[188:191], v[68:71], v[212:215]
    v_mfma_f32_16x16x32_bf16 v[216:219], a[188:191], v[72:75], v[216:219]
    v_mfma_f32_16x16x32_bf16 v[220:223], a[188:191], v[76:79], v[220:223]
    s_waitcnt vmcnt(9)
    v_mfma_f32_16x16x32_bf16 a[96:99], v[96:99], a[16:19], a[96:99]
    v_mfma_f32_16x16x32_bf16 a[116:119], v[100:103], a[16:19], a[116:119]
    v_mfma_f32_16x16x32_bf16 a[136:139], v[104:107], a[16:19], a[136:139]
    v_mfma_f32_16x16x32_bf16 a[156:159], v[108:111], a[16:19], a[156:159]
    buffer_load_dwordx4 a[16:19], v10, s[60:63], s79 offen offset:1024 sc1
    s_waitcnt lgkmcnt(0)
    s_waitcnt vmcnt(9)
    v_mfma_f32_16x16x32_bf16 a[80:83], v[112:115], a[20:23], a[80:83]
    ds_read_b64_tr_b16 v[96:97], v6 offset:24576
    ds_read_b64_tr_b16 v[98:99], v6 offset:25088
    v_mfma_f32_16x16x32_bf16 a[100:103], v[116:119], a[20:23], a[100:103]
    ds_read_b64_tr_b16 v[100:101], v7 offset:24576
    v_mfma_f32_16x16x32_bf16 a[120:123], v[120:123], a[20:23], a[120:123]
    v_mfma_f32_16x16x32_bf16 a[140:143], v[124:127], a[20:23], a[140:143]
    s_waitcnt vmcnt(8)
    v_mfma_f32_16x16x32_bf16 a[84:87], v[112:115], a[24:27], a[84:87]
    ds_read_b64_tr_b16 v[102:103], v7 offset:25088
    ds_read_b64_tr_b16 v[104:105], v8 offset:24576
    v_mfma_f32_16x16x32_bf16 a[104:107], v[116:119], a[24:27], a[104:107]
    ds_read_b64_tr_b16 v[106:107], v8 offset:25088
    v_mfma_f32_16x16x32_bf16 a[124:127], v[120:123], a[24:27], a[124:127]
    v_mfma_f32_16x16x32_bf16 a[144:147], v[124:127], a[24:27], a[144:147]
    v_mfma_f32_16x16x32_bf16 v[224:227], a[196:199], v[64:67], v[224:227]
    v_mfma_f32_16x16x32_bf16 v[228:231], a[196:199], v[68:71], v[228:231]
    v_mfma_f32_16x16x32_bf16 v[232:235], a[196:199], v[72:75], v[232:235]
    v_mfma_f32_16x16x32_bf16 v[236:239], a[196:199], v[76:79], v[236:239]
    s_waitcnt vmcnt(7)
    v_mfma_f32_16x16x32_bf16 a[88:91], v[112:115], a[28:31], a[88:91]
    ds_read_b64_tr_b16 v[108:109], v9 offset:24576
    ds_read_b64_tr_b16 v[110:111], v9 offset:25088
    v_mfma_f32_16x16x32_bf16 a[108:111], v[116:119], a[28:31], a[108:111]
    v_mfma_f32_16x16x32_bf16 a[128:131], v[120:123], a[28:31], a[128:131]
    v_mfma_f32_16x16x32_bf16 a[148:151], v[124:127], a[28:31], a[148:151]
    s_waitcnt vmcnt(6)
    v_mfma_f32_16x16x32_bf16 a[92:95], v[112:115], a[32:35], a[92:95]
    v_mfma_f32_16x16x32_bf16 a[112:115], v[116:119], a[32:35], a[112:115]
    v_mfma_f32_16x16x32_bf16 a[132:135], v[120:123], a[32:35], a[132:135]
    v_mfma_f32_16x16x32_bf16 a[152:155], v[124:127], a[32:35], a[152:155]
    s_waitcnt vmcnt(5)
    v_mfma_f32_16x16x32_bf16 a[96:99], v[112:115], a[36:39], a[96:99]
    v_mfma_f32_16x16x32_bf16 a[116:119], v[116:119], a[36:39], a[116:119]
    v_mfma_f32_16x16x32_bf16 a[136:139], v[120:123], a[36:39], a[136:139]
    v_mfma_f32_16x16x32_bf16 a[156:159], v[124:127], a[36:39], a[156:159]
    v_mfma_f32_16x16x32_bf16 v[240:243], a[204:207], v[64:67], v[240:243]
    v_mfma_f32_16x16x32_bf16 v[244:247], a[204:207], v[68:71], v[244:247]
    v_mfma_f32_16x16x32_bf16 v[248:251], a[204:207], v[72:75], v[248:251]
    v_mfma_f32_16x16x32_bf16 v[252:255], a[204:207], v[76:79], v[252:255]
    s_waitcnt lgkmcnt(0)
    s_waitcnt vmcnt(4)
    v_mfma_f32_16x16x32_bf16 a[100:103], v[100:103], a[0:3], a[100:103]
    s_waitcnt vmcnt(3)
    v_mfma_f32_16x16x32_bf16 a[104:107], v[100:103], a[4:7], a[104:107]
    s_waitcnt vmcnt(2)
    v_mfma_f32_16x16x32_bf16 a[108:111], v[100:103], a[8:11], a[108:111]
    s_waitcnt vmcnt(1)
    v_mfma_f32_16x16x32_bf16 a[112:115], v[100:103], a[12:15], a[112:115]
    s_waitcnt vmcnt(0)
    v_mfma_f32_16x16x32_bf16 a[116:119], v[100:103], a[16:19], a[116:119]
    s_add_u32 s78, s74, 0
    s_add_u32 m0, s72, 16384
    s_nop 0
    buffer_load_dwordx4 v2, s[56:59], s78 offen lds
    v_mfma_f32_16x16x32_bf16 a[120:123], v[104:107], a[0:3], a[120:123]
    ds_write_b128 v11, a[100:103] offset:0
    v_mfma_f32_16x16x32_bf16 a[124:127], v[104:107], a[4:7], a[124:127]
    ds_write_b128 v11, a[104:107] offset:1024
    v_mfma_f32_16x16x32_bf16 a[128:131], v[104:107], a[8:11], a[128:131]
    ds_write_b128 v11, a[108:111] offset:2048
    v_mfma_f32_16x16x32_bf16 a[132:135], v[104:107], a[12:15], a[132:135]
    ds_write_b128 v11, a[112:115] offset:3072
    v_mfma_f32_16x16x32_bf16 a[136:139], v[104:107], a[16:19], a[136:139]
    ds_write_b128 v11, a[116:119] offset:4096
    buffer_load_dwordx4 v3, s[56:59], s78 offen offset:1024 lds
    v_mfma_f32_16x16x32_bf16 a[140:143], v[108:111], a[0:3], a[140:143]
    ds_write_b128 v11, a[120:123] offset:5120
    v_mfma_f32_16x16x32_bf16 a[144:147], v[108:111], a[4:7], a[144:147]
    ds_write_b128 v11, a[124:127] offset:6144
    v_mfma_f32_16x16x32_bf16 a[148:151], v[108:111], a[8:11], a[148:151]
    ds_write_b128 v11, a[128:131] offset:7168
    v_mfma_f32_16x16x32_bf16 a[152:155], v[108:111], a[12:15], a[152:155]
    ds_write_b128 v11, a[132:135] offset:8192
    v_mfma_f32_16x16x32_bf16 a[156:159], v[108:111], a[16:19], a[156:159]
    ds_write_b128 v11, a[136:139] offset:9216
    buffer_load_dwordx4 v4, s[56:59], s78 offen offset:2048 lds
    v_mfma_f32_16x16x32_bf16 a[80:83], v[96:99], a[0:3], a[80:83]
    ds_write_b128 v11, a[140:143] offset:10240
    v_mfma_f32_16x16x32_bf16 a[84:87], v[96:99], a[4:7], a[84:87]
    v_mfma_f32_16x16x32_bf16 a[88:91], v[96:99], a[8:11], a[88:91]
    v_mfma_f32_16x16x32_bf16 a[92:95], v[96:99], a[12:15], a[92:95]
    v_mfma_f32_16x16x32_bf16 a[96:99], v[96:99], a[16:19], a[96:99]
    buffer_load_dwordx4 v5, s[56:59], s78 offen offset:3072 lds
    ds_write_b128 v11, a[144:147] offset:11264
    ds_write_b128 v11, a[148:151] offset:12288
    ds_write_b128 v11, a[152:155] offset:13312
    ds_write_b128 v11, a[156:159] offset:14336
    s_branch L_loop1e
L_loop1b:
    s_cmp_eq_u32 s3, 3
    s_cbranch_scc1 L_loop1c
    ds_read_b64_tr_b16 v[96:97], v6 offset:0
    ds_read_b64_tr_b16 v[98:99], v6 offset:512
    ds_read_b64_tr_b16 v[100:101], v7 offset:0
    ds_read_b64_tr_b16 v[102:103], v7 offset:512
    ds_read_b64_tr_b16 v[104:105], v8 offset:0
    ds_read_b64_tr_b16 v[106:107], v8 offset:512
    ds_read_b64_tr_b16 v[108:109], v9 offset:0
    ds_read_b64_tr_b16 v[110:111], v9 offset:512
    s_waitcnt lgkmcnt(0)
    s_waitcnt vmcnt(9)
    v_mfma_f32_16x16x32_bf16 a[80:83], v[96:99], a[0:3], 0
    s_cmp_ge_u32 s12, 13
    s_cselect_b32 s79, s77, 0
    v_mfma_f32_16x16x32_bf16 a[100:103], v[100:103], a[0:3], 0
    s_add_u32 s79, s79, s76
    s_add_u32 s79, s79, 81920
    v_mfma_f32_16x16x32_bf16 a[120:123], v[104:107], a[0:3], 0
    ds_read_b64_tr_b16 v[112:113], v6 offset:4096
    ds_read_b64_tr_b16 v[114:115], v6 offset:4608
    v_mfma_f32_16x16x32_bf16 a[140:143], v[108:111], a[0:3], 0
    buffer_load_dwordx4 a[0:3], v10, s[60:63], s79 offen sc1
    s_waitcnt vmcnt(9)
    v_mfma_f32_16x16x32_bf16 a[84:87], v[96:99], a[4:7], 0
    ds_read_b64_tr_b16 v[116:117], v7 offset:4096
    ds_read_b64_tr_b16 v[118:119], v7 offset:4608
    v_mfma_f32_16x16x32_bf16 a[104:107], v[100:103], a[4:7], 0
    ds_read_b64_tr_b16 v[120:121], v8 offset:4096
    ds_read_b64_tr_b16 v[122:123], v8 offset:4608
    v_mfma_f32_16x16x32_bf16 a[124:127], v[104:107], a[4:7], 0
    v_mfma_f32_16x16x32_bf16 a[144:147], v[108:111], a[4:7], 0
    buffer_load_dwordx4 a[4:7], v10, s[60:63], s79 offen offset:256 sc1
    s_waitcnt vmcnt(9)
    v_mfma_f32_16x16x32_bf16 a[88:91], v[96:99], a[8:11], 0
    ds_read_b64_tr_b16 v[124:125], v9 offset:4096
    ds_read_b64_tr_b16 v[126:127], v9 offset:4608
    v_mfma_f32_16x16x32_bf16 a[108:111], v[100:103], a[8:11], 0
    ds_write_b128 v11, a[40:43] offset:0
    ds_write_b128 v11, a[44:47] offset:1024
    v_mfma_f32_16x16x32_bf16 a[128:131], v[104:107], a[8:11], 0
    v_mfma_f32_16x16x32_bf16 a[148:151], v[108:111], a[8:11], 0
    buffer_load_dwordx4 a[8:11], v10, s[60:63], s79 offen offset:512 sc1
    s_waitcnt vmcnt(9)
    v_mfma_f32_16x16x32_bf16 a[92:95], v[96:99], a[12:15], 0
    ds_write_b128 v11, a[48:51] offset:2048
    v_mfma_f32_16x16x32_bf16 a[112:115], v[100:103], a[12:15], 0
    v_mfma_f32_16x16x32_bf16 a[132:135], v[104:107], a[12:15], 0
    v_mfma_f32_16x16x32_bf16 a[152:155], v[108:111], a[12:15], 0
    buffer_load_dwordx4 a[12:15], v10, s[60:63], s79 offen offset:768 sc1
    s_waitcnt vmcnt(9)
    v_mfma_f32_16x16x32_bf16 a[96:99], v[96:99], a[16:19], 0
    ds_write_b128 v11, a[52:55] offset:3072
    v_mfma_f32_16x16x32_bf16 a[116:119], v[100:103], a[16:19], 0
    v_mfma_f32_16x16x32_bf16 a[136:139], v[104:107], a[16:19], 0
    v_mfma_f32_16x16x32_bf16 a[156:159], v[108:111], a[16:19], 0
    buffer_load_dwordx4 a[16:19], v10, s[60:63], s79 offen offset:1024 sc1
    s_waitcnt lgkmcnt(4)
    s_waitcnt vmcnt(9)
    v_mfma_f32_16x16x32_bf16 a[80:83], v[112:115], a[20:23], a[80:83]
    s_cmp_ge_u32 s12, 12
    s_cselect_b32 s79, s77, 0
    v_mfma_f32_16x16x32_bf16 a[100:103], v[116:119], a[20:23], a[100:103]
    s_add_u32 s79, s79, s76
    s_add_u32 s79, s79, 122880
    v_mfma_f32_16x16x32_bf16 a[120:123], v[120:123], a[20:23], a[120:123]
    ds_read_b64_tr_b16 v[96:97], v6 offset:8192
    ds_read_b64_tr_b16 v[98:99], v6 offset:8704
    v_mfma_f32_16x16x32_bf16 a[140:143], v[124:127], a[20:23], a[140:143]
    buffer_load_dwordx4 a[20:23], v10, s[60:63], s79 offen sc1
    s_waitcnt vmcnt(9)
    v_mfma_f32_16x16x32_bf16 a[84:87], v[112:115], a[24:27], a[84:87]
    ds_read_b64_tr_b16 v[100:101], v7 offset:8192
    ds_read_b64_tr_b16 v[102:103], v7 offset:8704
    v_mfma_f32_16x16x32_bf16 a[104:107], v[116:119], a[24:27], a[104:107]
    ds_read_b64_tr_b16 v[104:105], v8 offset:8192
    ds_read_b64_tr_b16 v[106:107], v8 offset:8704
    v_mfma_f32_16x16x32_bf16 a[124:127], v[120:123], a[24:27], a[124:127]
    v_mfma_f32_16x16x32_bf16 a[144:147], v[124:127], a[24:27], a[144:147]
    buffer_load_dwordx4 a[24:27], v10, s[60:63], s79 offen offset:256 sc1
    s_waitcnt vmcnt(9)
    v_mfma_f32_16x16x32_bf16 a[88:91], v[112:115], a[28:31], a[88:91]
    ds_read_b64_tr_b16 v[108:109], v9 offset:8192
    ds_read_b64_tr_b16 v[110:111], v9 offset:8704
    v_mfma_f32_16x16x32_bf16 a[108:111], v[116:119], a[28:31], a[108:111]
    ds_write_b128 v11, a[56:59] offset:4096
    ds_write_b128 v11, a[60:63] offset:5120
    v_mfma_f32_16x16x32_bf16 a[128:131], v[120:123], a[28:31], a[128:131]
    v_mfma_f32_16x16x32_bf16 a[148:151], v[124:127], a[28:31], a[148:151]
    buffer_load_dwordx4 a[28:31], v10, s[60:63], s79 offen offset:512 sc1
    s_waitcnt vmcnt(9)
    v_mfma_f32_16x16x32_bf16 a[92:95], v[112:115], a[32:35], a[92:95]
    ds_write_b128 v11, a[64:67] offset:6144
    v_mfma_f32_16x16x32_bf16 a[112:115], v[116:119], a[32:35], a[112:115]
    v_mfma_f32_16x16x32_bf16 a[132:135], v[120:123], a[32:35], a[132:135]
    v_mfma_f32_16x16x32_bf16 a[152:155], v[124:127], a[32:35], a[152:155]
    buffer_load_dwordx4 a[32:35], v10, s[60:63], s79 offen offset:768 sc1
    s_waitcnt vmcnt(9)
    v_mfma_f32_16x16x32_bf16 a[96:99], v[112:115], a[36:39], a[96:99]
    ds_write_b128 v11, a[68:71] offset:7168
    v_mfma_f32_16x16x32_bf16 a[116:119], v[116:119], a[36:39], a[116:119]
    v_mfma_f32_16x16x32_bf16 a[136:139], v[120:123], a[36:39], a[136:139]
    v_mfma_f32_16x16x32_bf16 a[156:159], v[124:127], a[36:39], a[156:159]
    buffer_load_dwordx4 a[36:39], v10, s[60:63], s79 offen offset:1024 sc1
    s_waitcnt lgkmcnt(4)
    s_waitcnt vmcnt(9)
    v_mfma_f32_16x16x32_bf16 a[80:83], v[96:99], a[0:3], a[80:83]
    s_add_u32 s79, s79, 40960
    s_cmp_ge_u32 s12, 5
    v_mfma_f32_16x16x32_bf16 a[100:103], v[100:103], a[0:3], a[100:103]
    s_cselect_b32 s78, s75, 0
    s_add_u32 s78, s78, s74
    v_mfma_f32_16x16x32_bf16 a[120:123], v[104:107], a[0:3], a[120:123]
    s_add_u32 s78, s78, 1105920
    s_add_u32 m0, s72, 8192
    v_mfma_f32_16x16x32_bf16 a[140:143], v[108:111], a[0:3], a[140:143]
    buffer_load_dwordx4 a[0:3], v10, s[60:63], s79 offen sc1
    s_waitcnt vmcnt(9)
    v_mfma_f32_16x16x32_bf16 a[84:87], v[96:99], a[4:7], a[84:87]
    ds_read_b64_tr_b16 v[112:113], v6 offset:12288
    v_mfma_f32_16x16x32_bf16 a[104:107], v[100:103], a[4:7], a[104:107]
    buffer_load_dwordx4 v2, s[52:55], s78 offen lds
    v_mfma_f32_16x16x32_bf16 a[124:127], v[104:107], a[4:7], a[124:127]
    ds_read_b64_tr_b16 v[114:115], v6 offset:12800
    ds_read_b64_tr_b16 v[116:117], v7 offset:12288
    v_mfma_f32_16x16x32_bf16 a[144:147], v[108:111], a[4:7], a[144:147]
    buffer_load_dwordx4 a[4:7], v10, s[60:63], s79 offen offset:256 sc1
    s_waitcnt vmcnt(10)
    v_mfma_f32_16x16x32_bf16 a[88:91], v[96:99], a[8:11], a[88:91]
    ds_read_b64_tr_b16 v[118:119], v7 offset:12800
    v_mfma_f32_16x16x32_bf16 a[108:111], v[100:103], a[8:11], a[108:111]
    buffer_load_dwordx4 v3, s[52:55], s78 offen offset:1024 lds
    v_mfma_f32_16x16x32_bf16 a[128:131], v[104:107], a[8:11], a[128:131]
    ds_read_b64_tr_b16 v[120:121], v8 offset:12288
    ds_read_b64_tr_b16 v[122:123], v8 offset:12800
    v_mfma_f32_16x16x32_bf16 a[148:151], v[108:111], a[8:11], a[148:151]
    buffer_load_dwordx4 a[8:11], v10, s[60:63], s79 offen offset:512 sc1
    s_waitcnt vmcnt(11)
    v_mfma_f32_16x16x32_bf16 a[92:95], v[96:99], a[12:15], a[92:95]
    ds_read_b64_tr_b16 v[124:125], v9 offset:12288
    v_mfma_f32_16x16x32_bf16 a[112:115], v[100:103], a[12:15], a[112:115]
    buffer_load_dwordx4 v4, s[52:55], s78 offen offset:2048 lds
    v_mfma_f32_16x16x32_bf16 a[132:135], v[104:107], a[12:15], a[132:135]
    ds_read_b64_tr_b16 v[126:127], v9 offset:12800
    v_mfma_f32_16x16x32_bf16 a[152:155], v[108:111], a[12:15], a[152:155]
    buffer_load_dwordx4 a[12:15], v10, s[60:63], s79 offen offset:768 sc1
    s_waitcnt vmcnt(12)
    v_mfma_f32_16x16x32_bf16 a[96:99], v[96:99], a[16:19], a[96:99]
    buffer_load_dwordx4 v5, s[52:55], s78 offen offset:3072 lds
    v_mfma_f32_16x16x32_bf16 a[116:119], v[100:103], a[16:19], a[116:119]
    v_mfma_f32_16x16x32_bf16 a[136:139], v[104:107], a[16:19], a[136:139]
    v_mfma_f32_16x16x32_bf16 a[156:159], v[108:111], a[16:19], a[156:159]
    buffer_load_dwordx4 a[16:19], v10, s[60:63], s79 offen offset:1024 sc1
    s_waitcnt lgkmcnt(0)
    s_waitcnt vmcnt(13)
    v_mfma_f32_16x16x32_bf16 a[80:83], v[112:115], a[20:23], a[80:83]
    s_add_u32 s79, s79, 40960
    s_cmp_ge_u32 s12, 4
    v_mfma_f32_16x16x32_bf16 a[100:103], v[116:119], a[20:23], a[100:103]
    s_cselect_b32 s78, s75, 0
    s_add_u32 s78, s78, s74
    v_mfma_f32_16x16x32_bf16 a[120:123], v[120:123], a[20:23], a[120:123]
    s_add_u32 s78, s78, 1216512
    s_add_u32 m0, s72, 12288
    v_mfma_f32_16x16x32_bf16 a[140:143], v[124:127], a[20:23], a[140:143]
    buffer_load_dwordx4 a[20:23], v10, s[60:63], s79 offen sc1
    s_waitcnt vmcnt(13)
    v_mfma_f32_16x16x32_bf16 a[84:87], v[112:115], a[24:27], a[84:87]
    ds_read_b64_tr_b16 v[96:97], v6 offset:16384
    v_mfma_f32_16x16x32_bf16 a[104:107], v[116:119], a[24:27], a[104:107]
    buffer_load_dwordx4 v2, s[52:55], s78 offen lds
    v_mfma_f32_16x16x32_bf16 a[124:127], v[120:123], a[24:27], a[124:127]
    ds_read_b64_tr_b16 v[98:99], v6 offset:16896
    ds_read_b64_tr_b16 v[100:101], v7 offset:16384
    v_mfma_f32_16x16x32_bf16 a[144:147], v[124:127], a[24:27], a[144:147]
    buffer_load_dwordx4 a[24:27], v10, s[60:63], s79 offen offset:256 sc1
    s_waitcnt vmcnt(14)
    v_mfma_f32_16x16x32_bf16 a[88:91], v[112:115], a[28:31], a[88:91]
    ds_read_b64_tr_b16 v[102:103], v7 offset:16896
    v_mfma_f32_16x16x32_bf16 a[108:111], v[116:119], a[28:31], a[108:111]
    buffer_load_dwordx4 v3, s[52:55], s78 offen offset:1024 lds
    v_mfma_f32_16x16x32_bf16 a[128:131], v[120:123], a[28:31], a[128:131]
    ds_read_b64_tr_b16 v[104:105], v8 offset:16384
    ds_read_b64_tr_b16 v[106:107], v8 offset:16896
    v_mfma_f32_16x16x32_bf16 a[148:151], v[124:127], a[28:31], a[148:151]
    buffer_load_dwordx4 a[28:31], v10, s[60:63], s79 offen offset:512 sc1
    s_waitcnt vmcnt(15)
    v_mfma_f32_16x16x32_bf16 a[92:95], v[112:115], a[32:35], a[92:95]
    ds_read_b64_tr_b16 v[108:109], v9 offset:16384
    v_mfma_f32_16x16x32_bf16 a[112:115], v[116:119], a[32:35], a[112:115]
    buffer_load_dwordx4 v4, s[52:55], s78 offen offset:2048 lds
    v_mfma_f32_16x16x32_bf16 a[132:135], v[120:123], a[32:35], a[132:135]
    ds_read_b64_tr_b16 v[110:111], v9 offset:16896
    v_mfma_f32_16x16x32_bf16 a[152:155], v[124:127], a[32:35], a[152:155]
    buffer_load_dwordx4 a[32:35], v10, s[60:63], s79 offen offset:768 sc1
    s_waitcnt vmcnt(16)
    v_mfma_f32_16x16x32_bf16 a[96:99], v[112:115], a[36:39], a[96:99]
    buffer_load_dwordx4 v5, s[52:55], s78 offen offset:3072 lds
    v_mfma_f32_16x16x32_bf16 a[116:119], v[116:119], a[36:39], a[116:119]
    v_mfma_f32_16x16x32_bf16 a[136:139], v[120:123], a[36:39], a[136:139]
    v_mfma_f32_16x16x32_bf16 a[156:159], v[124:127], a[36:39], a[156:159]
    buffer_load_dwordx4 a[36:39], v10, s[60:63], s79 offen offset:1024 sc1
    s_waitcnt lgkmcnt(0)
    s_waitcnt vmcnt(17)
    v_mfma_f32_16x16x32_bf16 a[80:83], v[96:99], a[0:3], a[80:83]
    s_cmp_ge_u32 s12, 9
    s_cselect_b32 s79, s77, 0
    v_mfma_f32_16x16x32_bf16 a[100:103], v[100:103], a[0:3], a[100:103]
    s_add_u32 s79, s79, s76
    s_add_u32 s79, s79, 245760
    v_mfma_f32_16x16x32_bf16 a[120:123], v[104:107], a[0:3], a[120:123]
    s_add_u32 s78, s78, 110592
    s_add_u32 m0, s72, 16384
    v_mfma_f32_16x16x32_bf16 a[140:143], v[108:111], a[0:3], a[140:143]
    buffer_load_dwordx4 a[0:3], v10, s[60:63], s79 offen sc1
    s_waitcnt vmcnt(16)
    v_mfma_f32_16x16x32_bf16 a[84:87], v[96:99], a[4:7], a[84:87]
    ds_read_b64_tr_b16 v[112:113], v6 offset:20480
    v_mfma_f32_16x16x32_bf16 a[104:107], v[100:103], a[4:7], a[104:107]
    buffer_load_dwordx4 v2, s[52:55], s78 offen lds
    v_mfma_f32_16x16x32_bf16 a[124:127], v[104:107], a[4:7], a[124:127]
    ds_read_b64_tr_b16 v[114:115], v6 offset:20992
    ds_read_b64_tr_b16 v[116:117], v7 offset:20480
    v_mfma_f32_16x16x32_bf16 a[144:147], v[108:111], a[4:7], a[144:147]
    buffer_load_dwordx4 a[4:7], v10, s[60:63], s79 offen offset:256 sc1
    s_waitcnt vmcnt(16)
    v_mfma_f32_16x16x32_bf16 a[88:91], v[96:99], a[8:11], a[88:91]
    ds_read_b64_tr_b16 v[118:119], v7 offset:20992
    v_mfma_f32_16x16x32_bf16 a[108:111], v[100:103], a[8:11], a[108:111]
    buffer_load_dwordx4 v3, s[52:55], s78 offen offset:1024 lds
    v_mfma_f32_16x16x32_bf16 a[128:131], v[104:107], a[8:11], a[128:131]
    ds_read_b64_tr_b16 v[120:121], v8 offset:20480
    ds_read_b64_tr_b16 v[122:123], v8 offset:20992
    v_mfma_f32_16x16x32_bf16 a[148:151], v[108:111], a[8:11], a[148:151]
    buffer_load_dwordx4 a[8:11], v10, s[60:63], s79 offen offset:512 sc1
    s_waitcnt vmcnt(16)
    v_mfma_f32_16x16x32_bf16 a[92:95], v[96:99], a[12:15], a[92:95]
    ds_read_b64_tr_b16 v[124:125], v9 offset:20480
    v_mfma_f32_16x16x32_bf16 a[112:115], v[100:103], a[12:15], a[112:115]
    buffer_load_dwordx4 v4, s[52:55], s78 offen offset:2048 lds
    v_mfma_f32_16x16x32_bf16 a[132:135], v[104:107], a[12:15], a[132:135]
    ds_read_b64_tr_b16 v[126:127], v9 offset:20992
    v_mfma_f32_16x16x32_bf16 a[152:155], v[108:111], a[12:15], a[152:155]
    buffer_load_dwordx4 a[12:15], v10, s[60:63], s79 offen offset:768 sc1
    s_waitcnt vmcnt(16)
    v_mfma_f32_16x16x32_bf16 a[96:99], v[96:99], a[16:19], a[96:99]
    buffer_load_dwordx4 v5, s[52:55], s78 offen offset:3072 lds
    v_mfma_f32_16x16x32_bf16 a[116:119], v[100:103], a[16:19], a[116:119]
    v_mfma_f32_16x16x32_bf16 a[136:139], v[104:107], a[16:19], a[136:139]
    v_mfma_f32_16x16x32_bf16 a[156:159], v[108:111], a[16:19], a[156:159]
    buffer_load_dwordx4 a[16:19], v10, s[60:63], s79 offen offset:1024 sc1
    s_waitcnt lgkmcnt(0)
    s_waitcnt vmcnt(17)
    v_mfma_f32_16x16x32_bf16 a[80:83], v[112:115], a[20:23], a[80:83]
    s_cmp_ge_u32 s12, 8
    s_cselect_b32 s79, s77, 0
    v_mfma_f32_16x16x32_bf16 a[100:103], v[116:119], a[20:23], a[100:103]
    s_add_u32 s79, s79, s76
    s_add_u32 s79, s79, 286720
    v_mfma_f32_16x16x32_bf16 a[120:123], v[120:123], a[20:23], a[120:123]
    s_add_u32 s78, s78, 110592
    s_add_u32 m0, s72, 20480
    v_mfma_f32_16x16x32_bf16 a[140:143], v[124:127], a[20:23], a[140:143]
    buffer_load_dwordx4 a[20:23], v10, s[60:63], s79 offen sc1
    s_waitcnt vmcnt(16)
    v_mfma_f32_16x16x32_bf16 a[84:87], v[112:115], a[24:27], a[84:87]
    ds_read_b64_tr_b16 v[96:97], v6 offset:24576
    v_mfma_f32_16x16x32_bf16 a[104:107], v[116:119], a[24:27], a[104:107]
    buffer_load_dwordx4 v2, s[52:55], s78 offen lds
    v_mfma_f32_16x16x32_bf16 a[124:127], v[120:123], a[24:27], a[124:127]
    ds_read_b64_tr_b16 v[98:99], v6 offset:25088
    ds_read_b64_tr_b16 v[100:101], v7 offset:24576
    v_mfma_f32_16x16x32_bf16 a[144:147], v[124:127], a[24:27], a[144:147]
    buffer_load_dwordx4 a[24:27], v10, s[60:63], s79 offen offset:256 sc1
    s_waitcnt vmcnt(16)
    v_mfma_f32_16x16x32_bf16 a[88:91], v[112:115], a[28:31], a[88:91]
    ds_read_b64_tr_b16 v[102:103], v7 offset:25088
    v_mfma_f32_16x16x32_bf16 a[108:111], v[116:119], a[28:31], a[108:111]
    buffer_load_dwordx4 v3, s[52:55], s78 offen offset:1024 lds
    v_mfma_f32_16x16x32_bf16 a[128:131], v[120:123], a[28:31], a[128:131]
    ds_read_b64_tr_b16 v[104:105], v8 offset:24576
    ds_read_b64_tr_b16 v[106:107], v8 offset:25088
    v_mfma_f32_16x16x32_bf16 a[148:151], v[124:127], a[28:31], a[148:151]
    buffer_load_dwordx4 a[28:31], v10, s[60:63], s79 offen offset:512 sc1
    s_waitcnt vmcnt(16)
    v_mfma_f32_16x16x32_bf16 a[92:95], v[112:115], a[32:35], a[92:95]
    ds_read_b64_tr_b16 v[108:109], v9 offset:24576
    v_mfma_f32_16x16x32_bf16 a[112:115], v[116:119], a[32:35], a[112:115]
    buffer_load_dwordx4 v4, s[52:55], s78 offen offset:2048 lds
    v_mfma_f32_16x16x32_bf16 a[132:135], v[120:123], a[32:35], a[132:135]
    ds_read_b64_tr_b16 v[110:111], v9 offset:25088
    v_mfma_f32_16x16x32_bf16 a[152:155], v[124:127], a[32:35], a[152:155]
    buffer_load_dwordx4 a[32:35], v10, s[60:63], s79 offen offset:768 sc1
    s_waitcnt vmcnt(16)
    v_mfma_f32_16x16x32_bf16 a[96:99], v[112:115], a[36:39], a[96:99]
    buffer_load_dwordx4 v5, s[52:55], s78 offen offset:3072 lds
    v_mfma_f32_16x16x32_bf16 a[116:119], v[116:119], a[36:39], a[116:119]
    v_mfma_f32_16x16x32_bf16 a[136:139], v[120:123], a[36:39], a[136:139]
    v_mfma_f32_16x16x32_bf16 a[156:159], v[124:127], a[36:39], a[156:159]
    buffer_load_dwordx4 a[36:39], v10, s[60:63], s79 offen offset:1024 sc1
    s_waitcnt lgkmcnt(0)
    s_waitcnt vmcnt(17)
    v_mfma_f32_16x16x32_bf16 a[80:83], v[96:99], a[0:3], a[80:83]
    s_add_u32 s79, s79, 40960
    s_cmp_ge_u32 s12, 1
    v_mfma_f32_16x16x32_bf16 a[100:103], v[100:103], a[0:3], a[100:103]
    s_cselect_b32 s78, s75, 0
    s_add_u32 s78, s78, s74
    v_mfma_f32_16x16x32_bf16 a[120:123], v[104:107], a[0:3], a[120:123]
    s_add_u32 s78, s78, 1548288
    s_add_u32 m0, s72, 24576
    v_mfma_f32_16x16x32_bf16 a[140:143], v[108:111], a[0:3], a[140:143]
    buffer_load_dwordx4 a[0:3], v10, s[60:63], s79 offen sc1
    s_waitcnt vmcnt(16)
    v_mfma_f32_16x16x32_bf16 a[84:87], v[96:99], a[4:7], a[84:87]
    ds_read_b64_tr_b16 v[112:113], v6 offset:28672
    v_mfma_f32_16x16x32_bf16 a[104:107], v[100:103], a[4:7], a[104:107]
    buffer_load_dwordx4 v2, s[52:55], s78 offen lds
    v_mfma_f32_16x16x32_bf16 a[124:127], v[104:107], a[4:7], a[124:127]
    ds_read_b64_tr_b16 v[114:115], v6 offset:29184
    ds_read_b64_tr_b16 v[116:117], v7 offset:28672
    v_mfma_f32_16x16x32_bf16 a[144:147], v[108:111], a[4:7], a[144:147]
    buffer_load_dwordx4 a[4:7], v10, s[60:63], s79 offen offset:256 sc1
    s_waitcnt vmcnt(16)
    v_mfma_f32_16x16x32_bf16 a[88:91], v[96:99], a[8:11], a[88:91]
    ds_read_b64_tr_b16 v[118:119], v7 offset:29184
    v_mfma_f32_16x16x32_bf16 a[108:111], v[100:103], a[8:11], a[108:111]
    buffer_load_dwordx4 v3, s[52:55], s78 offen offset:1024 lds
    v_mfma_f32_16x16x32_bf16 a[128:131], v[104:107], a[8:11], a[128:131]
    ds_read_b64_tr_b16 v[120:121], v8 offset:28672
    ds_read_b64_tr_b16 v[122:123], v8 offset:29184
    v_mfma_f32_16x16x32_bf16 a[148:151], v[108:111], a[8:11], a[148:151]
    buffer_load_dwordx4 a[8:11], v10, s[60:63], s79 offen offset:512 sc1
    s_waitcnt vmcnt(16)
    v_mfma_f32_16x16x32_bf16 a[92:95], v[96:99], a[12:15], a[92:95]
    ds_read_b64_tr_b16 v[124:125], v9 offset:28672
    v_mfma_f32_16x16x32_bf16 a[112:115], v[100:103], a[12:15], a[112:115]
    buffer_load_dwordx4 v4, s[52:55], s78 offen offset:2048 lds
    v_mfma_f32_16x16x32_bf16 a[132:135], v[104:107], a[12:15], a[132:135]
    ds_read_b64_tr_b16 v[126:127], v9 offset:29184
    v_mfma_f32_16x16x32_bf16 a[152:155], v[108:111], a[12:15], a[152:155]
    buffer_load_dwordx4 a[12:15], v10, s[60:63], s79 offen offset:768 sc1
    s_waitcnt vmcnt(16)
    v_mfma_f32_16x16x32_bf16 a[96:99], v[96:99], a[16:19], a[96:99]
    buffer_load_dwordx4 v5, s[52:55], s78 offen offset:3072 lds
    v_mfma_f32_16x16x32_bf16 a[116:119], v[100:103], a[16:19], a[116:119]
    v_mfma_f32_16x16x32_bf16 a[136:139], v[104:107], a[16:19], a[136:139]
    v_mfma_f32_16x16x32_bf16 a[156:159], v[108:111], a[16:19], a[156:159]
    buffer_load_dwordx4 a[16:19], v10, s[60:63], s79 offen offset:1024 sc1
    s_waitcnt lgkmcnt(0)
    s_waitcnt vmcnt(17)
    v_mfma_f32_16x16x32_bf16 a[80:83], v[112:115], a[20:23], a[80:83]
    s_add_u32 s79, s79, 40960
    ds_read_b64_tr_b16 v[96:97], v6 offset:0
    v_mfma_f32_16x16x32_bf16 a[100:103], v[116:119], a[20:23], a[100:103]
    ds_read_b64_tr_b16 v[98:99], v6 offset:512
    ds_read_b64_tr_b16 v[100:101], v7 offset:0
    v_mfma_f32_16x16x32_bf16 a[120:123], v[120:123], a[20:23], a[120:123]
    v_mfma_f32_16x16x32_bf16 a[140:143], v[124:127], a[20:23], a[140:143]
    buffer_load_dwordx4 a[20:23], v10, s[60:63], s79 offen sc1
    s_waitcnt vmcnt(16)
    v_mfma_f32_16x16x32_bf16 a[84:87], v[112:115], a[24:27], a[84:87]
    ds_read_b64_tr_b16 v[102:103], v7 offset:512
    ds_read_b64_tr_b16 v[104:105], v8 offset:0
    v_mfma_f32_16x16x32_bf16 a[104:107], v[116:119], a[24:27], a[104:107]
    ds_read_b64_tr_b16 v[106:107], v8 offset:512
    v_mfma_f32_16x16x32_bf16 a[124:127], v[120:123], a[24:27], a[124:127]
    v_mfma_f32_16x16x32_bf16 a[144:147], v[124:127], a[24:27], a[144:147]
    buffer_load_dwordx4 a[24:27], v10, s[60:63], s79 offen offset:256 sc1
    s_waitcnt vmcnt(15)
    v_mfma_f32_16x16x32_bf16 a[88:91], v[112:115], a[28:31], a[88:91]
    s_mul_i32 s74, s3, 1703936
    s_lshl_b32 s15, s8, 7
    v_mfma_f32_16x16x32_bf16 a[108:111], v[116:119], a[28:31], a[108:111]
    s_add_u32 s74, s74, s15
    v_lshrrev_b32 v20, 3, v0
    v_mfma_f32_16x16x32_bf16 a[128:131], v[120:123], a[28:31], a[128:131]
    v_mul_u32_u24 v20, 4096, v20
    v_and_b32 v21, 7, v0
    v_mfma_f32_16x16x32_bf16 a[148:151], v[124:127], a[28:31], a[148:151]
    buffer_load_dwordx4 a[28:31], v10, s[60:63], s79 offen offset:512 sc1
    s_waitcnt vmcnt(14)
    v_mfma_f32_16x16x32_bf16 a[92:95], v[112:115], a[32:35], a[92:95]
    v_bfe_u32 v22, v0, 4, 1
    v_lshlrev_b32 v22, 1, v22
    v_mfma_f32_16x16x32_bf16 a[112:115], v[116:119], a[32:35], a[112:115]
    v_xor_b32 v21, v21, v22
    v_xor_b32 v22, 0, v21
    v_mfma_f32_16x16x32_bf16 a[132:135], v[120:123], a[32:35], a[132:135]
    v_lshl_add_u32 v2, v22, 4, v20
    v_xor_b32 v22, 4, v21
    v_mfma_f32_16x16x32_bf16 a[152:155], v[124:127], a[32:35], a[152:155]
    buffer_load_dwordx4 a[32:35], v10, s[60:63], s79 offen offset:768 sc1
    s_waitcnt vmcnt(13)
    v_mfma_f32_16x16x32_bf16 a[96:99], v[112:115], a[36:39], a[96:99]
    v_lshl_add_u32 v3, v22, 4, v20
    v_add_u32 v3, 31744, v3
    v_mfma_f32_16x16x32_bf16 a[116:119], v[116:119], a[36:39], a[116:119]
    v_xor_b32 v22, 0, v21
    v_lshl_add_u32 v4, v22, 4, v20
    v_mfma_f32_16x16x32_bf16 a[136:139], v[120:123], a[36:39], a[136:139]
    v_add_u32 v4, 63488, v4
    v_xor_b32 v22, 4, v21
    v_mfma_f32_16x16x32_bf16 a[156:159], v[124:127], a[36:39], a[156:159]
    buffer_load_dwordx4 a[36:39], v10, s[60:63], s79 offen offset:1024 sc1
    v_lshl_add_u32 v5, v22, 4, v20
    v_add_u32 v5, 95232, v5
    ds_read_b64_tr_b16 v[108:109], v9 offset:0
    ds_read_b64_tr_b16 v[110:111], v9 offset:512
    s_waitcnt lgkmcnt(0)
    s_waitcnt vmcnt(13)
    v_mfma_f32_16x16x32_bf16 a[80:83], v[96:99], a[0:3], a[80:83]
    s_cmp_ge_u32 s12, 5
    s_cselect_b32 s79, s77, 0
    v_mfma_f32_16x16x32_bf16 a[100:103], v[100:103], a[0:3], a[100:103]
    s_add_u32 s79, s79, s76
    s_add_u32 s79, s79, 409600
    v_mfma_f32_16x16x32_bf16 a[120:123], v[104:107], a[0:3], a[120:123]
    ds_read_b64_tr_b16 v[112:113], v6 offset:4096
    ds_read_b64_tr_b16 v[114:115], v6 offset:4608
    v_mfma_f32_16x16x32_bf16 a[140:143], v[108:111], a[0:3], a[140:143]
    buffer_load_dwordx4 a[0:3], v10, s[60:63], s79 offen sc1
    s_waitcnt vmcnt(12)
    v_mfma_f32_16x16x32_bf16 a[84:87], v[96:99], a[4:7], a[84:87]
    ds_read_b64_tr_b16 v[116:117], v7 offset:4096
    ds_read_b64_tr_b16 v[118:119], v7 offset:4608
    v_mfma_f32_16x16x32_bf16 a[104:107], v[100:103], a[4:7], a[104:107]
    ds_read_b64_tr_b16 v[120:121], v8 offset:4096
    ds_read_b64_tr_b16 v[122:123], v8 offset:4608
    v_mfma_f32_16x16x32_bf16 a[124:127], v[104:107], a[4:7], a[124:127]
    v_mfma_f32_16x16x32_bf16 a[144:147], v[108:111], a[4:7], a[144:147]
    buffer_load_dwordx4 a[4:7], v10, s[60:63], s79 offen offset:256 sc1
    s_waitcnt vmcnt(11)
    v_mfma_f32_16x16x32_bf16 a[88:91], v[96:99], a[8:11], a[88:91]
    ds_read_b64_tr_b16 v[124:125], v9 offset:4096
    ds_read_b64_tr_b16 v[126:127], v9 offset:4608
    v_mfma_f32_16x16x32_bf16 a[108:111], v[100:103], a[8:11], a[108:111]
    v_mfma_f32_16x16x32_bf16 a[128:131], v[104:107], a[8:11], a[128:131]
    v_mfma_f32_16x16x32_bf16 a[148:151], v[108:111], a[8:11], a[148:151]
    buffer_load_dwordx4 a[8:11], v10, s[60:63], s79 offen offset:512 sc1
    s_waitcnt vmcnt(10)
    v_mfma_f32_16x16x32_bf16 a[92:95], v[96:99], a[12:15], a[92:95]
    v_mfma_f32_16x16x32_bf16 a[112:115], v[100:103], a[12:15], a[112:115]
    v_mfma_f32_16x16x32_bf16 a[132:135], v[104:107], a[12:15], a[132:135]
    v_mfma_f32_16x16x32_bf16 a[152:155], v[108:111], a[12:15], a[152:155]
    buffer_load_dwordx4 a[12:15], v10, s[60:63], s79 offen offset:768 sc1
    s_waitcnt vmcnt(9)
    v_mfma_f32_16x16x32_bf16 a[96:99], v[96:99], a[16:19], a[96:99]
    v_mfma_f32_16x16x32_bf16 a[116:119], v[100:103], a[16:19], a[116:119]
    v_mfma_f32_16x16x32_bf16 a[136:139], v[104:107], a[16:19], a[136:139]
    v_mfma_f32_16x16x32_bf16 a[156:159], v[108:111], a[16:19], a[156:159]
    buffer_load_dwordx4 a[16:19], v10, s[60:63], s79 offen offset:1024 sc1
    s_waitcnt lgkmcnt(0)
    s_waitcnt vmcnt(9)
    v_mfma_f32_16x16x32_bf16 a[80:83], v[112:115], a[20:23], a[80:83]
    s_cmp_ge_u32 s12, 4
    s_cselect_b32 s79, s77, 0
    v_mfma_f32_16x16x32_bf16 a[100:103], v[116:119], a[20:23], a[100:103]
    s_add_u32 s79, s79, s76
    s_add_u32 s79, s79, 450560
    v_mfma_f32_16x16x32_bf16 a[120:123], v[120:123], a[20:23], a[120:123]
    ds_read_b64_tr_b16 v[96:97], v6 offset:8192
    ds_read_b64_tr_b16 v[98:99], v6 offset:8704
    v_mfma_f32_16x16x32_bf16 a[140:143], v[124:127], a[20:23], a[140:143]
    buffer_load_dwordx4 a[20:23], v10, s[60:63], s79 offen sc1
    s_waitcnt vmcnt(9)
    v_mfma_f32_16x16x32_bf16 a[84:87], v[112:115], a[24:27], a[84:87]
    ds_read_b64_tr_b16 v[100:101], v7 offset:8192
    ds_read_b64_tr_b16 v[102:103], v7 offset:8704
    v_mfma_f32_16x16x32_bf16 a[104:107], v[116:119], a[24:27], a[104:107]
    ds_read_b64_tr_b16 v[104:105], v8 offset:8192
    ds_read_b64_tr_b16 v[106:107], v8 offset:8704
    v_mfma_f32_16x16x32_bf16 a[124:127], v[120:123], a[24:27], a[124:127]
    v_mfma_f32_16x16x32_bf16 a[144:147], v[124:127], a[24:27], a[144:147]
    buffer_load_dwordx4 a[24:27], v10, s[60:63], s79 offen offset:256 sc1
    s_waitcnt vmcnt(9)
    v_mfma_f32_16x16x32_bf16 a[88:91], v[112:115], a[28:31], a[88:91]
    ds_read_b64_tr_b16 v[108:109], v9 offset:8192
    ds_read_b64_tr_b16 v[110:111], v9 offset:8704
    v_mfma_f32_16x16x32_bf16 a[108:111], v[116:119], a[28:31], a[108:111]
    v_mfma_f32_16x16x32_bf16 a[128:131], v[120:123], a[28:31], a[128:131]
    v_mfma_f32_16x16x32_bf16 a[148:151], v[124:127], a[28:31], a[148:151]
    buffer_load_dwordx4 a[28:31], v10, s[60:63], s79 offen offset:512 sc1
    s_waitcnt vmcnt(9)
    v_mfma_f32_16x16x32_bf16 a[92:95], v[112:115], a[32:35], a[92:95]
    v_mfma_f32_16x16x32_bf16 a[112:115], v[116:119], a[32:35], a[112:115]
    v_mfma_f32_16x16x32_bf16 a[132:135], v[120:123], a[32:35], a[132:135]
    v_mfma_f32_16x16x32_bf16 a[152:155], v[124:127], a[32:35], a[152:155]
    buffer_load_dwordx4 a[32:35], v10, s[60:63], s79 offen offset:768 sc1
    s_waitcnt vmcnt(9)
    v_mfma_f32_16x16x32_bf16 a[96:99], v[112:115], a[36:39], a[96:99]
    v_mfma_f32_16x16x32_bf16 a[116:119], v[116:119], a[36:39], a[116:119]
    v_mfma_f32_16x16x32_bf16 a[136:139], v[120:123], a[36:39], a[136:139]
    v_mfma_f32_16x16x32_bf16 a[156:159], v[124:127], a[36:39], a[156:159]
    buffer_load_dwordx4 a[36:39], v10, s[60:63], s79 offen offset:1024 sc1
    s_waitcnt lgkmcnt(0)
    s_waitcnt vmcnt(9)
    v_mfma_f32_16x16x32_bf16 a[80:83], v[96:99], a[0:3], a[80:83]
    s_add_u32 s79, s79, 40960
    ds_read_b64_tr_b16 v[112:113], v6 offset:12288
    v_mfma_f32_16x16x32_bf16 a[100:103], v[100:103], a[0:3], a[100:103]
    ds_read_b64_tr_b16 v[114:115], v6 offset:12800
    ds_read_b64_tr_b16 v[116:117], v7 offset:12288
    v_mfma_f32_16x16x32_bf16 a[120:123], v[104:107], a[0:3], a[120:123]
    v_mfma_f32_16x16x32_bf16 a[140:143], v[108:111], a[0:3], a[140:143]
    buffer_load_dwordx4 a[0:3], v10, s[60:63], s79 offen sc1
    s_waitcnt vmcnt(9)
    v_mfma_f32_16x16x32_bf16 a[84:87], v[96:99], a[4:7], a[84:87]
    ds_read_b64_tr_b16 v[118:119], v7 offset:12800
    ds_read_b64_tr_b16 v[120:121], v8 offset:12288
    v_mfma_f32_16x16x32_bf16 a[104:107], v[100:103], a[4:7], a[104:107]
    ds_read_b64_tr_b16 v[122:123], v8 offset:12800
    v_mfma_f32_16x16x32_bf16 a[124:127], v[104:107], a[4:7], a[124:127]
    v_mfma_f32_16x16x32_bf16 a[144:147], v[108:111], a[4:7], a[144:147]
    buffer_load_dwordx4 a[4:7], v10, s[60:63], s79 offen offset:256 sc1
    s_waitcnt vmcnt(9)
    v_mfma_f32_16x16x32_bf16 a[88:91], v[96:99], a[8:11], a[88:91]
    ds_read_b64_tr_b16 v[124:125], v9 offset:12288
    ds_read_b64_tr_b16 v[126:127], v9 offset:12800
    v_mfma_f32_16x16x32_bf16 a[108:111], v[100:103], a[8:11], a[108:111]
    v_mfma_f32_16x16x32_bf16 a[128:131], v[104:107], a[8:11], a[128:131]
    v_mfma_f32_16x16x32_bf16 a[148:151], v[108:111], a[8:11], a[148:151]
    buffer_load_dwordx4 a[8:11], v10, s[60:63], s79 offen offset:512 sc1
    s_waitcnt vmcnt(9)
    v_mfma_f32_16x16x32_bf16 a[92:95], v[96:99], a[12:15], a[92:95]
    v_mfma_f32_16x16x32_bf16 a[112:115], v[100:103], a[12:15], a[112:115]
    v_mfma_f32_16x16x32_bf16 a[132:135], v[104:107], a[12:15], a[132:135]
    v_mfma_f32_16x16x32_bf16 a[152:155], v[108:111], a[12:15], a[152:155]
    buffer_load_dwordx4 a[12:15], v10, s[60:63], s79 offen offset:768 sc1
    s_waitcnt vmcnt(9)
    v_mfma_f32_16x16x32_bf16 a[96:99], v[96:99], a[16:19], a[96:99]
    v_mfma_f32_16x16x32_bf16 a[116:119], v[100:103], a[16:19], a[116:119]
    v_mfma_f32_16x16x32_bf16 a[136:139], v[104:107], a[16:19], a[136:139]
    v_mfma_f32_16x16x32_bf16 a[156:159], v[108:111], a[16:19], a[156:159]
    buffer_load_dwordx4 a[16:19], v10, s[60:63], s79 offen offset:1024 sc1
    s_waitcnt lgkmcnt(0)
    s_waitcnt vmcnt(9)
    v_mfma_f32_16x16x32_bf16 a[80:83], v[112:115], a[20:23], a[80:83]
    s_add_u32 s79, s79, 40960
    ds_read_b64_tr_b16 v[96:97], v6 offset:16384
    v_mfma_f32_16x16x32_bf16 a[100:103], v[116:119], a[20:23], a[100:103]
    ds_read_b64_tr_b16 v[98:99], v6 offset:16896
    ds_read_b64_tr_b16 v[100:101], v7 offset:16384
    v_mfma_f32_16x16x32_bf16 a[120:123], v[120:123], a[20:23], a[120:123]
    v_mfma_f32_16x16x32_bf16 a[140:143], v[124:127], a[20:23], a[140:143]
    buffer_load_dwordx4 a[20:23], v10, s[60:63], s79 offen sc1
    s_waitcnt vmcnt(9)
    v_mfma_f32_16x16x32_bf16 a[84:87], v[112:115], a[24:27], a[84:87]
    ds_read_b64_tr_b16 v[102:103], v7 offset:16896
    ds_read_b64_tr_b16 v[104:105], v8 offset:16384
    v_mfma_f32_16x16x32_bf16 a[104:107], v[116:119], a[24:27], a[104:107]
    ds_read_b64_tr_b16 v[106:107], v8 offset:16896
    v_mfma_f32_16x16x32_bf16 a[124:127], v[120:123], a[24:27], a[124:127]
    v_mfma_f32_16x16x32_bf16 a[144:147], v[124:127], a[24:27], a[144:147]
    buffer_load_dwordx4 a[24:27], v10, s[60:63], s79 offen offset:256 sc1
    s_waitcnt vmcnt(9)
    v_mfma_f32_16x16x32_bf16 a[88:91], v[112:115], a[28:31], a[88:91]
    ds_read_b64_tr_b16 v[108:109], v9 offset:16384
    ds_read_b64_tr_b16 v[110:111], v9 offset:16896
    v_mfma_f32_16x16x32_bf16 a[108:111], v[116:119], a[28:31], a[108:111]
    v_mfma_f32_16x16x32_bf16 a[128:131], v[120:123], a[28:31], a[128:131]
    v_mfma_f32_16x16x32_bf16 a[148:151], v[124:127], a[28:31], a[148:151]
    buffer_load_dwordx4 a[28:31], v10, s[60:63], s79 offen offset:512 sc1
    s_waitcnt vmcnt(9)
    v_mfma_f32_16x16x32_bf16 a[92:95], v[112:115], a[32:35], a[92:95]
    v_mfma_f32_16x16x32_bf16 a[112:115], v[116:119], a[32:35], a[112:115]
    v_mfma_f32_16x16x32_bf16 a[132:135], v[120:123], a[32:35], a[132:135]
    v_mfma_f32_16x16x32_bf16 a[152:155], v[124:127], a[32:35], a[152:155]
    buffer_load_dwordx4 a[32:35], v10, s[60:63], s79 offen offset:768 sc1
    s_waitcnt vmcnt(9)
    v_mfma_f32_16x16x32_bf16 a[96:99], v[112:115], a[36:39], a[96:99]
    v_mfma_f32_16x16x32_bf16 a[116:119], v[116:119], a[36:39], a[116:119]
    v_mfma_f32_16x16x32_bf16 a[136:139], v[120:123], a[36:39], a[136:139]
    v_mfma_f32_16x16x32_bf16 a[156:159], v[124:127], a[36:39], a[156:159]
    buffer_load_dwordx4 a[36:39], v10, s[60:63], s79 offen offset:1024 sc1
    s_waitcnt lgkmcnt(0)
    s_waitcnt vmcnt(9)
    v_mfma_f32_16x16x32_bf16 a[80:83], v[96:99], a[0:3], a[80:83]
    s_cmp_ge_u32 s12, 1
    s_cselect_b32 s79, s77, 0
    v_mfma_f32_16x16x32_bf16 a[100:103], v[100:103], a[0:3], a[100:103]
    s_add_u32 s79, s79, s76
    s_add_u32 s79, s79, 573440
    v_mfma_f32_16x16x32_bf16 a[120:123], v[104:107], a[0:3], a[120:123]
    ds_read_b64_tr_b16 v[112:113], v6 offset:20480
    ds_read_b64_tr_b16 v[114:115], v6 offset:20992
    v_mfma_f32_16x16x32_bf16 a[140:143], v[108:111], a[0:3], a[140:143]
    buffer_load_dwordx4 a[0:3], v10, s[60:63], s79 offen sc1
    s_waitcnt vmcnt(9)
    v_mfma_f32_16x16x32_bf16 a[84:87], v[96:99], a[4:7], a[84:87]
    ds_read_b64_tr_b16 v[116:117], v7 offset:20480
    ds_read_b64_tr_b16 v[118:119], v7 offset:20992
    v_mfma_f32_16x16x32_bf16 a[104:107], v[100:103], a[4:7], a[104:107]
    ds_read_b64_tr_b16 v[120:121], v8 offset:20480
    ds_read_b64_tr_b16 v[122:123], v8 offset:20992
    v_mfma_f32_16x16x32_bf16 a[124:127], v[104:107], a[4:7], a[124:127]
    v_mfma_f32_16x16x32_bf16 a[144:147], v[108:111], a[4:7], a[144:147]
    buffer_load_dwordx4 a[4:7], v10, s[60:63], s79 offen offset:256 sc1
    s_waitcnt vmcnt(9)
    v_mfma_f32_16x16x32_bf16 a[88:91], v[96:99], a[8:11], a[88:91]
    ds_read_b64_tr_b16 v[124:125], v9 offset:20480
    ds_read_b64_tr_b16 v[126:127], v9 offset:20992
    v_mfma_f32_16x16x32_bf16 a[108:111], v[100:103], a[8:11], a[108:111]
    v_mfma_f32_16x16x32_bf16 a[128:131], v[104:107], a[8:11], a[128:131]
    v_mfma_f32_16x16x32_bf16 a[148:151], v[108:111], a[8:11], a[148:151]
    buffer_load_dwordx4 a[8:11], v10, s[60:63], s79 offen offset:512 sc1
    s_waitcnt vmcnt(9)
    v_mfma_f32_16x16x32_bf16 a[92:95], v[96:99], a[12:15], a[92:95]
    v_mfma_f32_16x16x32_bf16 a[112:115], v[100:103], a[12:15], a[112:115]
    v_mfma_f32_16x16x32_bf16 a[132:135], v[104:107], a[12:15], a[132:135]
    v_mfma_f32_16x16x32_bf16 a[152:155], v[108:111], a[12:15], a[152:155]
    buffer_load_dwordx4 a[12:15], v10, s[60:63], s79 offen offset:768 sc1
    s_waitcnt vmcnt(9)
    v_mfma_f32_16x16x32_bf16 a[96:99], v[96:99], a[16:19], a[96:99]
    v_mfma_f32_16x16x32_bf16 a[116:119], v[100:103], a[16:19], a[116:119]
    v_mfma_f32_16x16x32_bf16 a[136:139], v[104:107], a[16:19], a[136:139]
    v_mfma_f32_16x16x32_bf16 a[156:159], v[108:111], a[16:19], a[156:159]
    buffer_load_dwordx4 a[16:19], v10, s[60:63], s79 offen offset:1024 sc1
    s_waitcnt lgkmcnt(0)
    s_waitcnt vmcnt(9)
    v_mfma_f32_16x16x32_bf16 a[80:83], v[112:115], a[20:23], a[80:83]
    ds_read_b64_tr_b16 v[96:97], v6 offset:24576
    ds_read_b64_tr_b16 v[98:99], v6 offset:25088
    v_mfma_f32_16x16x32_bf16 a[100:103], v[116:119], a[20:23], a[100:103]
    ds_read_b64_tr_b16 v[100:101], v7 offset:24576
    v_mfma_f32_16x16x32_bf16 a[120:123], v[120:123], a[20:23], a[120:123]
    v_mfma_f32_16x16x32_bf16 a[140:143], v[124:127], a[20:23], a[140:143]
    s_waitcnt vmcnt(8)
    v_mfma_f32_16x16x32_bf16 a[84:87], v[112:115], a[24:27], a[84:87]
    ds_read_b64_tr_b16 v[102:103], v7 offset:25088
    ds_read_b64_tr_b16 v[104:105], v8 offset:24576
    v_mfma_f32_16x16x32_bf16 a[104:107], v[116:119], a[24:27], a[104:107]
    ds_read_b64_tr_b16 v[106:107], v8 offset:25088
    v_mfma_f32_16x16x32_bf16 a[124:127], v[120:123], a[24:27], a[124:127]
    v_mfma_f32_16x16x32_bf16 a[144:147], v[124:127], a[24:27], a[144:147]
    s_waitcnt vmcnt(7)
    v_mfma_f32_16x16x32_bf16 a[88:91], v[112:115], a[28:31], a[88:91]
    ds_read_b64_tr_b16 v[108:109], v9 offset:24576
    ds_read_b64_tr_b16 v[110:111], v9 offset:25088
    v_mfma_f32_16x16x32_bf16 a[108:111], v[116:119], a[28:31], a[108:111]
    v_mfma_f32_16x16x32_bf16 a[128:131], v[120:123], a[28:31], a[128:131]
    v_mfma_f32_16x16x32_bf16 a[148:151], v[124:127], a[28:31], a[148:151]
    s_waitcnt vmcnt(6)
    v_mfma_f32_16x16x32_bf16 a[92:95], v[112:115], a[32:35], a[92:95]
    v_mfma_f32_16x16x32_bf16 a[112:115], v[116:119], a[32:35], a[112:115]
    v_mfma_f32_16x16x32_bf16 a[132:135], v[120:123], a[32:35], a[132:135]
    v_mfma_f32_16x16x32_bf16 a[152:155], v[124:127], a[32:35], a[152:155]
    s_waitcnt vmcnt(5)
    v_mfma_f32_16x16x32_bf16 a[96:99], v[112:115], a[36:39], a[96:99]
    v_mfma_f32_16x16x32_bf16 a[116:119], v[116:119], a[36:39], a[116:119]
    v_mfma_f32_16x16x32_bf16 a[136:139], v[120:123], a[36:39], a[136:139]
    v_mfma_f32_16x16x32_bf16 a[156:159], v[124:127], a[36:39], a[156:159]
    s_waitcnt lgkmcnt(0)
    s_waitcnt vmcnt(4)
    v_mfma_f32_16x16x32_bf16 a[100:103], v[100:103], a[0:3], a[100:103]
    s_waitcnt vmcnt(3)
    v_mfma_f32_16x16x32_bf16 a[104:107], v[100:103], a[4:7], a[104:107]
    s_waitcnt vmcnt(2)
    v_mfma_f32_16x16x32_bf16 a[108:111], v[100:103], a[8:11], a[108:111]
    s_waitcnt vmcnt(1)
    v_mfma_f32_16x16x32_bf16 a[112:115], v[100:103], a[12:15], a[112:115]
    s_waitcnt vmcnt(0)
    v_mfma_f32_16x16x32_bf16 a[116:119], v[100:103], a[16:19], a[116:119]
    s_add_u32 s78, s74, 0
    s_add_u32 m0, s72, 16384
    s_nop 0
    buffer_load_dwordx4 v2, s[56:59], s78 offen lds
    v_mfma_f32_16x16x32_bf16 a[120:123], v[104:107], a[0:3], a[120:123]
    ds_write_b128 v11, a[100:103] offset:0
    v_mfma_f32_16x16x32_bf16 a[124:127], v[104:107], a[4:7], a[124:127]
    ds_write_b128 v11, a[104:107] offset:1024
    v_mfma_f32_16x16x32_bf16 a[128:131], v[104:107], a[8:11], a[128:131]
    ds_write_b128 v11, a[108:111] offset:2048
    v_mfma_f32_16x16x32_bf16 a[132:135], v[104:107], a[12:15], a[132:135]
    ds_write_b128 v11, a[112:115] offset:3072
    v_mfma_f32_16x16x32_bf16 a[136:139], v[104:107], a[16:19], a[136:139]
    ds_write_b128 v11, a[116:119] offset:4096
    buffer_load_dwordx4 v3, s[56:59], s78 offen offset:1024 lds
    v_mfma_f32_16x16x32_bf16 a[140:143], v[108:111], a[0:3], a[140:143]
    ds_write_b128 v11, a[120:123] offset:5120
    v_mfma_f32_16x16x32_bf16 a[144:147], v[108:111], a[4:7], a[144:147]
    ds_write_b128 v11, a[124:127] offset:6144
    v_mfma_f32_16x16x32_bf16 a[148:151], v[108:111], a[8:11], a[148:151]
    ds_write_b128 v11, a[128:131] offset:7168
    v_mfma_f32_16x16x32_bf16 a[152:155], v[108:111], a[12:15], a[152:155]
    ds_write_b128 v11, a[132:135] offset:8192
    v_mfma_f32_16x16x32_bf16 a[156:159], v[108:111], a[16:19], a[156:159]
    ds_write_b128 v11, a[136:139] offset:9216
    buffer_load_dwordx4 v4, s[56:59], s78 offen offset:2048 lds
    v_mfma_f32_16x16x32_bf16 a[80:83], v[96:99], a[0:3], a[80:83]
    ds_write_b128 v11, a[140:143] offset:10240
    v_mfma_f32_16x16x32_bf16 a[84:87], v[96:99], a[4:7], a[84:87]
    v_mfma_f32_16x16x32_bf16 a[88:91], v[96:99], a[8:11], a[88:91]
    v_mfma_f32_16x16x32_bf16 a[92:95], v[96:99], a[12:15], a[92:95]
    v_mfma_f32_16x16x32_bf16 a[96:99], v[96:99], a[16:19], a[96:99]
    buffer_load_dwordx4 v5, s[56:59], s78 offen offset:3072 lds
    ds_write_b128 v11, a[144:147] offset:11264
    ds_write_b128 v11, a[148:151] offset:12288
    ds_write_b128 v11, a[152:155] offset:13312
    ds_write_b128 v11, a[156:159] offset:14336
    s_branch L_loop1e
L_loop1c:
    ds_read_b64_tr_b16 v[96:97], v6 offset:0
    ds_read_b64_tr_b16 v[98:99], v6 offset:512
    ds_read_b64_tr_b16 v[100:101], v7 offset:0
    ds_read_b64_tr_b16 v[102:103], v7 offset:512
    ds_read_b64_tr_b16 v[104:105], v8 offset:0
    ds_read_b64_tr_b16 v[106:107], v8 offset:512
    ds_read_b64_tr_b16 v[108:109], v9 offset:0
    ds_read_b64_tr_b16 v[110:111], v9 offset:512
    s_waitcnt lgkmcnt(0)
    s_waitcnt vmcnt(9)
    v_mfma_f32_16x16x32_bf16 a[80:83], v[96:99], a[0:3], 0
    s_add_u32 s79, s79, 40960
    ds_read_b64_tr_b16 v[112:113], v6 offset:4096
    v_mfma_f32_16x16x32_bf16 a[100:103], v[100:103], a[0:3], 0
    ds_read_b64_tr_b16 v[114:115], v6 offset:4608
    ds_read_b64_tr_b16 v[116:117], v7 offset:4096
    v_mfma_f32_16x16x32_bf16 a[120:123], v[104:107], a[0:3], 0
    v_mfma_f32_16x16x32_bf16 a[140:143], v[108:111], a[0:3], 0
    buffer_load_dwordx4 a[0:3], v10, s[60:63], s79 offen sc1
    s_waitcnt vmcnt(9)
    v_mfma_f32_16x16x32_bf16 a[84:87], v[96:99], a[4:7], 0
    ds_read_b64_tr_b16 v[118:119], v7 offset:4608
    ds_read_b64_tr_b16 v[120:121], v8 offset:4096
    v_mfma_f32_16x16x32_bf16 a[104:107], v[100:103], a[4:7], 0
    ds_read_b64_tr_b16 v[122:123], v8 offset:4608
    v_mfma_f32_16x16x32_bf16 a[124:127], v[104:107], a[4:7], 0
    v_mfma_f32_16x16x32_bf16 a[144:147], v[108:111], a[4:7], 0
    buffer_load_dwordx4 a[4:7], v10, s[60:63], s79 offen offset:256 sc1
    s_waitcnt vmcnt(9)
    v_mfma_f32_16x16x32_bf16 a[88:91], v[96:99], a[8:11], 0
    ds_read_b64_tr_b16 v[124:125], v9 offset:4096
    ds_read_b64_tr_b16 v[126:127], v9 offset:4608
    v_mfma_f32_16x16x32_bf16 a[108:111], v[100:103], a[8:11], 0
    ds_write_b128 v11, a[40:43] offset:0
    ds_write_b128 v11, a[44:47] offset:1024
    v_mfma_f32_16x16x32_bf16 a[128:131], v[104:107], a[8:11], 0
    v_mfma_f32_16x16x32_bf16 a[148:151], v[108:111], a[8:11], 0
    buffer_load_dwordx4 a[8:11], v10, s[60:63], s79 offen offset:512 sc1
    s_waitcnt vmcnt(9)
    v_mfma_f32_16x16x32_bf16 a[92:95], v[96:99], a[12:15], 0
    ds_write_b128 v11, a[48:51] offset:2048
    v_mfma_f32_16x16x32_bf16 a[112:115], v[100:103], a[12:15], 0
    v_mfma_f32_16x16x32_bf16 a[132:135], v[104:107], a[12:15], 0
    v_mfma_f32_16x16x32_bf16 a[152:155], v[108:111], a[12:15], 0
    buffer_load_dwordx4 a[12:15], v10, s[60:63], s79 offen offset:768 sc1
    s_waitcnt vmcnt(9)
    v_mfma_f32_16x16x32_bf16 a[96:99], v[96:99], a[16:19], 0
    ds_write_b128 v11, a[52:55] offset:3072
    v_mfma_f32_16x16x32_bf16 a[116:119], v[100:103], a[16:19], 0
    v_mfma_f32_16x16x32_bf16 a[136:139], v[104:107], a[16:19], 0
    v_mfma_f32_16x16x32_bf16 a[156:159], v[108:111], a[16:19], 0
    buffer_load_dwordx4 a[16:19], v10, s[60:63], s79 offen offset:1024 sc1
    s_waitcnt lgkmcnt(4)
    s_waitcnt vmcnt(9)
    v_mfma_f32_16x16x32_bf16 a[80:83], v[112:115], a[20:23], a[80:83]
    s_cmp_ge_u32 s12, 16
    s_cselect_b32 s79, s77, 0
    v_mfma_f32_16x16x32_bf16 a[100:103], v[116:119], a[20:23], a[100:103]
    s_add_u32 s79, s79, s76
    s_add_u32 s79, s79, 122880
    v_mfma_f32_16x16x32_bf16 a[120:123], v[120:123], a[20:23], a[120:123]
    ds_read_b64_tr_b16 v[96:97], v6 offset:8192
    ds_read_b64_tr_b16 v[98:99], v6 offset:8704
    v_mfma_f32_16x16x32_bf16 a[140:143], v[124:127], a[20:23], a[140:143]
    buffer_load_dwordx4 a[20:23], v10, s[60:63], s79 offen sc1
    s_waitcnt vmcnt(9)
    v_mfma_f32_16x16x32_bf16 a[84:87], v[112:115], a[24:27], a[84:87]
    ds_read_b64_tr_b16 v[100:101], v7 offset:8192
    ds_read_b64_tr_b16 v[102:103], v7 offset:8704
    v_mfma_f32_16x16x32_bf16 a[104:107], v[116:119], a[24:27], a[104:107]
    ds_read_b64_tr_b16 v[104:105], v8 offset:8192
    ds_read_b64_tr_b16 v[106:107], v8 offset:8704
    v_mfma_f32_16x16x32_bf16 a[124:127], v[120:123], a[24:27], a[124:127]
    v_mfma_f32_16x16x32_bf16 a[144:147], v[124:127], a[24:27], a[144:147]
    buffer_load_dwordx4 a[24:27], v10, s[60:63], s79 offen offset:256 sc1
    s_waitcnt vmcnt(9)
    v_mfma_f32_16x16x32_bf16 a[88:91], v[112:115], a[28:31], a[88:91]
    ds_read_b64_tr_b16 v[108:109], v9 offset:8192
    ds_read_b64_tr_b16 v[110:111], v9 offset:8704
    v_mfma_f32_16x16x32_bf16 a[108:111], v[116:119], a[28:31], a[108:111]
    ds_write_b128 v11, a[56:59] offset:4096
    ds_write_b128 v11, a[60:63] offset:5120
    v_mfma_f32_16x16x32_bf16 a[128:131], v[120:123], a[28:31], a[128:131]
    v_mfma_f32_16x16x32_bf16 a[148:151], v[124:127], a[28:31], a[148:151]
    buffer_load_dwordx4 a[28:31], v10, s[60:63], s79 offen offset:512 sc1
    s_waitcnt vmcnt(9)
    v_mfma_f32_16x16x32_bf16 a[92:95], v[112:115], a[32:35], a[92:95]
    ds_write_b128 v11, a[64:67] offset:6144
    v_mfma_f32_16x16x32_bf16 a[112:115], v[116:119], a[32:35], a[112:115]
    v_mfma_f32_16x16x32_bf16 a[132:135], v[120:123], a[32:35], a[132:135]
    v_mfma_f32_16x16x32_bf16 a[152:155], v[124:127], a[32:35], a[152:155]
    buffer_load_dwordx4 a[32:35], v10, s[60:63], s79 offen offset:768 sc1
    s_waitcnt vmcnt(9)
    v_mfma_f32_16x16x32_bf16 a[96:99], v[112:115], a[36:39], a[96:99]
    ds_write_b128 v11, a[68:71] offset:7168
    v_mfma_f32_16x16x32_bf16 a[116:119], v[116:119], a[36:39], a[116:119]
    v_mfma_f32_16x16x32_bf16 a[136:139], v[120:123], a[36:39], a[136:139]
    v_mfma_f32_16x16x32_bf16 a[156:159], v[124:127], a[36:39], a[156:159]
    buffer_load_dwordx4 a[36:39], v10, s[60:63], s79 offen offset:1024 sc1
    s_waitcnt lgkmcnt(4)
    s_waitcnt vmcnt(9)
    v_mfma_f32_16x16x32_bf16 a[80:83], v[96:99], a[0:3], a[80:83]
    s_cmp_ge_u32 s12, 15
    s_cselect_b32 s79, s77, 0
    v_mfma_f32_16x16x32_bf16 a[100:103], v[100:103], a[0:3], a[100:103]
    s_add_u32 s79, s79, s76
    s_add_u32 s79, s79, 163840
    v_mfma_f32_16x16x32_bf16 a[120:123], v[104:107], a[0:3], a[120:123]
    s_cmp_ge_u32 s12, 9
    s_cselect_b32 s78, s75, 0
    v_mfma_f32_16x16x32_bf16 a[140:143], v[108:111], a[0:3], a[140:143]
    s_add_u32 s78, s78, s74
    s_add_u32 s78, s78, 1105920
    s_waitcnt vmcnt(8)
    v_mfma_f32_16x16x32_bf16 a[84:87], v[96:99], a[4:7], a[84:87]
    s_add_u32 m0, s72, 8192
    v_mfma_f32_16x16x32_bf16 a[104:107], v[100:103], a[4:7], a[104:107]
    buffer_load_dwordx4 a[0:3], v10, s[60:63], s79 offen sc1
    v_mfma_f32_16x16x32_bf16 a[124:127], v[104:107], a[4:7], a[124:127]
    ds_read_b64_tr_b16 v[112:113], v6 offset:12288
    v_mfma_f32_16x16x32_bf16 a[144:147], v[108:111], a[4:7], a[144:147]
    buffer_load_dwordx4 a[4:7], v10, s[60:63], s79 offen offset:256 sc1
    s_waitcnt vmcnt(9)
    v_mfma_f32_16x16x32_bf16 a[88:91], v[96:99], a[8:11], a[88:91]
    buffer_load_dwordx4 v2, s[52:55], s78 offen lds
    v_mfma_f32_16x16x32_bf16 a[108:111], v[100:103], a[8:11], a[108:111]
    ds_read_b64_tr_b16 v[114:115], v6 offset:12800
    ds_read_b64_tr_b16 v[116:117], v7 offset:12288
    v_mfma_f32_16x16x32_bf16 a[128:131], v[104:107], a[8:11], a[128:131]
    ds_read_b64_tr_b16 v[118:119], v7 offset:12800
    v_mfma_f32_16x16x32_bf16 a[148:151], v[108:111], a[8:11], a[148:151]
    buffer_load_dwordx4 a[8:11], v10, s[60:63], s79 offen offset:512 sc1
    s_waitcnt vmcnt(10)
    v_mfma_f32_16x16x32_bf16 a[92:95], v[96:99], a[12:15], a[92:95]
    buffer_load_dwordx4 v3, s[52:55], s78 offen offset:1024 lds
    v_mfma_f32_16x16x32_bf16 a[112:115], v[100:103], a[12:15], a[112:115]
    ds_read_b64_tr_b16 v[120:121], v8 offset:12288
    ds_read_b64_tr_b16 v[122:123], v8 offset:12800
    v_mfma_f32_16x16x32_bf16 a[132:135], v[104:107], a[12:15], a[132:135]
    ds_read_b64_tr_b16 v[124:125], v9 offset:12288
    v_mfma_f32_16x16x32_bf16 a[152:155], v[108:111], a[12:15], a[152:155]
    buffer_load_dwordx4 a[12:15], v10, s[60:63], s79 offen offset:768 sc1
    s_waitcnt vmcnt(11)
    v_mfma_f32_16x16x32_bf16 a[96:99], v[96:99], a[16:19], a[96:99]
    buffer_load_dwordx4 v4, s[52:55], s78 offen offset:2048 lds
    v_mfma_f32_16x16x32_bf16 a[116:119], v[100:103], a[16:19], a[116:119]
    ds_read_b64_tr_b16 v[126:127], v9 offset:12800
    v_mfma_f32_16x16x32_bf16 a[136:139], v[104:107], a[16:19], a[136:139]
    buffer_load_dwordx4 v5, s[52:55], s78 offen offset:3072 lds
    v_mfma_f32_16x16x32_bf16 a[156:159], v[108:111], a[16:19], a[156:159]
    buffer_load_dwordx4 a[16:19], v10, s[60:63], s79 offen offset:1024 sc1
    s_waitcnt lgkmcnt(0)
    s_waitcnt vmcnt(13)
    v_mfma_f32_16x16x32_bf16 a[80:83], v[112:115], a[20:23], a[80:83]
    s_add_u32 s79, s79, 40960
    s_add_u32 s78, s78, 110592
    v_mfma_f32_16x16x32_bf16 a[100:103], v[116:119], a[20:23], a[100:103]
    s_add_u32 m0, s72, 12288
    ds_read_b64_tr_b16 v[96:97], v6 offset:16384
    v_mfma_f32_16x16x32_bf16 a[120:123], v[120:123], a[20:23], a[120:123]
    buffer_load_dwordx4 v2, s[52:55], s78 offen lds
    v_mfma_f32_16x16x32_bf16 a[140:143], v[124:127], a[20:23], a[140:143]
    buffer_load_dwordx4 a[20:23], v10, s[60:63], s79 offen sc1
    s_waitcnt vmcnt(14)
    v_mfma_f32_16x16x32_bf16 a[84:87], v[112:115], a[24:27], a[84:87]
    ds_read_b64_tr_b16 v[98:99], v6 offset:16896
    ds_read_b64_tr_b16 v[100:101], v7 offset:16384
    v_mfma_f32_16x16x32_bf16 a[104:107], v[116:119], a[24:27], a[104:107]
    ds_read_b64_tr_b16 v[102:103], v7 offset:16896
    v_mfma_f32_16x16x32_bf16 a[124:127], v[120:123], a[24:27], a[124:127]
    buffer_load_dwordx4 v3, s[52:55], s78 offen offset:1024 lds
    v_mfma_f32_16x16x32_bf16 a[144:147], v[124:127], a[24:27], a[144:147]
    buffer_load_dwordx4 a[24:27], v10, s[60:63], s79 offen offset:256 sc1
    s_waitcnt vmcnt(15)
    v_mfma_f32_16x16x32_bf16 a[88:91], v[112:115], a[28:31], a[88:91]
    ds_read_b64_tr_b16 v[104:105], v8 offset:16384
    ds_read_b64_tr_b16 v[106:107], v8 offset:16896
    v_mfma_f32_16x16x32_bf16 a[108:111], v[116:119], a[28:31], a[108:111]
    ds_read_b64_tr_b16 v[108:109], v9 offset:16384
    v_mfma_f32_16x16x32_bf16 a[128:131], v[120:123], a[28:31], a[128:131]
    buffer_load_dwordx4 v4, s[52:55], s78 offen offset:2048 lds
    v_mfma_f32_16x16x32_bf16 a[148:151], v[124:127], a[28:31], a[148:151]
    buffer_load_dwordx4 a[28:31], v10, s[60:63], s79 offen offset:512 sc1
    s_waitcnt vmcnt(16)
    v_mfma_f32_16x16x32_bf16 a[92:95], v[112:115], a[32:35], a[92:95]
    ds_read_b64_tr_b16 v[110:111], v9 offset:16896
    v_mfma_f32_16x16x32_bf16 a[112:115], v[116:119], a[32:35], a[112:115]
    buffer_load_dwordx4 v5, s[52:55], s78 offen offset:3072 lds
    v_mfma_f32_16x16x32_bf16 a[132:135], v[120:123], a[32:35], a[132:135]
    v_mfma_f32_16x16x32_bf16 a[152:155], v[124:127], a[32:35], a[152:155]
    buffer_load_dwordx4 a[32:35], v10, s[60:63], s79 offen offset:768 sc1
    s_waitcnt vmcnt(17)
    v_mfma_f32_16x16x32_bf16 a[96:99], v[112:115], a[36:39], a[96:99]
    v_mfma_f32_16x16x32_bf16 a[116:119], v[116:119], a[36:39], a[116:119]
    v_mfma_f32_16x16x32_bf16 a[136:139], v[120:123], a[36:39], a[136:139]
    v_mfma_f32_16x16x32_bf16 a[156:159], v[124:127], a[36:39], a[156:159]
    buffer_load_dwordx4 a[36:39], v10, s[60:63], s79 offen offset:1024 sc1
    s_waitcnt lgkmcnt(0)
    s_waitcnt vmcnt(17)
    v_mfma_f32_16x16x32_bf16 a[80:83], v[96:99], a[0:3], a[80:83]
    s_add_u32 s79, s79, 40960
    s_add_u32 s78, s78, 110592
    v_mfma_f32_16x16x32_bf16 a[100:103], v[100:103], a[0:3], a[100:103]
    s_add_u32 m0, s72, 16384
    ds_read_b64_tr_b16 v[112:113], v6 offset:20480
    v_mfma_f32_16x16x32_bf16 a[120:123], v[104:107], a[0:3], a[120:123]
    buffer_load_dwordx4 v2, s[52:55], s78 offen lds
    v_mfma_f32_16x16x32_bf16 a[140:143], v[108:111], a[0:3], a[140:143]
    buffer_load_dwordx4 a[0:3], v10, s[60:63], s79 offen sc1
    s_waitcnt vmcnt(18)
    v_mfma_f32_16x16x32_bf16 a[84:87], v[96:99], a[4:7], a[84:87]
    ds_read_b64_tr_b16 v[114:115], v6 offset:20992
    ds_read_b64_tr_b16 v[116:117], v7 offset:20480
    v_mfma_f32_16x16x32_bf16 a[104:107], v[100:103], a[4:7], a[104:107]
    ds_read_b64_tr_b16 v[118:119], v7 offset:20992
    v_mfma_f32_16x16x32_bf16 a[124:127], v[104:107], a[4:7], a[124:127]
    buffer_load_dwordx4 v3, s[52:55], s78 offen offset:1024 lds
    v_mfma_f32_16x16x32_bf16 a[144:147], v[108:111], a[4:7], a[144:147]
    buffer_load_dwordx4 a[4:7], v10, s[60:63], s79 offen offset:256 sc1
    s_waitcnt vmcnt(18)
    v_mfma_f32_16x16x32_bf16 a[88:91], v[96:99], a[8:11], a[88:91]
    ds_read_b64_tr_b16 v[120:121], v8 offset:20480
    ds_read_b64_tr_b16 v[122:123], v8 offset:20992
    v_mfma_f32_16x16x32_bf16 a[108:111], v[100:103], a[8:11], a[108:111]
    ds_read_b64_tr_b16 v[124:125], v9 offset:20480
    v_mfma_f32_16x16x32_bf16 a[128:131], v[104:107], a[8:11], a[128:131]
    buffer_load_dwordx4 v4, s[52:55], s78 offen offset:2048 lds
    v_mfma_f32_16x16x32_bf16 a[148:151], v[108:111], a[8:11], a[148:151]
    buffer_load_dwordx4 a[8:11], v10, s[60:63], s79 offen offset:512 sc1
    s_waitcnt vmcnt(18)
    v_mfma_f32_16x16x32_bf16 a[92:95], v[96:99], a[12:15], a[92:95]
    ds_read_b64_tr_b16 v[126:127], v9 offset:20992
    v_mfma_f32_16x16x32_bf16 a[112:115], v[100:103], a[12:15], a[112:115]
    buffer_load_dwordx4 v5, s[52:55], s78 offen offset:3072 lds
    v_mfma_f32_16x16x32_bf16 a[132:135], v[104:107], a[12:15], a[132:135]
    v_mfma_f32_16x16x32_bf16 a[152:155], v[108:111], a[12:15], a[152:155]
    buffer_load_dwordx4 a[12:15], v10, s[60:63], s79 offen offset:768 sc1
    s_waitcnt vmcnt(17)
    v_mfma_f32_16x16x32_bf16 a[96:99], v[96:99], a[16:19], a[96:99]
    v_mfma_f32_16x16x32_bf16 a[116:119], v[100:103], a[16:19], a[116:119]
    v_mfma_f32_16x16x32_bf16 a[136:139], v[104:107], a[16:19], a[136:139]
    v_mfma_f32_16x16x32_bf16 a[156:159], v[108:111], a[16:19], a[156:159]
    buffer_load_dwordx4 a[16:19], v10, s[60:63], s79 offen offset:1024 sc1
    s_waitcnt lgkmcnt(0)
    s_waitcnt vmcnt(16)
    v_mfma_f32_16x16x32_bf16 a[80:83], v[112:115], a[20:23], a[80:83]
    s_add_u32 s79, s79, 40960
    s_cmp_ge_u32 s12, 6
    v_mfma_f32_16x16x32_bf16 a[100:103], v[116:119], a[20:23], a[100:103]
    s_cselect_b32 s78, s75, 0
    s_add_u32 s78, s78, s74
    v_mfma_f32_16x16x32_bf16 a[120:123], v[120:123], a[20:23], a[120:123]
    s_add_u32 s78, s78, 1437696
    s_add_u32 m0, s72, 20480
    v_mfma_f32_16x16x32_bf16 a[140:143], v[124:127], a[20:23], a[140:143]
    buffer_load_dwordx4 a[20:23], v10, s[60:63], s79 offen sc1
    s_waitcnt vmcnt(15)
    v_mfma_f32_16x16x32_bf16 a[84:87], v[112:115], a[24:27], a[84:87]
    ds_read_b64_tr_b16 v[96:97], v6 offset:24576
    v_mfma_f32_16x16x32_bf16 a[104:107], v[116:119], a[24:27], a[104:107]
    buffer_load_dwordx4 v2, s[52:55], s78 offen lds
    v_mfma_f32_16x16x32_bf16 a[124:127], v[120:123], a[24:27], a[124:127]
    ds_read_b64_tr_b16 v[98:99], v6 offset:25088
    ds_read_b64_tr_b16 v[100:101], v7 offset:24576
    v_mfma_f32_16x16x32_bf16 a[144:147], v[124:127], a[24:27], a[144:147]
    buffer_load_dwordx4 a[24:27], v10, s[60:63], s79 offen offset:256 sc1
    s_waitcnt vmcnt(15)
    v_mfma_f32_16x16x32_bf16 a[88:91], v[112:115], a[28:31], a[88:91]
    ds_read_b64_tr_b16 v[102:103], v7 offset:25088
    v_mfma_f32_16x16x32_bf16 a[108:111], v[116:119], a[28:31], a[108:111]
    buffer_load_dwordx4 v3, s[52:55], s78 offen offset:1024 lds
    v_mfma_f32_16x16x32_bf16 a[128:131], v[120:123], a[28:31], a[128:131]
    ds_read_b64_tr_b16 v[104:105], v8 offset:24576
    ds_read_b64_tr_b16 v[106:107], v8 offset:25088
    v_mfma_f32_16x16x32_bf16 a[148:151], v[124:127], a[28:31], a[148:151]
    buffer_load_dwordx4 a[28:31], v10, s[60:63], s79 offen offset:512 sc1
    s_waitcnt vmcnt(15)
    v_mfma_f32_16x16x32_bf16 a[92:95], v[112:115], a[32:35], a[92:95]
    ds_read_b64_tr_b16 v[108:109], v9 offset:24576
    v_mfma_f32_16x16x32_bf16 a[112:115], v[116:119], a[32:35], a[112:115]
    buffer_load_dwordx4 v4, s[52:55], s78 offen offset:2048 lds
    v_mfma_f32_16x16x32_bf16 a[132:135], v[120:123], a[32:35], a[132:135]
    ds_read_b64_tr_b16 v[110:111], v9 offset:25088
    v_mfma_f32_16x16x32_bf16 a[152:155], v[124:127], a[32:35], a[152:155]
    buffer_load_dwordx4 a[32:35], v10, s[60:63], s79 offen offset:768 sc1
    s_waitcnt vmcnt(16)
    v_mfma_f32_16x16x32_bf16 a[96:99], v[112:115], a[36:39], a[96:99]
    buffer_load_dwordx4 v5, s[52:55], s78 offen offset:3072 lds
    v_mfma_f32_16x16x32_bf16 a[116:119], v[116:119], a[36:39], a[116:119]
    v_mfma_f32_16x16x32_bf16 a[136:139], v[120:123], a[36:39], a[136:139]
    v_mfma_f32_16x16x32_bf16 a[156:159], v[124:127], a[36:39], a[156:159]
    buffer_load_dwordx4 a[36:39], v10, s[60:63], s79 offen offset:1024 sc1
    s_waitcnt lgkmcnt(0)
    s_waitcnt vmcnt(16)
    v_mfma_f32_16x16x32_bf16 a[80:83], v[96:99], a[0:3], a[80:83]
    s_cmp_ge_u32 s12, 11
    s_cselect_b32 s79, s77, 0
    v_mfma_f32_16x16x32_bf16 a[100:103], v[100:103], a[0:3], a[100:103]
    s_add_u32 s79, s79, s76
    s_add_u32 s79, s79, 327680
    v_mfma_f32_16x16x32_bf16 a[120:123], v[104:107], a[0:3], a[120:123]
    s_cmp_ge_u32 s12, 5
    s_cselect_b32 s78, s75, 0
    v_mfma_f32_16x16x32_bf16 a[140:143], v[108:111], a[0:3], a[140:143]
    s_add_u32 s78, s78, s74
    s_add_u32 s78, s78, 1548288
    s_waitcnt vmcnt(14)
    v_mfma_f32_16x16x32_bf16 a[84:87], v[96:99], a[4:7], a[84:87]
    s_add_u32 m0, s72, 24576
    v_mfma_f32_16x16x32_bf16 a[104:107], v[100:103], a[4:7], a[104:107]
    buffer_load_dwordx4 a[0:3], v10, s[60:63], s79 offen sc1
    v_mfma_f32_16x16x32_bf16 a[124:127], v[104:107], a[4:7], a[124:127]
    ds_read_b64_tr_b16 v[112:113], v6 offset:28672
    v_mfma_f32_16x16x32_bf16 a[144:147], v[108:111], a[4:7], a[144:147]
    buffer_load_dwordx4 a[4:7], v10, s[60:63], s79 offen offset:256 sc1
    s_waitcnt vmcnt(14)
    v_mfma_f32_16x16x32_bf16 a[88:91], v[96:99], a[8:11], a[88:91]
    buffer_load_dwordx4 v2, s[52:55], s78 offen lds
    v_mfma_f32_16x16x32_bf16 a[108:111], v[100:103], a[8:11], a[108:111]
    ds_read_b64_tr_b16 v[114:115], v6 offset:29184
    ds_read_b64_tr_b16 v[116:117], v7 offset:28672
    v_mfma_f32_16x16x32_bf16 a[128:131], v[104:107], a[8:11], a[128:131]
    ds_read_b64_tr_b16 v[118:119], v7 offset:29184
    v_mfma_f32_16x16x32_bf16 a[148:151], v[108:111], a[8:11], a[148:151]
    buffer_load_dwordx4 a[8:11], v10, s[60:63], s79 offen offset:512 sc1
    s_waitcnt vmcnt(14)
    v_mfma_f32_16x16x32_bf16 a[92:95], v[96:99], a[12:15], a[92:95]
    buffer_load_dwordx4 v3, s[52:55], s78 offen offset:1024 lds
    v_mfma_f32_16x16x32_bf16 a[112:115], v[100:103], a[12:15], a[112:115]
    ds_read_b64_tr_b16 v[120:121], v8 offset:28672
    ds_read_b64_tr_b16 v[122:123], v8 offset:29184
    v_mfma_f32_16x16x32_bf16 a[132:135], v[104:107], a[12:15], a[132:135]
    ds_read_b64_tr_b16 v[124:125], v9 offset:28672
    v_mfma_f32_16x16x32_bf16 a[152:155], v[108:111], a[12:15], a[152:155]
    buffer_load_dwordx4 a[12:15], v10, s[60:63], s79 offen offset:768 sc1
    s_waitcnt vmcnt(15)
    v_mfma_f32_16x16x32_bf16 a[96:99], v[96:99], a[16:19], a[96:99]
    buffer_load_dwordx4 v4, s[52:55], s78 offen offset:2048 lds
    v_mfma_f32_16x16x32_bf16 a[116:119], v[100:103], a[16:19], a[116:119]
    ds_read_b64_tr_b16 v[126:127], v9 offset:29184
    v_mfma_f32_16x16x32_bf16 a[136:139], v[104:107], a[16:19], a[136:139]
    buffer_load_dwordx4 v5, s[52:55], s78 offen offset:3072 lds
    v_mfma_f32_16x16x32_bf16 a[156:159], v[108:111], a[16:19], a[156:159]
    buffer_load_dwordx4 a[16:19], v10, s[60:63], s79 offen offset:1024 sc1
    s_waitcnt lgkmcnt(0)
    s_waitcnt vmcnt(17)
    v_mfma_f32_16x16x32_bf16 a[80:83], v[112:115], a[20:23], a[80:83]
    s_cmp_ge_u32 s12, 10
    s_cselect_b32 s79, s77, 0
    v_mfma_f32_16x16x32_bf16 a[100:103], v[116:119], a[20:23], a[100:103]
    s_add_u32 s79, s79, s76
    s_add_u32 s79, s79, 368640
    v_mfma_f32_16x16x32_bf16 a[120:123], v[120:123], a[20:23], a[120:123]
    s_add_u32 s78, s78, 110592
    s_add_u32 m0, s72, 28672
    v_mfma_f32_16x16x32_bf16 a[140:143], v[124:127], a[20:23], a[140:143]
    buffer_load_dwordx4 a[20:23], v10, s[60:63], s79 offen sc1
    s_waitcnt vmcnt(16)
    v_mfma_f32_16x16x32_bf16 a[84:87], v[112:115], a[24:27], a[84:87]
    ds_read_b64_tr_b16 v[96:97], v6 offset:0
    v_mfma_f32_16x16x32_bf16 a[104:107], v[116:119], a[24:27], a[104:107]
    buffer_load_dwordx4 v2, s[52:55], s78 offen lds
    v_mfma_f32_16x16x32_bf16 a[124:127], v[120:123], a[24:27], a[124:127]
    ds_read_b64_tr_b16 v[98:99], v6 offset:512
    ds_read_b64_tr_b16 v[100:101], v7 offset:0
    v_mfma_f32_16x16x32_bf16 a[144:147], v[124:127], a[24:27], a[144:147]
    buffer_load_dwordx4 a[24:27], v10, s[60:63], s79 offen offset:256 sc1
    s_waitcnt vmcnt(16)
    v_mfma_f32_16x16x32_bf16 a[88:91], v[112:115], a[28:31], a[88:91]
    ds_read_b64_tr_b16 v[102:103], v7 offset:512
    v_mfma_f32_16x16x32_bf16 a[108:111], v[116:119], a[28:31], a[108:111]
    buffer_load_dwordx4 v3, s[52:55], s78 offen offset:1024 lds
    v_mfma_f32_16x16x32_bf16 a[128:131], v[120:123], a[28:31], a[128:131]
    ds_read_b64_tr_b16 v[104:105], v8 offset:0
    ds_read_b64_tr_b16 v[106:107], v8 offset:512
    v_mfma_f32_16x16x32_bf16 a[148:151], v[124:127], a[28:31], a[148:151]
    buffer_load_dwordx4 a[28:31], v10, s[60:63], s79 offen offset:512 sc1
    s_waitcnt vmcnt(16)
    v_mfma_f32_16x16x32_bf16 a[92:95], v[112:115], a[32:35], a[92:95]
    ds_read_b64_tr_b16 v[108:109], v9 offset:0
    v_mfma_f32_16x16x32_bf16 a[112:115], v[116:119], a[32:35], a[112:115]
    buffer_load_dwordx4 v4, s[52:55], s78 offen offset:2048 lds
    v_mfma_f32_16x16x32_bf16 a[132:135], v[120:123], a[32:35], a[132:135]
    ds_read_b64_tr_b16 v[110:111], v9 offset:512
    v_mfma_f32_16x16x32_bf16 a[152:155], v[124:127], a[32:35], a[152:155]
    buffer_load_dwordx4 a[32:35], v10, s[60:63], s79 offen offset:768 sc1
    s_waitcnt vmcnt(16)
    v_mfma_f32_16x16x32_bf16 a[96:99], v[112:115], a[36:39], a[96:99]
    buffer_load_dwordx4 v5, s[52:55], s78 offen offset:3072 lds
    v_mfma_f32_16x16x32_bf16 a[116:119], v[116:119], a[36:39], a[116:119]
    v_mfma_f32_16x16x32_bf16 a[136:139], v[120:123], a[36:39], a[136:139]
    v_mfma_f32_16x16x32_bf16 a[156:159], v[124:127], a[36:39], a[156:159]
    buffer_load_dwordx4 a[36:39], v10, s[60:63], s79 offen offset:1024 sc1
    s_waitcnt lgkmcnt(0)
    s_waitcnt vmcnt(17)
    v_mfma_f32_16x16x32_bf16 a[80:83], v[96:99], a[0:3], a[80:83]
    s_add_u32 s79, s79, 40960
    s_add_u32 s78, s78, 110592
    v_mfma_f32_16x16x32_bf16 a[100:103], v[100:103], a[0:3], a[100:103]
    s_add_u32 m0, s72, 0
    ds_read_b64_tr_b16 v[112:113], v6 offset:4096
    v_mfma_f32_16x16x32_bf16 a[120:123], v[104:107], a[0:3], a[120:123]
    buffer_load_dwordx4 v2, s[52:55], s78 offen lds
    v_mfma_f32_16x16x32_bf16 a[140:143], v[108:111], a[0:3], a[140:143]
    buffer_load_dwordx4 a[0:3], v10, s[60:63], s79 offen sc1
    s_waitcnt vmcnt(18)
    v_mfma_f32_16x16x32_bf16 a[84:87], v[96:99], a[4:7], a[84:87]
    ds_read_b64_tr_b16 v[114:115], v6 offset:4608
    ds_read_b64_tr_b16 v[116:117], v7 offset:4096
    v_mfma_f32_16x16x32_bf16 a[104:107], v[100:103], a[4:7], a[104:107]
    ds_read_b64_tr_b16 v[118:119], v7 offset:4608
    v_mfma_f32_16x16x32_bf16 a[124:127], v[104:107], a[4:7], a[124:127]
    buffer_load_dwordx4 v3, s[52:55], s78 offen offset:1024 lds
    v_mfma_f32_16x16x32_bf16 a[144:147], v[108:111], a[4:7], a[144:147]
    buffer_load_dwordx4 a[4:7], v10, s[60:63], s79 offen offset:256 sc1
    s_waitcnt vmcnt(18)
    v_mfma_f32_16x16x32_bf16 a[88:91], v[96:99], a[8:11], a[88:91]
    ds_read_b64_tr_b16 v[120:121], v8 offset:4096
    ds_read_b64_tr_b16 v[122:123], v8 offset:4608
    v_mfma_f32_16x16x32_bf16 a[108:111], v[100:103], a[8:11], a[108:111]
    ds_read_b64_tr_b16 v[124:125], v9 offset:4096
    v_mfma_f32_16x16x32_bf16 a[128:131], v[104:107], a[8:11], a[128:131]
    buffer_load_dwordx4 v4, s[52:55], s78 offen offset:2048 lds
    v_mfma_f32_16x16x32_bf16 a[148:151], v[108:111], a[8:11], a[148:151]
    buffer_load_dwordx4 a[8:11], v10, s[60:63], s79 offen offset:512 sc1
    s_waitcnt vmcnt(18)
    v_mfma_f32_16x16x32_bf16 a[92:95], v[96:99], a[12:15], a[92:95]
    ds_read_b64_tr_b16 v[126:127], v9 offset:4608
    v_mfma_f32_16x16x32_bf16 a[112:115], v[100:103], a[12:15], a[112:115]
    buffer_load_dwordx4 v5, s[52:55], s78 offen offset:3072 lds
    v_mfma_f32_16x16x32_bf16 a[132:135], v[104:107], a[12:15], a[132:135]
    v_mfma_f32_16x16x32_bf16 a[152:155], v[108:111], a[12:15], a[152:155]
    buffer_load_dwordx4 a[12:15], v10, s[60:63], s79 offen offset:768 sc1
    s_waitcnt vmcnt(17)
    v_mfma_f32_16x16x32_bf16 a[96:99], v[96:99], a[16:19], a[96:99]
    v_mfma_f32_16x16x32_bf16 a[116:119], v[100:103], a[16:19], a[116:119]
    v_mfma_f32_16x16x32_bf16 a[136:139], v[104:107], a[16:19], a[136:139]
    v_mfma_f32_16x16x32_bf16 a[156:159], v[108:111], a[16:19], a[156:159]
    buffer_load_dwordx4 a[16:19], v10, s[60:63], s79 offen offset:1024 sc1
    s_waitcnt lgkmcnt(0)
    s_waitcnt vmcnt(17)
    v_mfma_f32_16x16x32_bf16 a[80:83], v[112:115], a[20:23], a[80:83]
    s_add_u32 s79, s79, 40960
    s_add_u32 s78, s78, 110592
    v_mfma_f32_16x16x32_bf16 a[100:103], v[116:119], a[20:23], a[100:103]
    s_add_u32 m0, s72, 4096
    ds_read_b64_tr_b16 v[96:97], v6 offset:8192
    v_mfma_f32_16x16x32_bf16 a[120:123], v[120:123], a[20:23], a[120:123]
    buffer_load_dwordx4 v2, s[52:55], s78 offen lds
    v_mfma_f32_16x16x32_bf16 a[140:143], v[124:127], a[20:23], a[140:143]
    buffer_load_dwordx4 a[20:23], v10, s[60:63], s79 offen sc1
    s_waitcnt vmcnt(17)
    v_mfma_f32_16x16x32_bf16 a[84:87], v[112:115], a[24:27], a[84:87]
    ds_read_b64_tr_b16 v[98:99], v6 offset:8704
    ds_read_b64_tr_b16 v[100:101], v7 offset:8192
    v_mfma_f32_16x16x32_bf16 a[104:107], v[116:119], a[24:27], a[104:107]
    ds_read_b64_tr_b16 v[102:103], v7 offset:8704
    v_mfma_f32_16x16x32_bf16 a[124:127], v[120:123], a[24:27], a[124:127]
    buffer_load_dwordx4 v3, s[52:55], s78 offen offset:1024 lds
    v_mfma_f32_16x16x32_bf16 a[144:147], v[124:127], a[24:27], a[144:147]
    buffer_load_dwordx4 a[24:27], v10, s[60:63], s79 offen offset:256 sc1
    s_waitcnt vmcnt(17)
    v_mfma_f32_16x16x32_bf16 a[88:91], v[112:115], a[28:31], a[88:91]
    ds_read_b64_tr_b16 v[104:105], v8 offset:8192
    ds_read_b64_tr_b16 v[106:107], v8 offset:8704
    v_mfma_f32_16x16x32_bf16 a[108:111], v[116:119], a[28:31], a[108:111]
    ds_read_b64_tr_b16 v[108:109], v9 offset:8192
    v_mfma_f32_16x16x32_bf16 a[128:131], v[120:123], a[28:31], a[128:131]
    buffer_load_dwordx4 v4, s[52:55], s78 offen offset:2048 lds
    v_mfma_f32_16x16x32_bf16 a[148:151], v[124:127], a[28:31], a[148:151]
    buffer_load_dwordx4 a[28:31], v10, s[60:63], s79 offen offset:512 sc1
    s_waitcnt vmcnt(17)
    v_mfma_f32_16x16x32_bf16 a[92:95], v[112:115], a[32:35], a[92:95]
    ds_read_b64_tr_b16 v[110:111], v9 offset:8704
    v_mfma_f32_16x16x32_bf16 a[112:115], v[116:119], a[32:35], a[112:115]
    buffer_load_dwordx4 v5, s[52:55], s78 offen offset:3072 lds
    v_mfma_f32_16x16x32_bf16 a[132:135], v[120:123], a[32:35], a[132:135]
    v_mfma_f32_16x16x32_bf16 a[152:155], v[124:127], a[32:35], a[152:155]
    buffer_load_dwordx4 a[32:35], v10, s[60:63], s79 offen offset:768 sc1
    s_waitcnt vmcnt(17)
    v_mfma_f32_16x16x32_bf16 a[96:99], v[112:115], a[36:39], a[96:99]
    v_mfma_f32_16x16x32_bf16 a[116:119], v[116:119], a[36:39], a[116:119]
    v_mfma_f32_16x16x32_bf16 a[136:139], v[120:123], a[36:39], a[136:139]
    v_mfma_f32_16x16x32_bf16 a[156:159], v[124:127], a[36:39], a[156:159]
    buffer_load_dwordx4 a[36:39], v10, s[60:63], s79 offen offset:1024 sc1
    s_waitcnt lgkmcnt(0)
    s_waitcnt vmcnt(16)
    v_mfma_f32_16x16x32_bf16 a[80:83], v[96:99], a[0:3], a[80:83]
    s_add_u32 s79, s79, 40960
    s_cmp_ge_u32 s12, 1
    v_mfma_f32_16x16x32_bf16 a[100:103], v[100:103], a[0:3], a[100:103]
    s_cselect_b32 s78, s75, 0
    s_add_u32 s78, s78, s74
    v_mfma_f32_16x16x32_bf16 a[120:123], v[104:107], a[0:3], a[120:123]
    s_add_u32 s78, s78, 1990656
    s_add_u32 m0, s72, 8192
    v_mfma_f32_16x16x32_bf16 a[140:143], v[108:111], a[0:3], a[140:143]
    buffer_load_dwordx4 a[0:3], v10, s[60:63], s79 offen sc1
    s_waitcnt vmcnt(15)
    v_mfma_f32_16x16x32_bf16 a[84:87], v[96:99], a[4:7], a[84:87]
    ds_read_b64_tr_b16 v[112:113], v6 offset:12288
    v_mfma_f32_16x16x32_bf16 a[104:107], v[100:103], a[4:7], a[104:107]
    buffer_load_dwordx4 v2, s[52:55], s78 offen lds
    v_mfma_f32_16x16x32_bf16 a[124:127], v[104:107], a[4:7], a[124:127]
    ds_read_b64_tr_b16 v[114:115], v6 offset:12800
    ds_read_b64_tr_b16 v[116:117], v7 offset:12288
    v_mfma_f32_16x16x32_bf16 a[144:147], v[108:111], a[4:7], a[144:147]
    buffer_load_dwordx4 a[4:7], v10, s[60:63], s79 offen offset:256 sc1
    s_waitcnt vmcnt(15)
    v_mfma_f32_16x16x32_bf16 a[88:91], v[96:99], a[8:11], a[88:91]
    ds_read_b64_tr_b16 v[118:119], v7 offset:12800
    v_mfma_f32_16x16x32_bf16 a[108:111], v[100:103], a[8:11], a[108:111]
    buffer_load_dwordx4 v3, s[52:55], s78 offen offset:1024 lds
    v_mfma_f32_16x16x32_bf16 a[128:131], v[104:107], a[8:11], a[128:131]
    ds_read_b64_tr_b16 v[120:121], v8 offset:12288
    ds_read_b64_tr_b16 v[122:123], v8 offset:12800
    v_mfma_f32_16x16x32_bf16 a[148:151], v[108:111], a[8:11], a[148:151]
    buffer_load_dwordx4 a[8:11], v10, s[60:63], s79 offen offset:512 sc1
    s_waitcnt vmcnt(15)
    v_mfma_f32_16x16x32_bf16 a[92:95], v[96:99], a[12:15], a[92:95]
    ds_read_b64_tr_b16 v[124:125], v9 offset:12288
    v_mfma_f32_16x16x32_bf16 a[112:115], v[100:103], a[12:15], a[112:115]
    buffer_load_dwordx4 v4, s[52:55], s78 offen offset:2048 lds
    v_mfma_f32_16x16x32_bf16 a[132:135], v[104:107], a[12:15], a[132:135]
    ds_read_b64_tr_b16 v[126:127], v9 offset:12800
    v_mfma_f32_16x16x32_bf16 a[152:155], v[108:111], a[12:15], a[152:155]
    buffer_load_dwordx4 a[12:15], v10, s[60:63], s79 offen offset:768 sc1
    s_waitcnt vmcnt(16)
    v_mfma_f32_16x16x32_bf16 a[96:99], v[96:99], a[16:19], a[96:99]
    buffer_load_dwordx4 v5, s[52:55], s78 offen offset:3072 lds
    v_mfma_f32_16x16x32_bf16 a[116:119], v[100:103], a[16:19], a[116:119]
    v_mfma_f32_16x16x32_bf16 a[136:139], v[104:107], a[16:19], a[136:139]
    v_mfma_f32_16x16x32_bf16 a[156:159], v[108:111], a[16:19], a[156:159]
    buffer_load_dwordx4 a[16:19], v10, s[60:63], s79 offen offset:1024 sc1
    s_waitcnt lgkmcnt(0)
    s_waitcnt vmcnt(16)
    v_mfma_f32_16x16x32_bf16 a[80:83], v[112:115], a[20:23], a[80:83]
    s_cmp_ge_u32 s12, 6
    s_cselect_b32 s79, s77, 0
    v_mfma_f32_16x16x32_bf16 a[100:103], v[116:119], a[20:23], a[100:103]
    s_add_u32 s79, s79, s76
    s_add_u32 s79, s79, 532480
    v_mfma_f32_16x16x32_bf16 a[120:123], v[120:123], a[20:23], a[120:123]
    ds_read_b64_tr_b16 v[96:97], v6 offset:16384
    ds_read_b64_tr_b16 v[98:99], v6 offset:16896
    v_mfma_f32_16x16x32_bf16 a[140:143], v[124:127], a[20:23], a[140:143]
    buffer_load_dwordx4 a[20:23], v10, s[60:63], s79 offen sc1
    ds_read_b64_tr_b16 v[100:101], v7 offset:16384
    s_waitcnt vmcnt(15)
    v_mfma_f32_16x16x32_bf16 a[84:87], v[112:115], a[24:27], a[84:87]
    ds_read_b64_tr_b16 v[102:103], v7 offset:16896
    ds_read_b64_tr_b16 v[104:105], v8 offset:16384
    v_mfma_f32_16x16x32_bf16 a[104:107], v[116:119], a[24:27], a[104:107]
    ds_read_b64_tr_b16 v[106:107], v8 offset:16896
    v_mfma_f32_16x16x32_bf16 a[124:127], v[120:123], a[24:27], a[124:127]
    v_mfma_f32_16x16x32_bf16 a[144:147], v[124:127], a[24:27], a[144:147]
    buffer_load_dwordx4 a[24:27], v10, s[60:63], s79 offen offset:256 sc1
    s_waitcnt vmcnt(14)
    v_mfma_f32_16x16x32_bf16 a[88:91], v[112:115], a[28:31], a[88:91]
    s_mul_i32 s74, s3, 1703936
    s_lshl_b32 s15, s8, 7
    v_mfma_f32_16x16x32_bf16 a[108:111], v[116:119], a[28:31], a[108:111]
    s_add_u32 s74, s74, s15
    v_lshrrev_b32 v20, 3, v0
    v_mfma_f32_16x16x32_bf16 a[128:131], v[120:123], a[28:31], a[128:131]
    v_mul_u32_u24 v20, 4096, v20
    v_and_b32 v21, 7, v0
    v_mfma_f32_16x16x32_bf16 a[148:151], v[124:127], a[28:31], a[148:151]
    buffer_load_dwordx4 a[28:31], v10, s[60:63], s79 offen offset:512 sc1
    s_waitcnt vmcnt(13)
    v_mfma_f32_16x16x32_bf16 a[92:95], v[112:115], a[32:35], a[92:95]
    v_bfe_u32 v22, v0, 4, 1
    v_lshlrev_b32 v22, 1, v22
    v_mfma_f32_16x16x32_bf16 a[112:115], v[116:119], a[32:35], a[112:115]
    v_xor_b32 v21, v21, v22
    v_xor_b32 v22, 0, v21
    v_mfma_f32_16x16x32_bf16 a[132:135], v[120:123], a[32:35], a[132:135]
    v_lshl_add_u32 v2, v22, 4, v20
    v_xor_b32 v22, 4, v21
    v_mfma_f32_16x16x32_bf16 a[152:155], v[124:127], a[32:35], a[152:155]
    buffer_load_dwordx4 a[32:35], v10, s[60:63], s79 offen offset:768 sc1
    s_waitcnt vmcnt(13)
    v_mfma_f32_16x16x32_bf16 a[96:99], v[112:115], a[36:39], a[96:99]
    v_lshl_add_u32 v3, v22, 4, v20
    v_add_u32 v3, 31744, v3
    v_mfma_f32_16x16x32_bf16 a[116:119], v[116:119], a[36:39], a[116:119]
    v_xor_b32 v22, 0, v21
    v_lshl_add_u32 v4, v22, 4, v20
    v_mfma_f32_16x16x32_bf16 a[136:139], v[120:123], a[36:39], a[136:139]
    v_add_u32 v4, 63488, v4
    v_xor_b32 v22, 4, v21
    v_mfma_f32_16x16x32_bf16 a[156:159], v[124:127], a[36:39], a[156:159]
    buffer_load_dwordx4 a[36:39], v10, s[60:63], s79 offen offset:1024 sc1
    v_lshl_add_u32 v5, v22, 4, v20
    v_add_u32 v5, 95232, v5
    ds_read_b64_tr_b16 v[108:109], v9 offset:16384
    ds_read_b64_tr_b16 v[110:111], v9 offset:16896
    s_waitcnt lgkmcnt(0)
    s_waitcnt vmcnt(13)
    v_mfma_f32_16x16x32_bf16 a[80:83], v[96:99], a[0:3], a[80:83]
    s_cmp_ge_u32 s12, 5
    s_cselect_b32 s79, s77, 0
    v_mfma_f32_16x16x32_bf16 a[100:103], v[100:103], a[0:3], a[100:103]
    s_add_u32 s79, s79, s76
    s_add_u32 s79, s79, 573440
    v_mfma_f32_16x16x32_bf16 a[120:123], v[104:107], a[0:3], a[120:123]
    ds_read_b64_tr_b16 v[112:113], v6 offset:20480
    ds_read_b64_tr_b16 v[114:115], v6 offset:20992
    v_mfma_f32_16x16x32_bf16 a[140:143], v[108:111], a[0:3], a[140:143]
    buffer_load_dwordx4 a[0:3], v10, s[60:63], s79 offen sc1
    s_waitcnt vmcnt(12)
    v_mfma_f32_16x16x32_bf16 a[84:87], v[96:99], a[4:7], a[84:87]
    ds_read_b64_tr_b16 v[116:117], v7 offset:20480
    ds_read_b64_tr_b16 v[118:119], v7 offset:20992
    v_mfma_f32_16x16x32_bf16 a[104:107], v[100:103], a[4:7], a[104:107]
    ds_read_b64_tr_b16 v[120:121], v8 offset:20480
    ds_read_b64_tr_b16 v[122:123], v8 offset:20992
    v_mfma_f32_16x16x32_bf16 a[124:127], v[104:107], a[4:7], a[124:127]
    v_mfma_f32_16x16x32_bf16 a[144:147], v[108:111], a[4:7], a[144:147]
    buffer_load_dwordx4 a[4:7], v10, s[60:63], s79 offen offset:256 sc1
    s_waitcnt vmcnt(11)
    v_mfma_f32_16x16x32_bf16 a[88:91], v[96:99], a[8:11], a[88:91]
    ds_read_b64_tr_b16 v[124:125], v9 offset:20480
    ds_read_b64_tr_b16 v[126:127], v9 offset:20992
    v_mfma_f32_16x16x32_bf16 a[108:111], v[100:103], a[8:11], a[108:111]
    v_mfma_f32_16x16x32_bf16 a[128:131], v[104:107], a[8:11], a[128:131]
    v_mfma_f32_16x16x32_bf16 a[148:151], v[108:111], a[8:11], a[148:151]
    buffer_load_dwordx4 a[8:11], v10, s[60:63], s79 offen offset:512 sc1
    s_waitcnt vmcnt(10)
    v_mfma_f32_16x16x32_bf16 a[92:95], v[96:99], a[12:15], a[92:95]
    v_mfma_f32_16x16x32_bf16 a[112:115], v[100:103], a[12:15], a[112:115]
    v_mfma_f32_16x16x32_bf16 a[132:135], v[104:107], a[12:15], a[132:135]
    v_mfma_f32_16x16x32_bf16 a[152:155], v[108:111], a[12:15], a[152:155]
    buffer_load_dwordx4 a[12:15], v10, s[60:63], s79 offen offset:768 sc1
    s_waitcnt vmcnt(9)
    v_mfma_f32_16x16x32_bf16 a[96:99], v[96:99], a[16:19], a[96:99]
    v_mfma_f32_16x16x32_bf16 a[116:119], v[100:103], a[16:19], a[116:119]
    v_mfma_f32_16x16x32_bf16 a[136:139], v[104:107], a[16:19], a[136:139]
    v_mfma_f32_16x16x32_bf16 a[156:159], v[108:111], a[16:19], a[156:159]
    buffer_load_dwordx4 a[16:19], v10, s[60:63], s79 offen offset:1024 sc1
    s_waitcnt lgkmcnt(0)
    s_waitcnt vmcnt(9)
    v_mfma_f32_16x16x32_bf16 a[80:83], v[112:115], a[20:23], a[80:83]
    s_add_u32 s79, s79, 40960
    ds_read_b64_tr_b16 v[96:97], v6 offset:24576
    v_mfma_f32_16x16x32_bf16 a[100:103], v[116:119], a[20:23], a[100:103]
    ds_read_b64_tr_b16 v[98:99], v6 offset:25088
    ds_read_b64_tr_b16 v[100:101], v7 offset:24576
    v_mfma_f32_16x16x32_bf16 a[120:123], v[120:123], a[20:23], a[120:123]
    v_mfma_f32_16x16x32_bf16 a[140:143], v[124:127], a[20:23], a[140:143]
    buffer_load_dwordx4 a[20:23], v10, s[60:63], s79 offen sc1
    s_waitcnt vmcnt(9)
    v_mfma_f32_16x16x32_bf16 a[84:87], v[112:115], a[24:27], a[84:87]
    ds_read_b64_tr_b16 v[102:103], v7 offset:25088
    ds_read_b64_tr_b16 v[104:105], v8 offset:24576
    v_mfma_f32_16x16x32_bf16 a[104:107], v[116:119], a[24:27], a[104:107]
    ds_read_b64_tr_b16 v[106:107], v8 offset:25088
    v_mfma_f32_16x16x32_bf16 a[124:127], v[120:123], a[24:27], a[124:127]
    v_mfma_f32_16x16x32_bf16 a[144:147], v[124:127], a[24:27], a[144:147]
    buffer_load_dwordx4 a[24:27], v10, s[60:63], s79 offen offset:256 sc1
    s_waitcnt vmcnt(9)
    v_mfma_f32_16x16x32_bf16 a[88:91], v[112:115], a[28:31], a[88:91]
    ds_read_b64_tr_b16 v[108:109], v9 offset:24576
    ds_read_b64_tr_b16 v[110:111], v9 offset:25088
    v_mfma_f32_16x16x32_bf16 a[108:111], v[116:119], a[28:31], a[108:111]
    v_mfma_f32_16x16x32_bf16 a[128:131], v[120:123], a[28:31], a[128:131]
    v_mfma_f32_16x16x32_bf16 a[148:151], v[124:127], a[28:31], a[148:151]
    buffer_load_dwordx4 a[28:31], v10, s[60:63], s79 offen offset:512 sc1
    s_waitcnt vmcnt(9)
    v_mfma_f32_16x16x32_bf16 a[92:95], v[112:115], a[32:35], a[92:95]
    v_mfma_f32_16x16x32_bf16 a[112:115], v[116:119], a[32:35], a[112:115]
    v_mfma_f32_16x16x32_bf16 a[132:135], v[120:123], a[32:35], a[132:135]
    v_mfma_f32_16x16x32_bf16 a[152:155], v[124:127], a[32:35], a[152:155]
    buffer_load_dwordx4 a[32:35], v10, s[60:63], s79 offen offset:768 sc1
    s_waitcnt vmcnt(9)
    v_mfma_f32_16x16x32_bf16 a[96:99], v[112:115], a[36:39], a[96:99]
    v_mfma_f32_16x16x32_bf16 a[116:119], v[116:119], a[36:39], a[116:119]
    v_mfma_f32_16x16x32_bf16 a[136:139], v[120:123], a[36:39], a[136:139]
    v_mfma_f32_16x16x32_bf16 a[156:159], v[124:127], a[36:39], a[156:159]
    buffer_load_dwordx4 a[36:39], v10, s[60:63], s79 offen offset:1024 sc1
    s_waitcnt lgkmcnt(0)
    s_waitcnt vmcnt(9)
    v_mfma_f32_16x16x32_bf16 a[80:83], v[96:99], a[0:3], a[80:83]
    s_add_u32 s79, s79, 40960
    ds_read_b64_tr_b16 v[112:113], v6 offset:28672
    v_mfma_f32_16x16x32_bf16 a[100:103], v[100:103], a[0:3], a[100:103]
    ds_read_b64_tr_b16 v[114:115], v6 offset:29184
    ds_read_b64_tr_b16 v[116:117], v7 offset:28672
    v_mfma_f32_16x16x32_bf16 a[120:123], v[104:107], a[0:3], a[120:123]
    v_mfma_f32_16x16x32_bf16 a[140:143], v[108:111], a[0:3], a[140:143]
    buffer_load_dwordx4 a[0:3], v10, s[60:63], s79 offen sc1
    s_waitcnt vmcnt(9)
    v_mfma_f32_16x16x32_bf16 a[84:87], v[96:99], a[4:7], a[84:87]
    ds_read_b64_tr_b16 v[118:119], v7 offset:29184
    ds_read_b64_tr_b16 v[120:121], v8 offset:28672
    v_mfma_f32_16x16x32_bf16 a[104:107], v[100:103], a[4:7], a[104:107]
    ds_read_b64_tr_b16 v[122:123], v8 offset:29184
    v_mfma_f32_16x16x32_bf16 a[124:127], v[104:107], a[4:7], a[124:127]
    v_mfma_f32_16x16x32_bf16 a[144:147], v[108:111], a[4:7], a[144:147]
    buffer_load_dwordx4 a[4:7], v10, s[60:63], s79 offen offset:256 sc1
    s_waitcnt vmcnt(9)
    v_mfma_f32_16x16x32_bf16 a[88:91], v[96:99], a[8:11], a[88:91]
    ds_read_b64_tr_b16 v[124:125], v9 offset:28672
    ds_read_b64_tr_b16 v[126:127], v9 offset:29184
    v_mfma_f32_16x16x32_bf16 a[108:111], v[100:103], a[8:11], a[108:111]
    v_mfma_f32_16x16x32_bf16 a[128:131], v[104:107], a[8:11], a[128:131]
    v_mfma_f32_16x16x32_bf16 a[148:151], v[108:111], a[8:11], a[148:151]
    buffer_load_dwordx4 a[8:11], v10, s[60:63], s79 offen offset:512 sc1
    s_waitcnt vmcnt(9)
    v_mfma_f32_16x16x32_bf16 a[92:95], v[96:99], a[12:15], a[92:95]
    v_mfma_f32_16x16x32_bf16 a[112:115], v[100:103], a[12:15], a[112:115]
    v_mfma_f32_16x16x32_bf16 a[132:135], v[104:107], a[12:15], a[132:135]
    v_mfma_f32_16x16x32_bf16 a[152:155], v[108:111], a[12:15], a[152:155]
    buffer_load_dwordx4 a[12:15], v10, s[60:63], s79 offen offset:768 sc1
    s_waitcnt vmcnt(9)
    v_mfma_f32_16x16x32_bf16 a[96:99], v[96:99], a[16:19], a[96:99]
    v_mfma_f32_16x16x32_bf16 a[116:119], v[100:103], a[16:19], a[116:119]
    v_mfma_f32_16x16x32_bf16 a[136:139], v[104:107], a[16:19], a[136:139]
    v_mfma_f32_16x16x32_bf16 a[156:159], v[108:111], a[16:19], a[156:159]
    buffer_load_dwordx4 a[16:19], v10, s[60:63], s79 offen offset:1024 sc1
    s_waitcnt lgkmcnt(0)
    s_waitcnt vmcnt(9)
    v_mfma_f32_16x16x32_bf16 a[80:83], v[112:115], a[20:23], a[80:83]
    s_add_u32 s79, s79, 40960
    ds_read_b64_tr_b16 v[96:97], v6 offset:0
    v_mfma_f32_16x16x32_bf16 a[100:103], v[116:119], a[20:23], a[100:103]
    ds_read_b64_tr_b16 v[98:99], v6 offset:512
    ds_read_b64_tr_b16 v[100:101], v7 offset:0
    v_mfma_f32_16x16x32_bf16 a[120:123], v[120:123], a[20:23], a[120:123]
    v_mfma_f32_16x16x32_bf16 a[140:143], v[124:127], a[20:23], a[140:143]
    buffer_load_dwordx4 a[20:23], v10, s[60:63], s79 offen sc1
    s_waitcnt vmcnt(9)
    v_mfma_f32_16x16x32_bf16 a[84:87], v[112:115], a[24:27], a[84:87]
    ds_read_b64_tr_b16 v[102:103], v7 offset:512
    ds_read_b64_tr_b16 v[104:105], v8 offset:0
    v_mfma_f32_16x16x32_bf16 a[104:107], v[116:119], a[24:27], a[104:107]
    ds_read_b64_tr_b16 v[106:107], v8 offset:512
    v_mfma_f32_16x16x32_bf16 a[124:127], v[120:123], a[24:27], a[124:127]
    v_mfma_f32_16x16x32_bf16 a[144:147], v[124:127], a[24:27], a[144:147]
    buffer_load_dwordx4 a[24:27], v10, s[60:63], s79 offen offset:256 sc1
    s_waitcnt vmcnt(9)
    v_mfma_f32_16x16x32_bf16 a[88:91], v[112:115], a[28:31], a[88:91]
    ds_read_b64_tr_b16 v[108:109], v9 offset:0
    ds_read_b64_tr_b16 v[110:111], v9 offset:512
    v_mfma_f32_16x16x32_bf16 a[108:111], v[116:119], a[28:31], a[108:111]
    v_mfma_f32_16x16x32_bf16 a[128:131], v[120:123], a[28:31], a[128:131]
    v_mfma_f32_16x16x32_bf16 a[148:151], v[124:127], a[28:31], a[148:151]
    buffer_load_dwordx4 a[28:31], v10, s[60:63], s79 offen offset:512 sc1
    s_waitcnt vmcnt(9)
    v_mfma_f32_16x16x32_bf16 a[92:95], v[112:115], a[32:35], a[92:95]
    v_mfma_f32_16x16x32_bf16 a[112:115], v[116:119], a[32:35], a[112:115]
    v_mfma_f32_16x16x32_bf16 a[132:135], v[120:123], a[32:35], a[132:135]
    v_mfma_f32_16x16x32_bf16 a[152:155], v[124:127], a[32:35], a[152:155]
    buffer_load_dwordx4 a[32:35], v10, s[60:63], s79 offen offset:768 sc1
    s_waitcnt vmcnt(9)
    v_mfma_f32_16x16x32_bf16 a[96:99], v[112:115], a[36:39], a[96:99]
    v_mfma_f32_16x16x32_bf16 a[116:119], v[116:119], a[36:39], a[116:119]
    v_mfma_f32_16x16x32_bf16 a[136:139], v[120:123], a[36:39], a[136:139]
    v_mfma_f32_16x16x32_bf16 a[156:159], v[124:127], a[36:39], a[156:159]
    buffer_load_dwordx4 a[36:39], v10, s[60:63], s79 offen offset:1024 sc1
    s_waitcnt lgkmcnt(0)
    s_waitcnt vmcnt(9)
    v_mfma_f32_16x16x32_bf16 a[80:83], v[96:99], a[0:3], a[80:83]
    s_cmp_ge_u32 s12, 1
    s_cselect_b32 s79, s77, 0
    v_mfma_f32_16x16x32_bf16 a[100:103], v[100:103], a[0:3], a[100:103]
    s_add_u32 s79, s79, s76
    s_add_u32 s79, s79, 737280
    v_mfma_f32_16x16x32_bf16 a[120:123], v[104:107], a[0:3], a[120:123]
    ds_read_b64_tr_b16 v[112:113], v6 offset:4096
    ds_read_b64_tr_b16 v[114:115], v6 offset:4608
    v_mfma_f32_16x16x32_bf16 a[140:143], v[108:111], a[0:3], a[140:143]
    buffer_load_dwordx4 a[0:3], v10, s[60:63], s79 offen sc1
    s_waitcnt vmcnt(9)
    v_mfma_f32_16x16x32_bf16 a[84:87], v[96:99], a[4:7], a[84:87]
    ds_read_b64_tr_b16 v[116:117], v7 offset:4096
    ds_read_b64_tr_b16 v[118:119], v7 offset:4608
    v_mfma_f32_16x16x32_bf16 a[104:107], v[100:103], a[4:7], a[104:107]
    ds_read_b64_tr_b16 v[120:121], v8 offset:4096
    ds_read_b64_tr_b16 v[122:123], v8 offset:4608
    v_mfma_f32_16x16x32_bf16 a[124:127], v[104:107], a[4:7], a[124:127]
    v_mfma_f32_16x16x32_bf16 a[144:147], v[108:111], a[4:7], a[144:147]
    buffer_load_dwordx4 a[4:7], v10, s[60:63], s79 offen offset:256 sc1
    s_waitcnt vmcnt(9)
    v_mfma_f32_16x16x32_bf16 a[88:91], v[96:99], a[8:11], a[88:91]
    ds_read_b64_tr_b16 v[124:125], v9 offset:4096
    ds_read_b64_tr_b16 v[126:127], v9 offset:4608
    v_mfma_f32_16x16x32_bf16 a[108:111], v[100:103], a[8:11], a[108:111]
    v_mfma_f32_16x16x32_bf16 a[128:131], v[104:107], a[8:11], a[128:131]
    v_mfma_f32_16x16x32_bf16 a[148:151], v[108:111], a[8:11], a[148:151]
    buffer_load_dwordx4 a[8:11], v10, s[60:63], s79 offen offset:512 sc1
    s_waitcnt vmcnt(9)
    v_mfma_f32_16x16x32_bf16 a[92:95], v[96:99], a[12:15], a[92:95]
    v_mfma_f32_16x16x32_bf16 a[112:115], v[100:103], a[12:15], a[112:115]
    v_mfma_f32_16x16x32_bf16 a[132:135], v[104:107], a[12:15], a[132:135]
    v_mfma_f32_16x16x32_bf16 a[152:155], v[108:111], a[12:15], a[152:155]
    buffer_load_dwordx4 a[12:15], v10, s[60:63], s79 offen offset:768 sc1
    s_waitcnt vmcnt(9)
    v_mfma_f32_16x16x32_bf16 a[96:99], v[96:99], a[16:19], a[96:99]
    v_mfma_f32_16x16x32_bf16 a[116:119], v[100:103], a[16:19], a[116:119]
    v_mfma_f32_16x16x32_bf16 a[136:139], v[104:107], a[16:19], a[136:139]
    v_mfma_f32_16x16x32_bf16 a[156:159], v[108:111], a[16:19], a[156:159]
    buffer_load_dwordx4 a[16:19], v10, s[60:63], s79 offen offset:1024 sc1
    s_waitcnt lgkmcnt(0)
    s_waitcnt vmcnt(9)
    v_mfma_f32_16x16x32_bf16 a[80:83], v[112:115], a[20:23], a[80:83]
    ds_read_b64_tr_b16 v[96:97], v6 offset:8192
    ds_read_b64_tr_b16 v[98:99], v6 offset:8704
    v_mfma_f32_16x16x32_bf16 a[100:103], v[116:119], a[20:23], a[100:103]
    ds_read_b64_tr_b16 v[100:101], v7 offset:8192
    v_mfma_f32_16x16x32_bf16 a[120:123], v[120:123], a[20:23], a[120:123]
    v_mfma_f32_16x16x32_bf16 a[140:143], v[124:127], a[20:23], a[140:143]
    s_waitcnt vmcnt(8)
    v_mfma_f32_16x16x32_bf16 a[84:87], v[112:115], a[24:27], a[84:87]
    ds_read_b64_tr_b16 v[102:103], v7 offset:8704
    ds_read_b64_tr_b16 v[104:105], v8 offset:8192
    v_mfma_f32_16x16x32_bf16 a[104:107], v[116:119], a[24:27], a[104:107]
    ds_read_b64_tr_b16 v[106:107], v8 offset:8704
    v_mfma_f32_16x16x32_bf16 a[124:127], v[120:123], a[24:27], a[124:127]
    v_mfma_f32_16x16x32_bf16 a[144:147], v[124:127], a[24:27], a[144:147]
    s_waitcnt vmcnt(7)
    v_mfma_f32_16x16x32_bf16 a[88:91], v[112:115], a[28:31], a[88:91]
    ds_read_b64_tr_b16 v[108:109], v9 offset:8192
    ds_read_b64_tr_b16 v[110:111], v9 offset:8704
    v_mfma_f32_16x16x32_bf16 a[108:111], v[116:119], a[28:31], a[108:111]
    v_mfma_f32_16x16x32_bf16 a[128:131], v[120:123], a[28:31], a[128:131]
    v_mfma_f32_16x16x32_bf16 a[148:151], v[124:127], a[28:31], a[148:151]
    s_waitcnt vmcnt(6)
    v_mfma_f32_16x16x32_bf16 a[92:95], v[112:115], a[32:35], a[92:95]
    v_mfma_f32_16x16x32_bf16 a[112:115], v[116:119], a[32:35], a[112:115]
    v_mfma_f32_16x16x32_bf16 a[132:135], v[120:123], a[32:35], a[132:135]
    v_mfma_f32_16x16x32_bf16 a[152:155], v[124:127], a[32:35], a[152:155]
    s_waitcnt vmcnt(5)
    v_mfma_f32_16x16x32_bf16 a[96:99], v[112:115], a[36:39], a[96:99]
    v_mfma_f32_16x16x32_bf16 a[116:119], v[116:119], a[36:39], a[116:119]
    v_mfma_f32_16x16x32_bf16 a[136:139], v[120:123], a[36:39], a[136:139]
    v_mfma_f32_16x16x32_bf16 a[156:159], v[124:127], a[36:39], a[156:159]
    s_waitcnt lgkmcnt(0)
    s_waitcnt vmcnt(4)
    v_mfma_f32_16x16x32_bf16 a[100:103], v[100:103], a[0:3], a[100:103]
    s_waitcnt vmcnt(3)
    v_mfma_f32_16x16x32_bf16 a[104:107], v[100:103], a[4:7], a[104:107]
    s_waitcnt vmcnt(2)
    v_mfma_f32_16x16x32_bf16 a[108:111], v[100:103], a[8:11], a[108:111]
    s_waitcnt vmcnt(1)
    v_mfma_f32_16x16x32_bf16 a[112:115], v[100:103], a[12:15], a[112:115]
    s_waitcnt vmcnt(0)
    v_mfma_f32_16x16x32_bf16 a[116:119], v[100:103], a[16:19], a[116:119]
    s_add_u32 s78, s74, 0
    s_add_u32 m0, s72, 16384
    s_nop 0
    buffer_load_dwordx4 v2, s[56:59], s78 offen lds
    v_mfma_f32_16x16x32_bf16 a[120:123], v[104:107], a[0:3], a[120:123]
    ds_write_b128 v11, a[100:103] offset:0
    v_mfma_f32_16x16x32_bf16 a[124:127], v[104:107], a[4:7], a[124:127]
    ds_write_b128 v11, a[104:107] offset:1024
    v_mfma_f32_16x16x32_bf16 a[128:131], v[104:107], a[8:11], a[128:131]
    ds_write_b128 v11, a[108:111] offset:2048
    v_mfma_f32_16x16x32_bf16 a[132:135], v[104:107], a[12:15], a[132:135]
    ds_write_b128 v11, a[112:115] offset:3072
    v_mfma_f32_16x16x32_bf16 a[136:139], v[104:107], a[16:19], a[136:139]
    ds_write_b128 v11, a[116:119] offset:4096
    buffer_load_dwordx4 v3, s[56:59], s78 offen offset:1024 lds
    v_mfma_f32_16x16x32_bf16 a[140:143], v[108:111], a[0:3], a[140:143]
    ds_write_b128 v11, a[120:123] offset:5120
    v_mfma_f32_16x16x32_bf16 a[144:147], v[108:111], a[4:7], a[144:147]
    ds_write_b128 v11, a[124:127] offset:6144
    v_mfma_f32_16x16x32_bf16 a[148:151], v[108:111], a[8:11], a[148:151]
    ds_write_b128 v11, a[128:131] offset:7168
    v_mfma_f32_16x16x32_bf16 a[152:155], v[108:111], a[12:15], a[152:155]
    ds_write_b128 v11, a[132:135] offset:8192
    v_mfma_f32_16x16x32_bf16 a[156:159], v[108:111], a[16:19], a[156:159]
    ds_write_b128 v11, a[136:139] offset:9216
    buffer_load_dwordx4 v4, s[56:59], s78 offen offset:2048 lds
    v_mfma_f32_16x16x32_bf16 a[80:83], v[96:99], a[0:3], a[80:83]
    ds_write_b128 v11, a[140:143] offset:10240
    v_mfma_f32_16x16x32_bf16 a[84:87], v[96:99], a[4:7], a[84:87]
    v_mfma_f32_16x16x32_bf16 a[88:91], v[96:99], a[8:11], a[88:91]
    v_mfma_f32_16x16x32_bf16 a[92:95], v[96:99], a[12:15], a[92:95]
    v_mfma_f32_16x16x32_bf16 a[96:99], v[96:99], a[16:19], a[96:99]
    buffer_load_dwordx4 v5, s[56:59], s78 offen offset:3072 lds
    ds_write_b128 v11, a[144:147] offset:11264
    ds_write_b128 v11, a[148:151] offset:12288
    ds_write_b128 v11, a[152:155] offset:13312
    ds_write_b128 v11, a[156:159] offset:14336
L_loop1e:
    v_accvgpr_read_b32 v32, a80
    v_accvgpr_read_b32 v33, a81
    v_accvgpr_read_b32 v34, a82
    v_accvgpr_read_b32 v35, a83
    v_accvgpr_read_b32 v36, a84
    v_accvgpr_read_b32 v37, a85
    v_accvgpr_read_b32 v38, a86
    v_accvgpr_read_b32 v39, a87
    v_accvgpr_read_b32 v40, a88
    v_accvgpr_read_b32 v41, a89
    v_accvgpr_read_b32 v42, a90
    v_accvgpr_read_b32 v43, a91
    v_accvgpr_read_b32 v44, a92
    v_accvgpr_read_b32 v45, a93
    v_accvgpr_read_b32 v46, a94
    v_accvgpr_read_b32 v47, a95
    v_accvgpr_read_b32 v48, a96
    v_accvgpr_read_b32 v49, a97
    v_accvgpr_read_b32 v50, a98
    v_accvgpr_read_b32 v51, a99
    s_mul_i32 s80, s7, 81920
    s_mul_i32 s15, s6, 1280
    s_add_u32 s80, s80, s15
    s_waitcnt lgkmcnt(0)
    s_barrier
    ds_read_b128 v[52:55], v12 offset:0
    ds_read_b128 v[56:59], v13 offset:5120
    ds_read_b128 v[60:63], v14 offset:10240
    ds_read_b128 v[64:67], v12 offset:1024
    ds_read_b128 v[68:71], v13 offset:6144
    ds_read_b128 v[72:75], v14 offset:11264
    ds_read_b128 v[76:79], v12 offset:2048
    ds_read_b128 v[80:83], v13 offset:7168
    ds_read_b128 v[84:87], v14 offset:12288
    ds_read_b128 v[88:91], v12 offset:3072
    ds_read_b128 v[92:95], v13 offset:8192
    ds_read_b128 v[96:99], v14 offset:13312
    ds_read_b128 v[100:103], v12 offset:4096
    ds_read_b128 v[104:107], v13 offset:9216
    ds_read_b128 v[108:111], v14 offset:14336
    v_pk_add_f32 v[32:33], v[32:33], v[24:25]
    v_pk_add_f32 v[34:35], v[34:35], v[26:27]
    v_pk_add_f32 v[36:37], v[36:37], v[24:25]
    v_pk_add_f32 v[38:39], v[38:39], v[26:27]
    v_pk_add_f32 v[40:41], v[40:41], v[24:25]
    v_pk_add_f32 v[42:43], v[42:43], v[26:27]
    v_pk_add_f32 v[44:45], v[44:45], v[24:25]
    v_pk_add_f32 v[46:47], v[46:47], v[26:27]
    v_pk_add_f32 v[48:49], v[48:49], v[24:25]
    v_pk_add_f32 v[50:51], v[50:51], v[26:27]
    s_add_u32 s78, s74, 131072
    s_add_u32 m0, s72, 20480
    s_nop 0
    buffer_load_dwordx4 v2, s[56:59], s78 offen lds
    buffer_load_dwordx4 v3, s[56:59], s78 offen offset:1024 lds
    buffer_load_dwordx4 v4, s[56:59], s78 offen offset:2048 lds
    buffer_load_dwordx4 v5, s[56:59], s78 offen offset:3072 lds
    s_add_u32 s78, s78, 131072
    s_add_u32 m0, s72, 24576
    s_nop 0
    buffer_load_dwordx4 v2, s[56:59], s78 offen lds
    buffer_load_dwordx4 v3, s[56:59], s78 offen offset:1024 lds
    s_waitcnt lgkmcnt(12)
    v_pk_add_f32 v[32:33], v[32:33], v[52:53]
    v_pk_add_f32 v[56:57], v[56:57], v[60:61]
    v_pk_add_f32 v[34:35], v[34:35], v[54:55]
    v_pk_add_f32 v[58:59], v[58:59], v[62:63]
    v_pk_add_f32 v[32:33], v[32:33], v[56:57]
    v_pk_add_f32 v[34:35], v[34:35], v[58:59]
    v_pk_mul_f32 v[112:113], v[32:33], v[32:33]
    v_pk_mul_f32 v[116:117], v[34:35], v[34:35]
    v_pk_fma_f32 v[112:113], v[112:113], s[100:101], s[100:101] op_sel:[0,0,1] op_sel_hi:[1,0,1]
    v_pk_fma_f32 v[116:117], v[116:117], s[100:101], s[100:101] op_sel:[0,0,1] op_sel_hi:[1,0,1]
    v_pk_mul_f32 v[112:113], v[112:113], v[32:33]
    v_pk_mul_f32 v[116:117], v[116:117], v[34:35]
    v_exp_f32 v112, v112
    v_exp_f32 v113, v113
    v_exp_f32 v116, v116
    v_exp_f32 v117, v117
    buffer_load_dwordx4 v4, s[56:59], s78 offen offset:2048 lds
    v_pk_add_f32 v[112:113], v[112:113], 1.0 op_sel_hi:[1,0]
    v_pk_add_f32 v[116:117], v[116:117], 1.0 op_sel_hi:[1,0]
    v_rcp_f32 v112, v112
    v_rcp_f32 v113, v113
    v_rcp_f32 v116, v116
    v_rcp_f32 v117, v117
    v_pk_mul_f32 v[32:33], v[32:33], v[112:113]
    v_pk_mul_f32 v[34:35], v[34:35], v[116:117]
    v_cvt_pk_bf16_f32 v52, v32, v33
    v_cvt_pk_bf16_f32 v53, v34, v35
    s_waitcnt lgkmcnt(9)
    v_pk_add_f32 v[36:37], v[36:37], v[64:65]
    v_pk_add_f32 v[68:69], v[68:69], v[72:73]
    v_pk_add_f32 v[38:39], v[38:39], v[66:67]
    v_pk_add_f32 v[70:71], v[70:71], v[74:75]
    v_pk_add_f32 v[36:37], v[36:37], v[68:69]
    v_pk_add_f32 v[38:39], v[38:39], v[70:71]
    buffer_load_dwordx4 v5, s[56:59], s78 offen offset:3072 lds
    v_pk_mul_f32 v[112:113], v[36:37], v[36:37]
    v_pk_mul_f32 v[116:117], v[38:39], v[38:39]
    v_pk_fma_f32 v[112:113], v[112:113], s[100:101], s[100:101] op_sel:[0,0,1] op_sel_hi:[1,0,1]
    v_pk_fma_f32 v[116:117], v[116:117], s[100:101], s[100:101] op_sel:[0,0,1] op_sel_hi:[1,0,1]
    v_pk_mul_f32 v[112:113], v[112:113], v[36:37]
    v_pk_mul_f32 v[116:117], v[116:117], v[38:39]
    v_exp_f32 v112, v112
    v_exp_f32 v113, v113
    v_exp_f32 v116, v116
    v_exp_f32 v117, v117
    v_pk_add_f32 v[112:113], v[112:113], 1.0 op_sel_hi:[1,0]
    v_pk_add_f32 v[116:117], v[116:117], 1.0 op_sel_hi:[1,0]
    v_rcp_f32 v112, v112
    v_rcp_f32 v113, v113
    v_rcp_f32 v116, v116
    v_rcp_f32 v117, v117
    s_add_u32 s78, s78, 131072
    s_add_u32 m0, s72, 28672
    s_nop 0
    buffer_load_dwordx4 v2, s[56:59], s78 offen lds
    v_pk_mul_f32 v[36:37], v[36:37], v[112:113]
    v_pk_mul_f32 v[38:39], v[38:39], v[116:117]
    v_cvt_pk_bf16_f32 v54, v36, v37
    v_cvt_pk_bf16_f32 v55, v38, v39
    s_waitcnt lgkmcnt(6)
    v_pk_add_f32 v[40:41], v[40:41], v[76:77]
    v_pk_add_f32 v[80:81], v[80:81], v[84:85]
    v_pk_add_f32 v[42:43], v[42:43], v[78:79]
    v_pk_add_f32 v[82:83], v[82:83], v[86:87]
    v_pk_add_f32 v[40:41], v[40:41], v[80:81]
    v_pk_add_f32 v[42:43], v[42:43], v[82:83]
    v_pk_mul_f32 v[112:113], v[40:41], v[40:41]
    v_pk_mul_f32 v[116:117], v[42:43], v[42:43]
    v_pk_fma_f32 v[112:113], v[112:113], s[100:101], s[100:101] op_sel:[0,0,1] op_sel_hi:[1,0,1]
    v_pk_fma_f32 v[116:117], v[116:117], s[100:101], s[100:101] op_sel:[0,0,1] op_sel_hi:[1,0,1]
    v_pk_mul_f32 v[112:113], v[112:113], v[40:41]
    v_pk_mul_f32 v[116:117], v[116:117], v[42:43]
    buffer_load_dwordx4 v3, s[56:59], s78 offen offset:1024 lds
    v_exp_f32 v112, v112
    v_exp_f32 v113, v113
    v_exp_f32 v116, v116
    v_exp_f32 v117, v117
    v_pk_add_f32 v[112:113], v[112:113], 1.0 op_sel_hi:[1,0]
    v_pk_add_f32 v[116:117], v[116:117], 1.0 op_sel_hi:[1,0]
    v_rcp_f32 v112, v112
    v_rcp_f32 v113, v113
    v_rcp_f32 v116, v116
    v_rcp_f32 v117, v117
    v_pk_mul_f32 v[40:41], v[40:41], v[112:113]
    v_pk_mul_f32 v[42:43], v[42:43], v[116:117]
    v_cvt_pk_bf16_f32 v56, v40, v41
    v_cvt_pk_bf16_f32 v57, v42, v43
    s_waitcnt lgkmcnt(3)
    v_pk_add_f32 v[44:45], v[44:45], v[88:89]
    v_pk_add_f32 v[92:93], v[92:93], v[96:97]
    buffer_load_dwordx4 v4, s[56:59], s78 offen offset:2048 lds
    v_pk_add_f32 v[46:47], v[46:47], v[90:91]
    v_pk_add_f32 v[94:95], v[94:95], v[98:99]
    v_pk_add_f32 v[44:45], v[44:45], v[92:93]
    v_pk_add_f32 v[46:47], v[46:47], v[94:95]
    v_pk_mul_f32 v[112:113], v[44:45], v[44:45]
    v_pk_mul_f32 v[116:117], v[46:47], v[46:47]
    v_pk_fma_f32 v[112:113], v[112:113], s[100:101], s[100:101] op_sel:[0,0,1] op_sel_hi:[1,0,1]
    v_pk_fma_f32 v[116:117], v[116:117], s[100:101], s[100:101] op_sel:[0,0,1] op_sel_hi:[1,0,1]
    v_pk_mul_f32 v[112:113], v[112:113], v[44:45]
    v_pk_mul_f32 v[116:117], v[116:117], v[46:47]
    v_exp_f32 v112, v112
    v_exp_f32 v113, v113
    v_exp_f32 v116, v116
    v_exp_f32 v117, v117
    v_pk_add_f32 v[112:113], v[112:113], 1.0 op_sel_hi:[1,0]
    v_pk_add_f32 v[116:117], v[116:117], 1.0 op_sel_hi:[1,0]
    buffer_load_dwordx4 v5, s[56:59], s78 offen offset:3072 lds
    v_rcp_f32 v112, v112
    v_rcp_f32 v113, v113
    v_rcp_f32 v116, v116
    v_rcp_f32 v117, v117
    v_pk_mul_f32 v[44:45], v[44:45], v[112:113]
    v_pk_mul_f32 v[46:47], v[46:47], v[116:117]
    v_cvt_pk_bf16_f32 v58, v44, v45
    v_cvt_pk_bf16_f32 v59, v46, v47
    s_waitcnt lgkmcnt(0)
    v_pk_add_f32 v[48:49], v[48:49], v[100:101]
    v_pk_add_f32 v[104:105], v[104:105], v[108:109]
    v_pk_add_f32 v[50:51], v[50:51], v[102:103]
    v_pk_add_f32 v[106:107], v[106:107], v[110:111]
    v_pk_add_f32 v[48:49], v[48:49], v[104:105]
    v_pk_add_f32 v[50:51], v[50:51], v[106:107]
    s_barrier
    v_pk_mul_f32 v[112:113], v[48:49], v[48:49]
    v_pk_mul_f32 v[116:117], v[50:51], v[50:51]
    v_pk_fma_f32 v[112:113], v[112:113], s[100:101], s[100:101] op_sel:[0,0,1] op_sel_hi:[1,0,1]
    v_pk_fma_f32 v[116:117], v[116:117], s[100:101], s[100:101] op_sel:[0,0,1] op_sel_hi:[1,0,1]
    v_pk_mul_f32 v[112:113], v[112:113], v[48:49]
    v_pk_mul_f32 v[116:117], v[116:117], v[50:51]
    v_exp_f32 v112, v112
    v_exp_f32 v113, v113
    v_exp_f32 v116, v116
    v_exp_f32 v117, v117
    v_pk_add_f32 v[112:113], v[112:113], 1.0 op_sel_hi:[1,0]
    v_pk_add_f32 v[116:117], v[116:117], 1.0 op_sel_hi:[1,0]
    v_rcp_f32 v112, v112
    v_rcp_f32 v113, v113
    v_rcp_f32 v116, v116
    v_rcp_f32 v117, v117
    v_pk_mul_f32 v[48:49], v[48:49], v[112:113]
    v_pk_mul_f32 v[50:51], v[50:51], v[116:117]
    v_cvt_pk_bf16_f32 v60, v48, v49
    v_cvt_pk_bf16_f32 v61, v50, v51
    v_mov_b32 v62, v60
    v_mov_b32 v63, v61
    v_permlane16_swap_b32 v52, v54
    v_permlane16_swap_b32 v53, v55
    v_permlane16_swap_b32 v56, v58
    v_permlane16_swap_b32 v57, v59
    v_permlane16_swap_b32 v60, v62
    v_permlane16_swap_b32 v61, v63
    buffer_store_dwordx4 v[52:55], v28, s[64:67], s80 offen sc1
    buffer_store_dwordx4 v[56:59], v28, s[64:67], s80 offen offset:512 sc1
    s_mov_b32 exec_lo, 0xffff
    s_mov_b32 exec_hi, 0xffff
    buffer_store_dwordx4 v[60:63], v28, s[64:67], s80 offen offset:1024 sc1
    s_mov_b64 exec, -1
    s_cmp_lg_u32 s3, 3
    s_cbranch_scc1 L_gap2
    v_mov_b32 v20, 157280
    ds_read_b128 v[32:35], v20
    v_mov_b32 v20, 0
    s_lshl_b32 s14, s2, 4
    s_add_u32 s14, s14, 0x80000
    s_waitcnt lgkmcnt(0)
    s_mov_b64 exec, 1
    buffer_store_dwordx4 v[32:35], v20, s[60:63], s14 offen sc1
    s_mov_b64 exec, -1
    s_add_u32 s78, s74, 1048576
    buffer_load_dwordx4 a[80:83], v2, s[56:59], s78 offen
    buffer_load_dwordx4 a[84:87], v3, s[56:59], s78 offen offset:1024
    buffer_load_dwordx4 a[88:91], v4, s[56:59], s78 offen offset:2048
    buffer_load_dwordx4 a[92:95], v5, s[56:59], s78 offen offset:3072
    s_waitcnt vmcnt(4)
    v_mov_b32 v20, 157300
    s_mov_b32 s84, 0
L_cntG:
    ds_read_b32 v21, v20
    s_waitcnt lgkmcnt(0)
    v_readfirstlane_b32 s14, v21
    s_nop 0
    s_cmp_ge_u32 s14, 3
    s_cbranch_scc1 L_cntG_ok
    s_sleep 1
    s_add_u32 s84, s84, 1
    s_cmp_lt_u32 s84, 0x80000
    s_cbranch_scc1 L_cntG
L_cntG_ok:
    s_lshl_b32 s14, s6, 5
    s_add_u32 s14, s14, s7
    v_mov_b32 v24, s4
    v_mov_b32 v25, s4
    v_mov_b32 v26, s4
    v_mov_b32 v27, s4
    v_mul_u32_u24 v28, 4096, v0
    s_lshl_b32 s85, s14, 4
    s_add_u32 s85, s85, 0x30000
    s_mov_b64 exec, 0xff
    buffer_store_dwordx4 v[24:27], v28, s[60:63], s85 offen sc1
    s_mov_b64 exec, -1
    s_nop 0
    v_mov_b32 v24, s4
    v_mov_b32 v25, s4
    v_mov_b32 v26, s4
    v_mov_b32 v27, s4
    v_mul_u32_u24 v28, 4096, v0
    s_lshl_b32 s85, s2, 4
    s_add_u32 s85, s85, 0x60000
    s_mov_b64 exec, 0xff
    buffer_store_dwordx4 v[24:27], v28, s[60:63], s85 offen sc1
    s_mov_b64 exec, -1
    s_add_u32 s78, s78, 131072
    buffer_load_dwordx4 a[96:99], v2, s[56:59], s78 offen
    buffer_load_dwordx4 a[100:103], v3, s[56:59], s78 offen offset:1024
    buffer_load_dwordx4 a[104:107], v4, s[56:59], s78 offen offset:2048
    buffer_load_dwordx4 a[108:111], v5, s[56:59], s78 offen offset:3072
    s_add_u32 s78, s78, 131072
    buffer_load_dwordx4 a[40:43], v2, s[56:59], s78 offen
    buffer_load_dwordx4 a[44:47], v3, s[56:59], s78 offen offset:1024
    buffer_load_dwordx4 a[48:51], v4, s[56:59], s78 offen offset:2048
    buffer_load_dwordx4 a[52:55], v5, s[56:59], s78 offen offset:3072
    s_add_u32 s78, s78, 131072
    buffer_load_dwordx4 a[56:59], v2, s[56:59], s78 offen
    buffer_load_dwordx4 a[60:63], v3, s[56:59], s78 offen offset:1024
    buffer_load_dwordx4 a[64:67], v4, s[56:59], s78 offen offset:2048
    buffer_load_dwordx4 a[68:71], v5, s[56:59], s78 offen offset:3072
    s_add_u32 s78, s78, 131072
    buffer_load_dwordx4 a[224:227], v2, s[56:59], s78 offen
    buffer_load_dwordx4 a[228:231], v3, s[56:59], s78 offen offset:1024
    buffer_load_dwordx4 a[232:235], v4, s[56:59], s78 offen offset:2048
    buffer_load_dwordx4 a[236:239], v5, s[56:59], s78 offen offset:3072
    s_add_u32 s78, s78, 131072
    buffer_load_dwordx4 a[240:243], v2, s[56:59], s78 offen
    buffer_load_dwordx4 a[244:247], v3, s[56:59], s78 offen offset:1024
    buffer_load_dwordx4 a[248:251], v4, s[56:59], s78 offen offset:2048
    buffer_load_dwordx4 a[252:255], v5, s[56:59], s78 offen offset:3072
    s_add_u32 s78, s78, 131072
    buffer_load_dwordx4 a[112:115], v2, s[56:59], s78 offen
    buffer_load_dwordx4 a[116:119], v3, s[56:59], s78 offen offset:1024
    buffer_load_dwordx4 a[120:123], v4, s[56:59], s78 offen offset:2048
    buffer_load_dwordx4 a[124:127], v5, s[56:59], s78 offen offset:3072
    s_add_u32 s78, s74, -4587520
    s_mov_b32 m0, 0
    s_nop 0
    buffer_load_dwordx4 v2, s[56:59], s78 offen lds
    buffer_load_dwordx4 v3, s[56:59], s78 offen offset:1024 lds
    buffer_load_dwordx4 v4, s[56:59], s78 offen offset:2048 lds
    buffer_load_dwordx4 v5, s[56:59], s78 offen offset:3072 lds
    s_add_u32 s78, s78, 1703936
    s_mov_b32 m0, 32768
    s_nop 0
    buffer_load_dwordx4 v2, s[56:59], s78 offen lds
    buffer_load_dwordx4 v3, s[56:59], s78 offen offset:1024 lds
    buffer_load_dwordx4 v4, s[56:59], s78 offen offset:2048 lds
    buffer_load_dwordx4 v5, s[56:59], s78 offen offset:3072 lds
    s_add_u32 s78, s78, 1703936
    s_mov_b32 m0, 65536
    s_nop 0
    buffer_load_dwordx4 v2, s[56:59], s78 offen lds
    buffer_load_dwordx4 v3, s[56:59], s78 offen offset:1024 lds
    buffer_load_dwordx4 v4, s[56:59], s78 offen offset:2048 lds
    buffer_load_dwordx4 v5, s[56:59], s78 offen offset:3072 lds
    s_add_u32 s78, s74, 524288
    s_mov_b32 m0, 98304
    s_nop 0
    buffer_load_dwordx4 v2, s[56:59], s78 offen lds
    buffer_load_dwordx4 v3, s[56:59], s78 offen offset:1024 lds
    buffer_load_dwordx4 v4, s[56:59], s78 offen offset:2048 lds
    buffer_load_dwordx4 v5, s[56:59], s78 offen offset:3072 lds
    s_add_u32 s78, s74, -4456448
    s_mov_b32 m0, 4096
    s_nop 0
    buffer_load_dwordx4 v2, s[56:59], s78 offen lds
    buffer_load_dwordx4 v3, s[56:59], s78 offen offset:1024 lds
    buffer_load_dwordx4 v4, s[56:59], s78 offen offset:2048 lds
    buffer_load_dwordx4 v5, s[56:59], s78 offen offset:3072 lds
    s_add_u32 s78, s78, 1703936
    s_mov_b32 m0, 36864
    s_nop 0
    buffer_load_dwordx4 v2, s[56:59], s78 offen lds
    buffer_load_dwordx4 v3, s[56:59], s78 offen offset:1024 lds
    buffer_load_dwordx4 v4, s[56:59], s78 offen offset:2048 lds
    buffer_load_dwordx4 v5, s[56:59], s78 offen offset:3072 lds
    s_add_u32 s78, s78, 1703936
    s_mov_b32 m0, 69632
    s_nop 0
    buffer_load_dwordx4 v2, s[56:59], s78 offen lds
    buffer_load_dwordx4 v3, s[56:59], s78 offen offset:1024 lds
    buffer_load_dwordx4 v4, s[56:59], s78 offen offset:2048 lds
    buffer_load_dwordx4 v5, s[56:59], s78 offen offset:3072 lds
    s_add_u32 s78, s74, 655360
    s_mov_b32 m0, 102400
    s_nop 0
    buffer_load_dwordx4 v2, s[56:59], s78 offen lds
    buffer_load_dwordx4 v3, s[56:59], s78 offen offset:1024 lds
    buffer_load_dwordx4 v4, s[56:59], s78 offen offset:2048 lds
    buffer_load_dwordx4 v5, s[56:59], s78 offen offset:3072 lds
    s_add_u32 s78, s74, -4325376
    s_mov_b32 m0, 8192
    s_nop 0
    buffer_load_dwordx4 v2, s[56:59], s78 offen lds
    buffer_load_dwordx4 v3, s[56:59], s78 offen offset:1024 lds
    buffer_load_dwordx4 v4, s[56:59], s78 offen offset:2048 lds
    buffer_load_dwordx4 v5, s[56:59], s78 offen offset:3072 lds
    s_add_u32 s78, s78, 1703936
    s_mov_b32 m0, 40960
    s_nop 0
    buffer_load_dwordx4 v2, s[56:59], s78 offen lds
    buffer_load_dwordx4 v3, s[56:59], s78 offen offset:1024 lds
    buffer_load_dwordx4 v4, s[56:59], s78 offen offset:2048 lds
    buffer_load_dwordx4 v5, s[56:59], s78 offen offset:3072 lds
    s_add_u32 s78, s78, 1703936
    s_mov_b32 m0, 73728
    s_nop 0
    buffer_load_dwordx4 v2, s[56:59], s78 offen lds
    buffer_load_dwordx4 v3, s[56:59], s78 offen offset:1024 lds
    buffer_load_dwordx4 v4, s[56:59], s78 offen offset:2048 lds
    buffer_load_dwordx4 v5, s[56:59], s78 offen offset:3072 lds
    s_add_u32 s78, s74, 786432
    s_mov_b32 m0, 106496
    s_nop 0
    buffer_load_dwordx4 v2, s[56:59], s78 offen lds
    buffer_load_dwordx4 v3, s[56:59], s78 offen offset:1024 lds
    buffer_load_dwordx4 v4, s[56:59], s78 offen offset:2048 lds
    buffer_load_dwordx4 v5, s[56:59], s78 offen offset:3072 lds
    s_add_u32 s78, s74, -4194304
    s_mov_b32 m0, 12288
    s_nop 0
    buffer_load_dwordx4 v2, s[56:59], s78 offen lds
    buffer_load_dwordx4 v3, s[56:59], s78 offen offset:1024 lds
    buffer_load_dwordx4 v4, s[56:59], s78 offen offset:2048 lds
    buffer_load_dwordx4 v5, s[56:59], s78 offen offset:3072 lds
    s_add_u32 s78, s78, 1703936
    s_mov_b32 m0, 45056
    s_nop 0
    buffer_load_dwordx4 v2, s[56:59], s78 offen lds
    buffer_load_dwordx4 v3, s[56:59], s78 offen offset:1024 lds
    buffer_load_dwordx4 v4, s[56:59], s78 offen offset:2048 lds
    buffer_load_dwordx4 v5, s[56:59], s78 offen offset:3072 lds
    s_add_u32 s78, s78, 1703936
    s_mov_b32 m0, 77824
    s_nop 0
    buffer_load_dwordx4 v2, s[56:59], s78 offen lds
    buffer_load_dwordx4 v3, s[56:59], s78 offen offset:1024 lds
    buffer_load_dwordx4 v4, s[56:59], s78 offen offset:2048 lds
    buffer_load_dwordx4 v5, s[56:59], s78 offen offset:3072 lds
    s_add_u32 s78, s74, 917504
    s_mov_b32 m0, 110592
    s_nop 0
    buffer_load_dwordx4 v2, s[56:59], s78 offen lds
    buffer_load_dwordx4 v3, s[56:59], s78 offen offset:1024 lds
    buffer_load_dwordx4 v4, s[56:59], s78 offen offset:2048 lds
    buffer_load_dwordx4 v5, s[56:59], s78 offen offset:3072 lds
    s_branch L_plain2
L_skip1w:
    s_nop 1
    s_and_b32 s99, s91, 3
    s_mul_i32 s99, s99, 1769472
    s_lshl_b32 s15, s5, 9
    s_add_u32 s99, s99, s15
    s_cmp_ge_u32 s5, 6
    s_cselect_b32 s80, 13, 27
    s_cselect_b32 s15, 884736, 0
    s_bitcmp1_b32 s91, 2
    s_cselect_b32 s15, s15, 0
    s_add_u32 s99, s99, s15
    v_lshrrev_b32 v22, 5, v0
    v_lshlrev_b32 v22, 12, v22
    v_and_b32 v21, 31, v0
    v_lshl_add_u32 v22, v21, 4, v22
    s_mov_b32 s96, 0
    s_mov_b32 s97, s80
L_warmA:
    buffer_load_dwordx4 v[128:131], v22, s[56:59], s99 offen
    s_add_u32 s99, s99, 8192
    buffer_load_dwordx4 v[132:135], v22, s[56:59], s99 offen
    s_add_u32 s99, s99, 8192
    buffer_load_dwordx4 v[136:139], v22, s[56:59], s99 offen
    s_add_u32 s99, s99, 8192
    buffer_load_dwordx4 v[140:143], v22, s[56:59], s99 offen
    s_add_u32 s99, s99, 8192
    buffer_load_dwordx4 v[144:147], v22, s[56:59], s99 offen
    s_add_u32 s99, s99, 8192
    buffer_load_dwordx4 v[148:151], v22, s[56:59], s99 offen
    s_add_u32 s99, s99, 8192
    buffer_load_dwordx4 v[152:155], v22, s[56:59], s99 offen
    s_add_u32 s99, s99, 8192
    buffer_load_dwordx4 v[156:159], v22, s[56:59], s99 offen
    s_add_u32 s99, s99, 8192
    s_waitcnt vmcnt(40)
    s_add_u32 s96, s96, 1
    s_cmp_le_u32 s96, 6
    s_cbranch_scc1 L_warmA
    v_add_u32 v40, 1024, v1
    v_add_u32 v41, 2048, v1
    v_add_u32 v42, 3072, v1
    s_lshl_b32 s80, s5, 12
    s_add_u32 s80, s80, 0x10000
    s_mov_b32 s84, 0
Lpoll_5:
    buffer_load_dword v36, v1, s[60:63], s80 offen sc1
    buffer_load_dword v37, v40, s[60:63], s80 offen sc1
    buffer_load_dword v38, v41, s[60:63], s80 offen sc1
    buffer_load_dword v39, v42, s[60:63], s80 offen sc1
    s_waitcnt vmcnt(0)
    v_xor_b32 v37, s4, v37
    v_xor_b32 v38, s4, v38
    v_xor_b32 v39, s4, v39
    v_xor_b32 v36, s4, v36
    v_or_b32 v36, v36, v37
    v_or_b32 v36, v36, v38
    v_or_b32 v36, v36, v39
    v_cmp_ne_u32 vcc, 0, v36
    s_cbranch_vccz Lpolled_6
    s_sleep 8
    s_add_u32 s84, s84, 1
    s_cmp_lt_u32 s84, 0x4000
    s_cbranch_scc1 Lpoll_5
Lpolled_6:
    v_mov_b32 v20, 157308
    v_mov_b32 v21, 1
    s_mov_b64 exec, 1
    ds_add_u32 v20, v21
    s_mov_b64 exec, -1
L_warmB:
    buffer_load_dwordx4 v[128:131], v22, s[56:59], s99 offen
    s_add_u32 s99, s99, 8192
    buffer_load_dwordx4 v[132:135], v22, s[56:59], s99 offen
    s_add_u32 s99, s99, 8192
    buffer_load_dwordx4 v[136:139], v22, s[56:59], s99 offen
    s_add_u32 s99, s99, 8192
    buffer_load_dwordx4 v[140:143], v22, s[56:59], s99 offen
    s_add_u32 s99, s99, 8192
    buffer_load_dwordx4 v[144:147], v22, s[56:59], s99 offen
    s_add_u32 s99, s99, 8192
    buffer_load_dwordx4 v[148:151], v22, s[56:59], s99 offen
    s_add_u32 s99, s99, 8192
    buffer_load_dwordx4 v[152:155], v22, s[56:59], s99 offen
    s_add_u32 s99, s99, 8192
    buffer_load_dwordx4 v[156:159], v22, s[56:59], s99 offen
    s_add_u32 s99, s99, 8192
    s_waitcnt vmcnt(40)
    s_add_u32 s96, s96, 1
    s_cmp_le_u32 s96, s97
    s_cbranch_scc1 L_warmB
    v_mov_b32 v20, 157316
    v_mov_b32 v21, 1
    s_mov_b64 exec, 1
    ds_add_u32 v20, v21
    s_mov_b64 exec, -1
    v_mov_b32 v116, 0
    v_mov_b32 v117, 0x3f803f80
    v_lshlrev_b32 v120, 16, v208
    v_and_b32 v121, s83, v208
    v_pk_mul_f32 v[120:121], v[120:121], v[96:97]
    v_cvt_pk_bf16_f32 v122, v120, v121
    v_dot2c_f32_bf16 v116, v122, v117
    v_lshlrev_b32 v124, 16, v209
    v_and_b32 v125, s83, v209
    v_pk_mul_f32 v[124:125], v[124:125], v[98:99]
    v_cvt_pk_bf16_f32 v126, v124, v125
    v_dot2c_f32_bf16 v116, v126, v117
    v_lshlrev_b32 v120, 16, v210
    v_and_b32 v121, s83, v210
    v_pk_mul_f32 v[120:121], v[120:121], v[100:101]
    v_cvt_pk_bf16_f32 v122, v120, v121
    v_dot2c_f32_bf16 v116, v122, v117
    v_lshlrev_b32 v124, 16, v211
    v_and_b32 v125, s83, v211
    v_pk_mul_f32 v[124:125], v[124:125], v[102:103]
    v_cvt_pk_bf16_f32 v126, v124, v125
    v_dot2c_f32_bf16 v116, v126, v117
    v_lshlrev_b32 v120, 16, v212
    v_and_b32 v121, s83, v212
    v_pk_mul_f32 v[120:121], v[120:121], v[104:105]
    v_cvt_pk_bf16_f32 v122, v120, v121
    v_dot2c_f32_bf16 v116, v122, v117
    v_lshlrev_b32 v124, 16, v213
    v_and_b32 v125, s83, v213
    v_pk_mul_f32 v[124:125], v[124:125], v[106:107]
    v_cvt_pk_bf16_f32 v126, v124, v125
    v_dot2c_f32_bf16 v116, v126, v117
    v_lshlrev_b32 v120, 16, v214
    v_and_b32 v121, s83, v214
    v_pk_mul_f32 v[120:121], v[120:121], v[108:109]
    v_cvt_pk_bf16_f32 v122, v120, v121
    v_dot2c_f32_bf16 v116, v122, v117
    v_lshlrev_b32 v124, 16, v215
    v_and_b32 v125, s83, v215
    v_pk_mul_f32 v[124:125], v[124:125], v[110:111]
    v_cvt_pk_bf16_f32 v126, v124, v125
    v_dot2c_f32_bf16 v116, v126, v117
    v_lshlrev_b32 v120, 16, v216
    v_and_b32 v121, s83, v216
    v_pk_mul_f32 v[120:121], v[120:121], v[112:113]
    v_cvt_pk_bf16_f32 v122, v120, v121
    v_dot2c_f32_bf16 v116, v122, v117
    v_lshlrev_b32 v124, 16, v217
    v_and_b32 v125, s83, v217
    v_pk_mul_f32 v[124:125], v[124:125], v[114:115]
    v_cvt_pk_bf16_f32 v126, v124, v125
    v_dot2c_f32_bf16 v116, v126, v117
    s_nop 2
    v_add_f32_dpp v116, v116, v116 row_ror:8 row_mask:0xf bank_mask:0xf
    s_nop 1
    v_add_f32_dpp v116, v116, v116 row_ror:4 row_mask:0xf bank_mask:0xf
    s_nop 1
    v_add_f32_dpp v116, v116, v116 row_ror:2 row_mask:0xf bank_mask:0xf
    s_nop 1
    v_add_f32_dpp v116, v116, v116 row_ror:1 row_mask:0xf bank_mask:0xf
    v_mov_b32 v117, v116
    s_nop 1
    v_permlane16_swap_b32 v116, v117
    v_add_f32 v116, v116, v117
    v_cvt_pk_bf16_f32 v116, v116, v116
    v_lshlrev_b32 v116, 16, v116
    v_mul_f32 v116, 0xbfb8aa3b, v116
    v_exp_f32 v116, v116
    s_nop 0
    v_add_f32 v116, 1.0, v116
    v_rcp_f32 v116, v116
    s_nop 0
    v_cvt_pk_bf16_f32 v116, v116, v116
    v_lshlrev_b32 v26, 1, v26
    v_add_u32 v26, 157280, v26
    s_mov_b32 exec_lo, 1
    s_mov_b32 exec_hi, 1
    ds_write_b16 v26, v116
    s_mov_b64 exec, -1
    v_mov_b32 v20, 157312
    s_mov_b32 s84, 0
L_cntg:
    ds_read_b32 v21, v20
    s_waitcnt lgkmcnt(0)
    v_readfirstlane_b32 s14, v21
    s_nop 0
    s_cmp_ge_u32 s14, 3
    s_cbranch_scc1 L_cntg_ok
    s_sleep 1
    s_add_u32 s84, s84, 1
    s_cmp_lt_u32 s84, 0x80000
    s_cbranch_scc1 L_cntg
L_cntg_ok:
    v_mov_b32 v20, 157280
    ds_read_b128 v[32:35], v20
    v_mov_b32 v20, 0
    s_lshl_b32 s14, s2, 4
    s_add_u32 s14, s14, 0x80000
    s_waitcnt lgkmcnt(0)
    s_mov_b64 exec, 1
    buffer_store_dwordx4 v[32:35], v20, s[60:63], s14 offen sc1
    s_mov_b64 exec, -1
    s_mul_i32 s74, s3, 1703936
    s_lshl_b32 s15, s8, 7
    s_add_u32 s74, s74, s15
    v_lshrrev_b32 v20, 3, v0
    v_mul_u32_u24 v20, 4096, v20
    v_and_b32 v21, 7, v0
    v_bfe_u32 v22, v0, 4, 1
    v_lshlrev_b32 v22, 1, v22
    v_xor_b32 v21, v21, v22
    v_xor_b32 v22, 0, v21
    v_lshl_add_u32 v2, v22, 4, v20
    v_xor_b32 v22, 4, v21
    v_lshl_add_u32 v3, v22, 4, v20
    v_add_u32 v3, 31744, v3
    v_xor_b32 v22, 0, v21
    v_lshl_add_u32 v4, v22, 4, v20
    v_add_u32 v4, 63488, v4
    v_xor_b32 v22, 4, v21
    v_lshl_add_u32 v5, v22, 4, v20
    v_add_u32 v5, 95232, v5
    s_add_u32 s78, s74, 0
    s_add_u32 m0, s72, 16384
    s_nop 0
    buffer_load_dwordx4 v2, s[56:59], s78 offen lds
    buffer_load_dwordx4 v3, s[56:59], s78 offen offset:1024 lds
    buffer_load_dwordx4 v4, s[56:59], s78 offen offset:2048 lds
    buffer_load_dwordx4 v5, s[56:59], s78 offen offset:3072 lds
    s_add_u32 s78, s78, 131072
    s_add_u32 m0, s72, 20480
    s_nop 0
    buffer_load_dwordx4 v2, s[56:59], s78 offen lds
    buffer_load_dwordx4 v3, s[56:59], s78 offen offset:1024 lds
    buffer_load_dwordx4 v4, s[56:59], s78 offen offset:2048 lds
    buffer_load_dwordx4 v5, s[56:59], s78 offen offset:3072 lds
    s_add_u32 s78, s78, 131072
    s_add_u32 m0, s72, 24576
    s_nop 0
    buffer_load_dwordx4 v2, s[56:59], s78 offen lds
    buffer_load_dwordx4 v3, s[56:59], s78 offen offset:1024 lds
    buffer_load_dwordx4 v4, s[56:59], s78 offen offset:2048 lds
    buffer_load_dwordx4 v5, s[56:59], s78 offen offset:3072 lds
    s_add_u32 s78, s78, 131072
    s_add_u32 m0, s72, 28672
    s_nop 0
    buffer_load_dwordx4 v2, s[56:59], s78 offen lds
    buffer_load_dwordx4 v3, s[56:59], s78 offen offset:1024 lds
    buffer_load_dwordx4 v4, s[56:59], s78 offen offset:2048 lds
    buffer_load_dwordx4 v5, s[56:59], s78 offen offset:3072 lds
    s_waitcnt vmcnt(16)
    v_mov_b32 v24, s4
    v_mov_b32 v25, s4
    v_mov_b32 v26, s4
    v_mov_b32 v27, s4
    v_mul_u32_u24 v28, 4096, v0
    s_lshl_b32 s85, s2, 4
    s_add_u32 s85, s85, 0x60000
    s_mov_b64 exec, 0xff
    buffer_store_dwordx4 v[24:27], v28, s[60:63], s85 offen sc1
    s_mov_b64 exec, -1
    s_add_u32 s78, s74, 1048576
    buffer_load_dwordx4 a[80:83], v2, s[56:59], s78 offen
    buffer_load_dwordx4 a[84:87], v3, s[56:59], s78 offen offset:1024
    buffer_load_dwordx4 a[88:91], v4, s[56:59], s78 offen offset:2048
    buffer_load_dwordx4 a[92:95], v5, s[56:59], s78 offen offset:3072
    s_add_u32 s78, s78, 131072
    buffer_load_dwordx4 a[96:99], v2, s[56:59], s78 offen
    buffer_load_dwordx4 a[100:103], v3, s[56:59], s78 offen offset:1024
    buffer_load_dwordx4 a[104:107], v4, s[56:59], s78 offen offset:2048
    buffer_load_dwordx4 a[108:111], v5, s[56:59], s78 offen offset:3072
    s_add_u32 s78, s78, 131072
    buffer_load_dwordx4 a[40:43], v2, s[56:59], s78 offen
    buffer_load_dwordx4 a[44:47], v3, s[56:59], s78 offen offset:1024
    buffer_load_dwordx4 a[48:51], v4, s[56:59], s78 offen offset:2048
    buffer_load_dwordx4 a[52:55], v5, s[56:59], s78 offen offset:3072
    s_add_u32 s78, s78, 131072
    buffer_load_dwordx4 a[56:59], v2, s[56:59], s78 offen
    buffer_load_dwordx4 a[60:63], v3, s[56:59], s78 offen offset:1024
    buffer_load_dwordx4 a[64:67], v4, s[56:59], s78 offen offset:2048
    buffer_load_dwordx4 a[68:71], v5, s[56:59], s78 offen offset:3072
    s_add_u32 s78, s78, 131072
    buffer_load_dwordx4 a[224:227], v2, s[56:59], s78 offen
    buffer_load_dwordx4 a[228:231], v3, s[56:59], s78 offen offset:1024
    buffer_load_dwordx4 a[232:235], v4, s[56:59], s78 offen offset:2048
    buffer_load_dwordx4 a[236:239], v5, s[56:59], s78 offen offset:3072
    s_add_u32 s78, s78, 131072
    buffer_load_dwordx4 a[240:243], v2, s[56:59], s78 offen
    buffer_load_dwordx4 a[244:247], v3, s[56:59], s78 offen offset:1024
    buffer_load_dwordx4 a[248:251], v4, s[56:59], s78 offen offset:2048
    buffer_load_dwordx4 a[252:255], v5, s[56:59], s78 offen offset:3072
    s_add_u32 s78, s78, 131072
    buffer_load_dwordx4 a[112:115], v2, s[56:59], s78 offen
    buffer_load_dwordx4 a[116:119], v3, s[56:59], s78 offen offset:1024
    buffer_load_dwordx4 a[120:123], v4, s[56:59], s78 offen offset:2048
    buffer_load_dwordx4 a[124:127], v5, s[56:59], s78 offen offset:3072
    s_add_u32 s78, s74, -4587520
    s_mov_b32 m0, 0
    s_nop 0
    buffer_load_dwordx4 v2, s[56:59], s78 offen lds
    buffer_load_dwordx4 v3, s[56:59], s78 offen offset:1024 lds
    buffer_load_dwordx4 v4, s[56:59], s78 offen offset:2048 lds
    buffer_load_dwordx4 v5, s[56:59], s78 offen offset:3072 lds
    s_add_u32 s78, s78, 1703936
    s_mov_b32 m0, 32768
    s_nop 0
    buffer_load_dwordx4 v2, s[56:59], s78 offen lds
    buffer_load_dwordx4 v3, s[56:59], s78 offen offset:1024 lds
    buffer_load_dwordx4 v4, s[56:59], s78 offen offset:2048 lds
    buffer_load_dwordx4 v5, s[56:59], s78 offen offset:3072 lds
    s_add_u32 s78, s78, 1703936
    s_mov_b32 m0, 65536
    s_nop 0
    buffer_load_dwordx4 v2, s[56:59], s78 offen lds
    buffer_load_dwordx4 v3, s[56:59], s78 offen offset:1024 lds
    buffer_load_dwordx4 v4, s[56:59], s78 offen offset:2048 lds
    buffer_load_dwordx4 v5, s[56:59], s78 offen offset:3072 lds
    s_add_u32 s78, s74, 524288
    s_mov_b32 m0, 98304
    s_nop 0
    buffer_load_dwordx4 v2, s[56:59], s78 offen lds
    buffer_load_dwordx4 v3, s[56:59], s78 offen offset:1024 lds
    buffer_load_dwordx4 v4, s[56:59], s78 offen offset:2048 lds
    buffer_load_dwordx4 v5, s[56:59], s78 offen offset:3072 lds
    s_add_u32 s78, s74, -4456448
    s_mov_b32 m0, 4096
    s_nop 0
    buffer_load_dwordx4 v2, s[56:59], s78 offen lds
    buffer_load_dwordx4 v3, s[56:59], s78 offen offset:1024 lds
    buffer_load_dwordx4 v4, s[56:59], s78 offen offset:2048 lds
    buffer_load_dwordx4 v5, s[56:59], s78 offen offset:3072 lds
    s_add_u32 s78, s78, 1703936
    s_mov_b32 m0, 36864
    s_nop 0
    buffer_load_dwordx4 v2, s[56:59], s78 offen lds
    buffer_load_dwordx4 v3, s[56:59], s78 offen offset:1024 lds
    buffer_load_dwordx4 v4, s[56:59], s78 offen offset:2048 lds
    buffer_load_dwordx4 v5, s[56:59], s78 offen offset:3072 lds
    s_add_u32 s78, s78, 1703936
    s_mov_b32 m0, 69632
    s_nop 0
    buffer_load_dwordx4 v2, s[56:59], s78 offen lds
    buffer_load_dwordx4 v3, s[56:59], s78 offen offset:1024 lds
    buffer_load_dwordx4 v4, s[56:59], s78 offen offset:2048 lds
    buffer_load_dwordx4 v5, s[56:59], s78 offen offset:3072 lds
    s_add_u32 s78, s74, 655360
    s_mov_b32 m0, 102400
    s_nop 0
    buffer_load_dwordx4 v2, s[56:59], s78 offen lds
    buffer_load_dwordx4 v3, s[56:59], s78 offen offset:1024 lds
    buffer_load_dwordx4 v4, s[56:59], s78 offen offset:2048 lds
    buffer_load_dwordx4 v5, s[56:59], s78 offen offset:3072 lds
    s_add_u32 s78, s74, -4325376
    s_mov_b32 m0, 8192
    s_nop 0
    buffer_load_dwordx4 v2, s[56:59], s78 offen lds
    buffer_load_dwordx4 v3, s[56:59], s78 offen offset:1024 lds
    buffer_load_dwordx4 v4, s[56:59], s78 offen offset:2048 lds
    buffer_load_dwordx4 v5, s[56:59], s78 offen offset:3072 lds
    s_add_u32 s78, s78, 1703936
    s_mov_b32 m0, 40960
    s_nop 0
    buffer_load_dwordx4 v2, s[56:59], s78 offen lds
    buffer_load_dwordx4 v3, s[56:59], s78 offen offset:1024 lds
    buffer_load_dwordx4 v4, s[56:59], s78 offen offset:2048 lds
    buffer_load_dwordx4 v5, s[56:59], s78 offen offset:3072 lds
    s_add_u32 s78, s78, 1703936
    s_mov_b32 m0, 73728
    s_nop 0
    buffer_load_dwordx4 v2, s[56:59], s78 offen lds
    buffer_load_dwordx4 v3, s[56:59], s78 offen offset:1024 lds
    buffer_load_dwordx4 v4, s[56:59], s78 offen offset:2048 lds
    buffer_load_dwordx4 v5, s[56:59], s78 offen offset:3072 lds
    s_add_u32 s78, s74, 786432
    s_mov_b32 m0, 106496
    s_nop 0
    buffer_load_dwordx4 v2, s[56:59], s78 offen lds
    buffer_load_dwordx4 v3, s[56:59], s78 offen offset:1024 lds
    buffer_load_dwordx4 v4, s[56:59], s78 offen offset:2048 lds
    buffer_load_dwordx4 v5, s[56:59], s78 offen offset:3072 lds
    s_add_u32 s78, s74, -4194304
    s_mov_b32 m0, 12288
    s_nop 0
    buffer_load_dwordx4 v2, s[56:59], s78 offen lds
    buffer_load_dwordx4 v3, s[56:59], s78 offen offset:1024 lds
    buffer_load_dwordx4 v4, s[56:59], s78 offen offset:2048 lds
    buffer_load_dwordx4 v5, s[56:59], s78 offen offset:3072 lds
    s_add_u32 s78, s78, 1703936
    s_mov_b32 m0, 45056
    s_nop 0
    buffer_load_dwordx4 v2, s[56:59], s78 offen lds
    buffer_load_dwordx4 v3, s[56:59], s78 offen offset:1024 lds
    buffer_load_dwordx4 v4, s[56:59], s78 offen offset:2048 lds
    buffer_load_dwordx4 v5, s[56:59], s78 offen offset:3072 lds
    s_add_u32 s78, s78, 1703936
    s_mov_b32 m0, 77824
    s_nop 0
    buffer_load_dwordx4 v2, s[56:59], s78 offen lds
    buffer_load_dwordx4 v3, s[56:59], s78 offen offset:1024 lds
    buffer_load_dwordx4 v4, s[56:59], s78 offen offset:2048 lds
    buffer_load_dwordx4 v5, s[56:59], s78 offen offset:3072 lds
    s_add_u32 s78, s74, 917504
    s_mov_b32 m0, 110592
    s_nop 0
    buffer_load_dwordx4 v2, s[56:59], s78 offen lds
    buffer_load_dwordx4 v3, s[56:59], s78 offen offset:1024 lds
    buffer_load_dwordx4 v4, s[56:59], s78 offen offset:2048 lds
    buffer_load_dwordx4 v5, s[56:59], s78 offen offset:3072 lds
    s_branch L_plain2
L_skip1:
    s_nop 11
    v_mov_b32 v116, 0
    v_mov_b32 v117, 0x3f803f80
    v_lshlrev_b32 v120, 16, v208
    v_and_b32 v121, s83, v208
    v_pk_mul_f32 v[120:121], v[120:121], v[96:97]
    v_cvt_pk_bf16_f32 v122, v120, v121
    v_dot2c_f32_bf16 v116, v122, v117
    v_lshlrev_b32 v124, 16, v209
    v_and_b32 v125, s83, v209
    v_pk_mul_f32 v[124:125], v[124:125], v[98:99]
    v_cvt_pk_bf16_f32 v126, v124, v125
    v_dot2c_f32_bf16 v116, v126, v117
    v_lshlrev_b32 v120, 16, v210
    v_and_b32 v121, s83, v210
    v_pk_mul_f32 v[120:121], v[120:121], v[100:101]
    v_cvt_pk_bf16_f32 v122, v120, v121
    v_dot2c_f32_bf16 v116, v122, v117
    v_lshlrev_b32 v124, 16, v211
    v_and_b32 v125, s83, v211
    v_pk_mul_f32 v[124:125], v[124:125], v[102:103]
    v_cvt_pk_bf16_f32 v126, v124, v125
    v_dot2c_f32_bf16 v116, v126, v117
    v_lshlrev_b32 v120, 16, v212
    v_and_b32 v121, s83, v212
    v_pk_mul_f32 v[120:121], v[120:121], v[104:105]
    v_cvt_pk_bf16_f32 v122, v120, v121
    v_dot2c_f32_bf16 v116, v122, v117
    v_lshlrev_b32 v124, 16, v213
    v_and_b32 v125, s83, v213
    v_pk_mul_f32 v[124:125], v[124:125], v[106:107]
    v_cvt_pk_bf16_f32 v126, v124, v125
    v_dot2c_f32_bf16 v116, v126, v117
    v_lshlrev_b32 v120, 16, v214
    v_and_b32 v121, s83, v214
    v_pk_mul_f32 v[120:121], v[120:121], v[108:109]
    v_cvt_pk_bf16_f32 v122, v120, v121
    v_dot2c_f32_bf16 v116, v122, v117
    v_lshlrev_b32 v124, 16, v215
    v_and_b32 v125, s83, v215
    v_pk_mul_f32 v[124:125], v[124:125], v[110:111]
    v_cvt_pk_bf16_f32 v126, v124, v125
    v_dot2c_f32_bf16 v116, v126, v117
    v_lshlrev_b32 v120, 16, v216
    v_and_b32 v121, s83, v216
    v_pk_mul_f32 v[120:121], v[120:121], v[112:113]
    v_cvt_pk_bf16_f32 v122, v120, v121
    v_dot2c_f32_bf16 v116, v122, v117
    v_lshlrev_b32 v124, 16, v217
    v_and_b32 v125, s83, v217
    v_pk_mul_f32 v[124:125], v[124:125], v[114:115]
    v_cvt_pk_bf16_f32 v126, v124, v125
    v_dot2c_f32_bf16 v116, v126, v117
    s_nop 2
    v_add_f32_dpp v116, v116, v116 row_ror:8 row_mask:0xf bank_mask:0xf
    s_nop 1
    v_add_f32_dpp v116, v116, v116 row_ror:4 row_mask:0xf bank_mask:0xf
    s_nop 1
    v_add_f32_dpp v116, v116, v116 row_ror:2 row_mask:0xf bank_mask:0xf
    s_nop 1
    v_add_f32_dpp v116, v116, v116 row_ror:1 row_mask:0xf bank_mask:0xf
    v_mov_b32 v117, v116
    s_nop 1
    v_permlane16_swap_b32 v116, v117
    v_add_f32 v116, v116, v117
    v_cvt_pk_bf16_f32 v116, v116, v116
    v_lshlrev_b32 v116, 16, v116
    v_mul_f32 v116, 0xbfb8aa3b, v116
    v_exp_f32 v116, v116
    s_nop 0
    v_add_f32 v116, 1.0, v116
    v_rcp_f32 v116, v116
    s_nop 0
    v_cvt_pk_bf16_f32 v116, v116, v116
    v_lshlrev_b32 v26, 1, v26
    v_add_u32 v26, 157280, v26
    s_mov_b32 exec_lo, 1
    s_mov_b32 exec_hi, 1
    ds_write_b16 v26, v116
    s_mov_b64 exec, -1
    s_waitcnt lgkmcnt(0)
    v_mov_b32 v20, 157312
    v_mov_b32 v21, 1
    s_mov_b64 exec, 1
    ds_add_u32 v20, v21
    s_mov_b64 exec, -1
    v_mov_b32 v20, 157308
    s_mov_b32 s84, 0
L_cnt1b:
    ds_read_b32 v21, v20
    s_waitcnt lgkmcnt(0)
    v_readfirstlane_b32 s14, v21
    s_nop 0
    s_cmp_ge_u32 s14, 1
    s_cbranch_scc1 L_cnt1b_ok
    s_sleep 1
    s_add_u32 s84, s84, 1
    s_cmp_lt_u32 s84, 0x80000
    s_cbranch_scc1 L_cnt1b
L_cnt1b_ok:
    s_lshl_b32 s14, s9, 12
    s_add_u32 s14, s14, 0x400000
    buffer_load_dwordx4 v[48:51], v1, s[60:63], s14 offen sc1
    buffer_load_dwordx4 v[52:55], v1, s[60:63], s14 offen offset:1024 sc1
    buffer_load_dwordx4 v[56:59], v1, s[60:63], s14 offen offset:2048 sc1
    buffer_load_dwordx4 v[60:63], v1, s[60:63], s14 offen offset:3072 sc1
    s_mul_i32 s74, s3, 1703936
    s_lshl_b32 s15, s8, 7
    s_add_u32 s74, s74, s15
    v_lshrrev_b32 v20, 3, v0
    v_mul_u32_u24 v20, 4096, v20
    v_and_b32 v21, 7, v0
    v_bfe_u32 v22, v0, 4, 1
    v_lshlrev_b32 v22, 1, v22
    v_xor_b32 v21, v21, v22
    v_xor_b32 v22, 0, v21
    v_lshl_add_u32 v2, v22, 4, v20
    v_xor_b32 v22, 4, v21
    v_lshl_add_u32 v3, v22, 4, v20
    v_add_u32 v3, 31744, v3
    v_xor_b32 v22, 0, v21
    v_lshl_add_u32 v4, v22, 4, v20
    v_add_u32 v4, 63488, v4
    v_xor_b32 v22, 4, v21
    v_lshl_add_u32 v5, v22, 4, v20
    v_add_u32 v5, 95232, v5
    s_mov_b32 s58, 0
    s_waitcnt vmcnt(0)
    ds_write_b128 v18, v[48:51] offset:4640
    ds_write_b128 v18, v[52:55] offset:5664
    ds_write_b128 v18, v[56:59] offset:6688
    ds_write_b128 v18, v[60:63] offset:7712
    ds_read2_b64 v[64:67], v17 offset0:120 offset1:121
    ds_read2_b64 v[68:71], v32 offset0:120 offset1:121
    ds_read2_b64 v[72:75], v33 offset0:120 offset1:121
    ds_read2_b64 v[76:79], v34 offset0:120 offset1:121
    ds_read_b64_tr_b16 a[164:165], v16 offset:256
    ds_read_b64_tr_b16 a[166:167], v16 offset:288
    ds_read_b64_tr_b16 a[172:173], v16 offset:768
    ds_read_b64_tr_b16 a[174:175], v16 offset:800
    ds_read_b64_tr_b16 a[180:181], v16 offset:1280
    ds_read_b64_tr_b16 a[182:183], v16 offset:1312
    ds_read_b64_tr_b16 a[188:189], v16 offset:1792
    ds_read_b64_tr_b16 a[190:191], v16 offset:1824
    ds_read_b64_tr_b16 a[196:197], v16 offset:2304
    ds_read_b64_tr_b16 a[198:199], v16 offset:2336
    ds_read_b64_tr_b16 a[204:205], v16 offset:2816
    ds_read_b64_tr_b16 a[206:207], v16 offset:2848
    ds_read_b64_tr_b16 a[212:213], v16 offset:3328
    ds_read_b64_tr_b16 a[214:215], v16 offset:3360
    ds_read_b64_tr_b16 a[220:221], v16 offset:3840
    ds_read_b64_tr_b16 a[222:223], v16 offset:3872
    ds_read_b64_tr_b16 a[160:161], v16 offset:0
    ds_read_b64_tr_b16 a[162:163], v16 offset:32
    ds_read_b64_tr_b16 a[168:169], v16 offset:512
    ds_read_b64_tr_b16 a[170:171], v16 offset:544
    ds_read_b64_tr_b16 a[176:177], v16 offset:1024
    ds_read_b64_tr_b16 a[178:179], v16 offset:1056
    ds_read_b64_tr_b16 a[184:185], v16 offset:1536
    ds_read_b64_tr_b16 a[186:187], v16 offset:1568
    ds_read_b64_tr_b16 a[192:193], v16 offset:2048
    ds_read_b64_tr_b16 a[194:195], v16 offset:2080
    ds_read_b64_tr_b16 a[200:201], v16 offset:2560
    ds_read_b64_tr_b16 a[202:203], v16 offset:2592
    ds_read_b64_tr_b16 a[208:209], v16 offset:3072
    ds_read_b64_tr_b16 a[210:211], v16 offset:3104
    ds_read_b64_tr_b16 a[216:217], v16 offset:3584
    ds_read_b64_tr_b16 a[218:219], v16 offset:3616
    s_waitcnt lgkmcnt(15)
    v_mfma_f32_16x16x32_bf16 v[128:131], a[164:167], v[64:67], 0
    ds_read2_b64 v[80:83], v17 offset0:112 offset1:113
    ds_read2_b64 v[84:87], v32 offset0:112 offset1:113
    v_mfma_f32_16x16x32_bf16 v[132:135], a[164:167], v[68:71], 0
    ds_read2_b64 v[88:91], v33 offset0:112 offset1:113
    ds_read2_b64 v[92:95], v34 offset0:112 offset1:113
    v_mfma_f32_16x16x32_bf16 v[136:139], a[164:167], v[72:75], 0
    v_mfma_f32_16x16x32_bf16 v[140:143], a[164:167], v[76:79], 0
    v_mfma_f32_16x16x32_bf16 v[144:147], a[172:175], v[64:67], 0
    v_mfma_f32_16x16x32_bf16 v[148:151], a[172:175], v[68:71], 0
    v_mfma_f32_16x16x32_bf16 v[152:155], a[172:175], v[72:75], 0
    v_mfma_f32_16x16x32_bf16 v[156:159], a[172:175], v[76:79], 0
    v_mfma_f32_16x16x32_bf16 v[160:163], a[180:183], v[64:67], 0
    v_mfma_f32_16x16x32_bf16 v[164:167], a[180:183], v[68:71], 0
    v_mfma_f32_16x16x32_bf16 v[168:171], a[180:183], v[72:75], 0
    v_mfma_f32_16x16x32_bf16 v[172:175], a[180:183], v[76:79], 0
    v_mfma_f32_16x16x32_bf16 v[176:179], a[188:191], v[64:67], 0
    v_mfma_f32_16x16x32_bf16 v[180:183], a[188:191], v[68:71], 0
    v_mfma_f32_16x16x32_bf16 v[184:187], a[188:191], v[72:75], 0
    v_mfma_f32_16x16x32_bf16 v[188:191], a[188:191], v[76:79], 0
    v_mfma_f32_16x16x32_bf16 v[192:195], a[196:199], v[64:67], 0
    v_mfma_f32_16x16x32_bf16 v[196:199], a[196:199], v[68:71], 0
    v_mfma_f32_16x16x32_bf16 v[200:203], a[196:199], v[72:75], 0
    v_mfma_f32_16x16x32_bf16 v[204:207], a[196:199], v[76:79], 0
    v_mfma_f32_16x16x32_bf16 v[208:211], a[204:207], v[64:67], 0
    v_mfma_f32_16x16x32_bf16 v[212:215], a[204:207], v[68:71], 0
    v_mfma_f32_16x16x32_bf16 v[216:219], a[204:207], v[72:75], 0
    v_mfma_f32_16x16x32_bf16 v[220:223], a[204:207], v[76:79], 0
    v_mfma_f32_16x16x32_bf16 v[224:227], a[212:215], v[64:67], 0
    v_mfma_f32_16x16x32_bf16 v[228:231], a[212:215], v[68:71], 0
    v_mfma_f32_16x16x32_bf16 v[232:235], a[212:215], v[72:75], 0
    v_mfma_f32_16x16x32_bf16 v[236:239], a[212:215], v[76:79], 0
    v_mfma_f32_16x16x32_bf16 v[240:243], a[220:223], v[64:67], 0
    v_mfma_f32_16x16x32_bf16 v[244:247], a[220:223], v[68:71], 0
    v_mfma_f32_16x16x32_bf16 v[248:251], a[220:223], v[72:75], 0
    v_mfma_f32_16x16x32_bf16 v[252:255], a[220:223], v[76:79], 0
    s_waitcnt lgkmcnt(0)
    v_mfma_f32_16x16x32_bf16 v[128:131], a[160:163], v[80:83], v[128:131]
    ds_read2_b64 v[64:67], v17 offset0:104 offset1:105
    ds_read2_b64 v[68:71], v32 offset0:104 offset1:105
    v_mfma_f32_16x16x32_bf16 v[132:135], a[160:163], v[84:87], v[132:135]
    ds_read2_b64 v[72:75], v33 offset0:104 offset1:105
    ds_read2_b64 v[76:79], v34 offset0:104 offset1:105
    v_mfma_f32_16x16x32_bf16 v[136:139], a[160:163], v[88:91], v[136:139]
    v_mfma_f32_16x16x32_bf16 v[140:143], a[160:163], v[92:95], v[140:143]
    v_mfma_f32_16x16x32_bf16 v[144:147], a[168:171], v[80:83], v[144:147]
    v_mfma_f32_16x16x32_bf16 v[148:151], a[168:171], v[84:87], v[148:151]
    v_mfma_f32_16x16x32_bf16 v[152:155], a[168:171], v[88:91], v[152:155]
    v_mfma_f32_16x16x32_bf16 v[156:159], a[168:171], v[92:95], v[156:159]
    v_mfma_f32_16x16x32_bf16 v[160:163], a[176:179], v[80:83], v[160:163]
    v_mfma_f32_16x16x32_bf16 v[164:167], a[176:179], v[84:87], v[164:167]
    v_mfma_f32_16x16x32_bf16 v[168:171], a[176:179], v[88:91], v[168:171]
    v_mfma_f32_16x16x32_bf16 v[172:175], a[176:179], v[92:95], v[172:175]
    v_mfma_f32_16x16x32_bf16 v[176:179], a[184:187], v[80:83], v[176:179]
    v_mfma_f32_16x16x32_bf16 v[180:183], a[184:187], v[84:87], v[180:183]
    v_mfma_f32_16x16x32_bf16 v[184:187], a[184:187], v[88:91], v[184:187]
    v_mfma_f32_16x16x32_bf16 v[188:191], a[184:187], v[92:95], v[188:191]
    v_mfma_f32_16x16x32_bf16 v[192:195], a[192:195], v[80:83], v[192:195]
    v_mfma_f32_16x16x32_bf16 v[196:199], a[192:195], v[84:87], v[196:199]
    v_mfma_f32_16x16x32_bf16 v[200:203], a[192:195], v[88:91], v[200:203]
    v_mfma_f32_16x16x32_bf16 v[204:207], a[192:195], v[92:95], v[204:207]
    v_mfma_f32_16x16x32_bf16 v[208:211], a[200:203], v[80:83], v[208:211]
    v_mfma_f32_16x16x32_bf16 v[212:215], a[200:203], v[84:87], v[212:215]
    v_mfma_f32_16x16x32_bf16 v[216:219], a[200:203], v[88:91], v[216:219]
    v_mfma_f32_16x16x32_bf16 v[220:223], a[200:203], v[92:95], v[220:223]
    v_mfma_f32_16x16x32_bf16 v[224:227], a[208:211], v[80:83], v[224:227]
    v_mfma_f32_16x16x32_bf16 v[228:231], a[208:211], v[84:87], v[228:231]
    v_mfma_f32_16x16x32_bf16 v[232:235], a[208:211], v[88:91], v[232:235]
    v_mfma_f32_16x16x32_bf16 v[236:239], a[208:211], v[92:95], v[236:239]
    v_mfma_f32_16x16x32_bf16 v[240:243], a[216:219], v[80:83], v[240:243]
    v_mfma_f32_16x16x32_bf16 v[244:247], a[216:219], v[84:87], v[244:247]
    v_mfma_f32_16x16x32_bf16 v[248:251], a[216:219], v[88:91], v[248:251]
    v_mfma_f32_16x16x32_bf16 v[252:255], a[216:219], v[92:95], v[252:255]
    s_waitcnt lgkmcnt(0)
    v_mfma_f32_16x16x32_bf16 v[144:147], a[164:167], v[64:67], v[144:147]
    ds_read2_b64 v[80:83], v17 offset0:96 offset1:97
    ds_read2_b64 v[84:87], v32 offset0:96 offset1:97
    v_mfma_f32_16x16x32_bf16 v[148:151], a[164:167], v[68:71], v[148:151]
    ds_read2_b64 v[88:91], v33 offset0:96 offset1:97
    ds_read2_b64 v[92:95], v34 offset0:96 offset1:97
    v_mfma_f32_16x16x32_bf16 v[152:155], a[164:167], v[72:75], v[152:155]
    v_mfma_f32_16x16x32_bf16 v[156:159], a[164:167], v[76:79], v[156:159]
    v_mfma_f32_16x16x32_bf16 v[160:163], a[172:175], v[64:67], v[160:163]
    v_mfma_f32_16x16x32_bf16 v[164:167], a[172:175], v[68:71], v[164:167]
    v_mfma_f32_16x16x32_bf16 v[168:171], a[172:175], v[72:75], v[168:171]
    v_mfma_f32_16x16x32_bf16 v[172:175], a[172:175], v[76:79], v[172:175]
    v_mfma_f32_16x16x32_bf16 v[176:179], a[180:183], v[64:67], v[176:179]
    v_mfma_f32_16x16x32_bf16 v[180:183], a[180:183], v[68:71], v[180:183]
    v_mfma_f32_16x16x32_bf16 v[184:187], a[180:183], v[72:75], v[184:187]
    v_mfma_f32_16x16x32_bf16 v[188:191], a[180:183], v[76:79], v[188:191]
    v_mfma_f32_16x16x32_bf16 v[192:195], a[188:191], v[64:67], v[192:195]
    v_mfma_f32_16x16x32_bf16 v[196:199], a[188:191], v[68:71], v[196:199]
    v_mfma_f32_16x16x32_bf16 v[200:203], a[188:191], v[72:75], v[200:203]
    v_mfma_f32_16x16x32_bf16 v[204:207], a[188:191], v[76:79], v[204:207]
    v_mfma_f32_16x16x32_bf16 v[208:211], a[196:199], v[64:67], v[208:211]
    v_mfma_f32_16x16x32_bf16 v[212:215], a[196:199], v[68:71], v[212:215]
    v_mfma_f32_16x16x32_bf16 v[216:219], a[196:199], v[72:75], v[216:219]
    v_mfma_f32_16x16x32_bf16 v[220:223], a[196:199], v[76:79], v[220:223]
    v_mfma_f32_16x16x32_bf16 v[224:227], a[204:207], v[64:67], v[224:227]
    v_mfma_f32_16x16x32_bf16 v[228:231], a[204:207], v[68:71], v[228:231]
    v_mfma_f32_16x16x32_bf16 v[232:235], a[204:207], v[72:75], v[232:235]
    v_mfma_f32_16x16x32_bf16 v[236:239], a[204:207], v[76:79], v[236:239]
    v_mfma_f32_16x16x32_bf16 v[240:243], a[212:215], v[64:67], v[240:243]
    v_mfma_f32_16x16x32_bf16 v[244:247], a[212:215], v[68:71], v[244:247]
    v_mfma_f32_16x16x32_bf16 v[248:251], a[212:215], v[72:75], v[248:251]
    v_mfma_f32_16x16x32_bf16 v[252:255], a[212:215], v[76:79], v[252:255]
    s_waitcnt lgkmcnt(0)
    v_mfma_f32_16x16x32_bf16 v[144:147], a[160:163], v[80:83], v[144:147]
    ds_read2_b64 v[64:67], v17 offset0:88 offset1:89
    ds_read2_b64 v[68:71], v32 offset0:88 offset1:89
    v_mfma_f32_16x16x32_bf16 v[148:151], a[160:163], v[84:87], v[148:151]
    ds_read2_b64 v[72:75], v33 offset0:88 offset1:89
    ds_read2_b64 v[76:79], v34 offset0:88 offset1:89
    v_mfma_f32_16x16x32_bf16 v[152:155], a[160:163], v[88:91], v[152:155]
    v_mfma_f32_16x16x32_bf16 v[156:159], a[160:163], v[92:95], v[156:159]
    v_mfma_f32_16x16x32_bf16 v[160:163], a[168:171], v[80:83], v[160:163]
    v_mfma_f32_16x16x32_bf16 v[164:167], a[168:171], v[84:87], v[164:167]
    v_mfma_f32_16x16x32_bf16 v[168:171], a[168:171], v[88:91], v[168:171]
    v_mfma_f32_16x16x32_bf16 v[172:175], a[168:171], v[92:95], v[172:175]
    v_mfma_f32_16x16x32_bf16 v[176:179], a[176:179], v[80:83], v[176:179]
    v_mfma_f32_16x16x32_bf16 v[180:183], a[176:179], v[84:87], v[180:183]
    v_mfma_f32_16x16x32_bf16 v[184:187], a[176:179], v[88:91], v[184:187]
    v_mfma_f32_16x16x32_bf16 v[188:191], a[176:179], v[92:95], v[188:191]
    v_mfma_f32_16x16x32_bf16 v[192:195], a[184:187], v[80:83], v[192:195]
    v_mfma_f32_16x16x32_bf16 v[196:199], a[184:187], v[84:87], v[196:199]
    v_mfma_f32_16x16x32_bf16 v[200:203], a[184:187], v[88:91], v[200:203]
    v_mfma_f32_16x16x32_bf16 v[204:207], a[184:187], v[92:95], v[204:207]
    v_mfma_f32_16x16x32_bf16 v[208:211], a[192:195], v[80:83], v[208:211]
    v_mfma_f32_16x16x32_bf16 v[212:215], a[192:195], v[84:87], v[212:215]
    v_mfma_f32_16x16x32_bf16 v[216:219], a[192:195], v[88:91], v[216:219]
    v_mfma_f32_16x16x32_bf16 v[220:223], a[192:195], v[92:95], v[220:223]
    v_mfma_f32_16x16x32_bf16 v[224:227], a[200:203], v[80:83], v[224:227]
    v_mfma_f32_16x16x32_bf16 v[228:231], a[200:203], v[84:87], v[228:231]
    v_mfma_f32_16x16x32_bf16 v[232:235], a[200:203], v[88:91], v[232:235]
    v_mfma_f32_16x16x32_bf16 v[236:239], a[200:203], v[92:95], v[236:239]
    v_mfma_f32_16x16x32_bf16 v[240:243], a[208:211], v[80:83], v[240:243]
    v_mfma_f32_16x16x32_bf16 v[244:247], a[208:211], v[84:87], v[244:247]
    v_mfma_f32_16x16x32_bf16 v[248:251], a[208:211], v[88:91], v[248:251]
    v_mfma_f32_16x16x32_bf16 v[252:255], a[208:211], v[92:95], v[252:255]
    s_waitcnt lgkmcnt(0)
    v_mfma_f32_16x16x32_bf16 v[160:163], a[164:167], v[64:67], v[160:163]
    ds_read2_b64 v[80:83], v17 offset0:80 offset1:81
    ds_read2_b64 v[84:87], v32 offset0:80 offset1:81
    v_mfma_f32_16x16x32_bf16 v[164:167], a[164:167], v[68:71], v[164:167]
    ds_read2_b64 v[88:91], v33 offset0:80 offset1:81
    ds_read2_b64 v[92:95], v34 offset0:80 offset1:81
    v_mfma_f32_16x16x32_bf16 v[168:171], a[164:167], v[72:75], v[168:171]
    v_mfma_f32_16x16x32_bf16 v[172:175], a[164:167], v[76:79], v[172:175]
    v_mfma_f32_16x16x32_bf16 v[176:179], a[172:175], v[64:67], v[176:179]
    v_mfma_f32_16x16x32_bf16 v[180:183], a[172:175], v[68:71], v[180:183]
    v_mfma_f32_16x16x32_bf16 v[184:187], a[172:175], v[72:75], v[184:187]
    v_mfma_f32_16x16x32_bf16 v[188:191], a[172:175], v[76:79], v[188:191]
    v_mfma_f32_16x16x32_bf16 v[192:195], a[180:183], v[64:67], v[192:195]
    v_mfma_f32_16x16x32_bf16 v[196:199], a[180:183], v[68:71], v[196:199]
    v_mfma_f32_16x16x32_bf16 v[200:203], a[180:183], v[72:75], v[200:203]
    v_mfma_f32_16x16x32_bf16 v[204:207], a[180:183], v[76:79], v[204:207]
    v_mfma_f32_16x16x32_bf16 v[208:211], a[188:191], v[64:67], v[208:211]
    v_mfma_f32_16x16x32_bf16 v[212:215], a[188:191], v[68:71], v[212:215]
    v_mfma_f32_16x16x32_bf16 v[216:219], a[188:191], v[72:75], v[216:219]
    v_mfma_f32_16x16x32_bf16 v[220:223], a[188:191], v[76:79], v[220:223]
    v_mfma_f32_16x16x32_bf16 v[224:227], a[196:199], v[64:67], v[224:227]
    v_mfma_f32_16x16x32_bf16 v[228:231], a[196:199], v[68:71], v[228:231]
    v_mfma_f32_16x16x32_bf16 v[232:235], a[196:199], v[72:75], v[232:235]
    v_mfma_f32_16x16x32_bf16 v[236:239], a[196:199], v[76:79], v[236:239]
    v_mfma_f32_16x16x32_bf16 v[240:243], a[204:207], v[64:67], v[240:243]
    v_mfma_f32_16x16x32_bf16 v[244:247], a[204:207], v[68:71], v[244:247]
    v_mfma_f32_16x16x32_bf16 v[248:251], a[204:207], v[72:75], v[248:251]
    v_mfma_f32_16x16x32_bf16 v[252:255], a[204:207], v[76:79], v[252:255]
L_gap2:
    s_nop 11
    s_cmp_eq_u32 s10, 0
    s_cbranch_scc1 L_idle2
    v_add_u32 v32, 1152, v17
    v_add_u32 v33, 2304, v17
    v_add_u32 v34, 3456, v17
    v_add_u32 v16, 48, v0
    v_and_b32 v16, 63, v16
    v_add_u32 v19, 47, v0
    v_cmp_gt_u32 vcc, 16, v0
    s_nop 1
    v_cndmask_b32 v16, v16, v19, vcc
    v_cmp_eq_u32 vcc, 0, v0
    s_nop 1
    v_cndmask_b32 v16, v16, 63, vcc
    v_lshlrev_b32 v16, 2, v16
    s_mov_b32 s86, 0
    s_mov_b32 s87, 0x80000000
    v_and_b32 v19, 15, v0
    v_lshlrev_b32 v19, 5, v19
    v_lshrrev_b32 v20, 4, v0
    v_lshl_add_u32 v19, v20, 3, v19
    v_add_u32 v19, s73, v19
    s_lshl_b32 s80, s9, 12
    s_add_u32 s80, s80, 0xa00000
    ds_read2_b64 v[80:83], v17 offset0:80 offset1:81
    ds_read2_b64 v[84:87], v32 offset0:80 offset1:81
    ds_read2_b64 v[88:91], v33 offset0:80 offset1:81
    ds_read2_b64 v[92:95], v34 offset0:80 offset1:81
    s_waitcnt lgkmcnt(0)
    v_mfma_f32_16x16x32_bf16 v[160:163], a[160:163], v[80:83], v[160:163]
    ds_read2_b64 v[64:67], v17 offset0:72 offset1:73
    ds_read2_b64 v[68:71], v32 offset0:72 offset1:73
    v_mfma_f32_16x16x32_bf16 v[164:167], a[160:163], v[84:87], v[164:167]
    ds_read2_b64 v[72:75], v33 offset0:72 offset1:73
    ds_read2_b64 v[76:79], v34 offset0:72 offset1:73
    v_mfma_f32_16x16x32_bf16 v[168:171], a[160:163], v[88:91], v[168:171]
    v_mfma_f32_16x16x32_bf16 v[172:175], a[160:163], v[92:95], v[172:175]
    v_mfma_f32_16x16x32_bf16 v[176:179], a[168:171], v[80:83], v[176:179]
    v_add_f32 v96, v135, v138
    v_add_f32 v97, v139, v142
    v_mfma_f32_16x16x32_bf16 v[180:183], a[168:171], v[84:87], v[180:183]
    s_add_u32 s78, s74, 1048576
    buffer_load_dwordx4 a[80:83], v2, s[56:59], s78 offen
    v_add_f32 v96, v96, v141
    v_add_f32 v129, v129, v132
    v_mfma_f32_16x16x32_bf16 v[184:187], a[168:171], v[88:91], v[184:187]
    v_add_f32 v130, v130, v133
    v_add_f32 v131, v131, v134
    v_mfma_f32_16x16x32_bf16 v[188:191], a[168:171], v[92:95], v[188:191]
    v_pk_add_f32 v[130:131], v[130:131], v[136:137]
    v_add_f32 v131, v131, v140
    v_mfma_f32_16x16x32_bf16 v[192:195], a[176:179], v[80:83], v[192:195]
    v_add_f32 v99, v151, v154
    v_add_f32 v100, v155, v158
    v_mfma_f32_16x16x32_bf16 v[196:199], a[176:179], v[84:87], v[196:199]
    v_add_f32 v99, v99, v157
    v_add_f32 v145, v145, v148
    v_mfma_f32_16x16x32_bf16 v[200:203], a[176:179], v[88:91], v[200:203]
    v_add_f32 v146, v146, v149
    v_add_f32 v147, v147, v150
    v_mfma_f32_16x16x32_bf16 v[204:207], a[176:179], v[92:95], v[204:207]
    buffer_load_dwordx4 a[84:87], v3, s[56:59], s78 offen offset:1024
    v_pk_add_f32 v[146:147], v[146:147], v[152:153]
    v_add_f32 v147, v147, v156
    v_mfma_f32_16x16x32_bf16 v[208:211], a[184:187], v[80:83], v[208:211]
    v_add_f32 v102, v167, v170
    v_add_f32 v103, v171, v174
    v_mfma_f32_16x16x32_bf16 v[212:215], a[184:187], v[84:87], v[212:215]
    v_add_f32 v102, v102, v173
    v_add_f32 v161, v161, v164
    v_mfma_f32_16x16x32_bf16 v[216:219], a[184:187], v[88:91], v[216:219]
    v_add_f32 v162, v162, v165
    v_add_f32 v163, v163, v166
    v_mfma_f32_16x16x32_bf16 v[220:223], a[184:187], v[92:95], v[220:223]
    v_pk_add_f32 v[162:163], v[162:163], v[168:169]
    v_add_f32 v163, v163, v172
    v_mfma_f32_16x16x32_bf16 v[224:227], a[192:195], v[80:83], v[224:227]
    v_cndmask_b32 v135, v96, 0, s[86:87]
    v_cndmask_b32 v139, v97, 0, s[86:87]
    v_mfma_f32_16x16x32_bf16 v[228:231], a[192:195], v[84:87], v[228:231]
    buffer_load_dwordx4 a[88:91], v4, s[56:59], s78 offen offset:2048
    v_cndmask_b32 v98, v143, 0, s[86:87]
    ds_bpermute_b32 v135, v16, v135
    v_mfma_f32_16x16x32_bf16 v[232:235], a[192:195], v[88:91], v[232:235]
    ds_bpermute_b32 v139, v16, v139
    ds_bpermute_b32 v98, v16, v98
    v_mfma_f32_16x16x32_bf16 v[236:239], a[192:195], v[92:95], v[236:239]
    v_mfma_f32_16x16x32_bf16 v[240:243], a[200:203], v[80:83], v[240:243]
    v_cndmask_b32 v151, v99, v96, s[86:87]
    v_cndmask_b32 v155, v100, v97, s[86:87]
    v_mfma_f32_16x16x32_bf16 v[244:247], a[200:203], v[84:87], v[244:247]
    v_cndmask_b32 v101, v159, v143, s[86:87]
    ds_bpermute_b32 v151, v16, v151
    v_mfma_f32_16x16x32_bf16 v[248:251], a[200:203], v[88:91], v[248:251]
    ds_bpermute_b32 v155, v16, v155
    ds_bpermute_b32 v101, v16, v101
    v_mfma_f32_16x16x32_bf16 v[252:255], a[200:203], v[92:95], v[252:255]
    buffer_load_dwordx4 a[92:95], v5, s[56:59], s78 offen offset:3072
    s_waitcnt lgkmcnt(6)
    v_mfma_f32_16x16x32_bf16 v[176:179], a[164:167], v[64:67], v[176:179]
    ds_read2_b64 v[80:83], v17 offset0:64 offset1:65
    ds_read2_b64 v[84:87], v32 offset0:64 offset1:65
    v_mfma_f32_16x16x32_bf16 v[180:183], a[164:167], v[68:71], v[180:183]
    ds_read2_b64 v[88:91], v33 offset0:64 offset1:65
    ds_read2_b64 v[92:95], v34 offset0:64 offset1:65
    v_mfma_f32_16x16x32_bf16 v[184:187], a[164:167], v[72:75], v[184:187]
    v_cndmask_b32 v167, v102, v99, s[86:87]
    v_cndmask_b32 v171, v103, v100, s[86:87]
    v_mfma_f32_16x16x32_bf16 v[188:191], a[164:167], v[76:79], v[188:191]
    v_cndmask_b32 v104, v175, v159, s[86:87]
    ds_bpermute_b32 v167, v16, v167
    v_mfma_f32_16x16x32_bf16 v[192:195], a[172:175], v[64:67], v[192:195]
    ds_bpermute_b32 v171, v16, v171
    ds_bpermute_b32 v104, v16, v104
    v_mfma_f32_16x16x32_bf16 v[196:199], a[172:175], v[68:71], v[196:199]
    s_add_u32 s78, s78, 131072
    buffer_load_dwordx4 a[96:99], v2, s[56:59], s78 offen
    s_waitcnt lgkmcnt(10)
    v_add_f32 v128, v128, v135
    v_mfma_f32_16x16x32_bf16 v[200:203], a[172:175], v[72:75], v[200:203]
    v_add_f32 v129, v129, v139
    v_add_f32 v130, v130, v98
    v_mfma_f32_16x16x32_bf16 v[204:207], a[172:175], v[76:79], v[204:207]
    v_cvt_pk_bf16_f32 v132, v128, v129
    v_cvt_pk_bf16_f32 v133, v130, v131
    v_mfma_f32_16x16x32_bf16 v[208:211], a[180:183], v[64:67], v[208:211]
    ds_write_b64 v19, v[132:133] offset:4640
    s_waitcnt lgkmcnt(8)
    v_mfma_f32_16x16x32_bf16 v[212:215], a[180:183], v[68:71], v[212:215]
    v_add_f32 v144, v144, v151
    v_add_f32 v145, v145, v155
    v_mfma_f32_16x16x32_bf16 v[216:219], a[180:183], v[72:75], v[216:219]
    v_add_f32 v146, v146, v101
    v_cvt_pk_bf16_f32 v148, v144, v145
    v_mfma_f32_16x16x32_bf16 v[220:223], a[180:183], v[76:79], v[220:223]
    buffer_load_dwordx4 a[100:103], v3, s[56:59], s78 offen offset:1024
    v_cvt_pk_bf16_f32 v149, v146, v147
    ds_write_b64 v19, v[148:149] offset:5152
    v_mfma_f32_16x16x32_bf16 v[224:227], a[188:191], v[64:67], v[224:227]
    ds_read_b128 v[152:155], v18 offset:4640
    s_waitcnt lgkmcnt(3)
    v_mfma_f32_16x16x32_bf16 v[228:231], a[188:191], v[68:71], v[228:231]
    v_add_f32 v160, v160, v167
    v_add_f32 v161, v161, v171
    v_mfma_f32_16x16x32_bf16 v[232:235], a[188:191], v[72:75], v[232:235]
    v_add_f32 v162, v162, v104
    v_cvt_pk_bf16_f32 v164, v160, v161
    v_mfma_f32_16x16x32_bf16 v[236:239], a[188:191], v[76:79], v[236:239]
    v_cvt_pk_bf16_f32 v165, v162, v163
    ds_write_b64 v19, v[164:165] offset:5664
    v_mfma_f32_16x16x32_bf16 v[240:243], a[196:199], v[64:67], v[240:243]
    v_mfma_f32_16x16x32_bf16 v[244:247], a[196:199], v[68:71], v[244:247]
    buffer_load_dwordx4 a[104:107], v4, s[56:59], s78 offen offset:2048
    v_mfma_f32_16x16x32_bf16 v[248:251], a[196:199], v[72:75], v[248:251]
    v_mfma_f32_16x16x32_bf16 v[252:255], a[196:199], v[76:79], v[252:255]
    v_mfma_f32_16x16x32_bf16 v[176:179], a[160:163], v[80:83], v[176:179]
    ds_read2_b64 v[64:67], v17 offset0:56 offset1:57
    ds_read2_b64 v[68:71], v32 offset0:56 offset1:57
    v_mfma_f32_16x16x32_bf16 v[180:183], a[160:163], v[84:87], v[180:183]
    ds_read2_b64 v[72:75], v33 offset0:56 offset1:57
    ds_read2_b64 v[76:79], v34 offset0:56 offset1:57
    v_mfma_f32_16x16x32_bf16 v[184:187], a[160:163], v[88:91], v[184:187]
    v_mfma_f32_16x16x32_bf16 v[188:191], a[160:163], v[92:95], v[188:191]
    buffer_load_dwordx4 a[108:111], v5, s[56:59], s78 offen offset:3072
    v_mfma_f32_16x16x32_bf16 v[192:195], a[168:171], v[80:83], v[192:195]
    v_mfma_f32_16x16x32_bf16 v[196:199], a[168:171], v[84:87], v[196:199]
    v_mfma_f32_16x16x32_bf16 v[200:203], a[168:171], v[88:91], v[200:203]
    v_mfma_f32_16x16x32_bf16 v[204:207], a[168:171], v[92:95], v[204:207]
    s_waitcnt vmcnt(8)
    v_mov_b32 v20, 157300
    v_mov_b32 v21, 1
    s_mov_b64 exec, 1
    ds_add_u32 v20, v21
    s_mov_b64 exec, -1
    v_mfma_f32_16x16x32_bf16 v[208:211], a[176:179], v[80:83], v[208:211]
    v_add_f32 v105, v183, v186
    v_add_f32 v106, v187, v190
    v_mfma_f32_16x16x32_bf16 v[212:215], a[176:179], v[84:87], v[212:215]
    s_add_u32 s78, s78, 131072
    buffer_load_dwordx4 a[40:43], v2, s[56:59], s78 offen
    v_add_f32 v105, v105, v189
    v_add_f32 v177, v177, v180
    v_mfma_f32_16x16x32_bf16 v[216:219], a[176:179], v[88:91], v[216:219]
    v_add_f32 v178, v178, v181
    v_add_f32 v179, v179, v182
    v_mfma_f32_16x16x32_bf16 v[220:223], a[176:179], v[92:95], v[220:223]
    v_pk_add_f32 v[178:179], v[178:179], v[184:185]
    v_add_f32 v179, v179, v188
    v_mfma_f32_16x16x32_bf16 v[224:227], a[184:187], v[80:83], v[224:227]
    v_cndmask_b32 v183, v105, v102, s[86:87]
    v_cndmask_b32 v187, v106, v103, s[86:87]
    v_mfma_f32_16x16x32_bf16 v[228:231], a[184:187], v[84:87], v[228:231]
    v_cndmask_b32 v107, v191, v175, s[86:87]
    ds_bpermute_b32 v183, v16, v183
    v_mfma_f32_16x16x32_bf16 v[232:235], a[184:187], v[88:91], v[232:235]
    ds_bpermute_b32 v187, v16, v187
    ds_bpermute_b32 v107, v16, v107
    v_mfma_f32_16x16x32_bf16 v[236:239], a[184:187], v[92:95], v[236:239]
    buffer_load_dwordx4 a[44:47], v3, s[56:59], s78 offen offset:1024
    v_mfma_f32_16x16x32_bf16 v[240:243], a[192:195], v[80:83], v[240:243]
    s_waitcnt lgkmcnt(0)
    v_add_f32 v176, v176, v183
    v_mfma_f32_16x16x32_bf16 v[244:247], a[192:195], v[84:87], v[244:247]
    v_add_f32 v177, v177, v187
    v_add_f32 v178, v178, v107
    v_mfma_f32_16x16x32_bf16 v[248:251], a[192:195], v[88:91], v[248:251]
    v_cvt_pk_bf16_f32 v180, v176, v177
    v_cvt_pk_bf16_f32 v181, v178, v179
    v_mfma_f32_16x16x32_bf16 v[252:255], a[192:195], v[92:95], v[252:255]
    ds_write_b64 v19, v[180:181] offset:6176
    ds_read_b128 v[184:187], v18 offset:5664
    v_mfma_f32_16x16x32_bf16 v[192:195], a[164:167], v[64:67], v[192:195]
    ds_read2_b64 v[80:83], v17 offset0:48 offset1:49
    ds_read2_b64 v[84:87], v32 offset0:48 offset1:49
    v_mfma_f32_16x16x32_bf16 v[196:199], a[164:167], v[68:71], v[196:199]
    buffer_load_dwordx4 a[48:51], v4, s[56:59], s78 offen offset:2048
    ds_read2_b64 v[88:91], v33 offset0:48 offset1:49
    ds_read2_b64 v[92:95], v34 offset0:48 offset1:49
    v_mfma_f32_16x16x32_bf16 v[200:203], a[164:167], v[72:75], v[200:203]
    v_mfma_f32_16x16x32_bf16 v[204:207], a[164:167], v[76:79], v[204:207]
    v_mfma_f32_16x16x32_bf16 v[208:211], a[172:175], v[64:67], v[208:211]
    v_mfma_f32_16x16x32_bf16 v[212:215], a[172:175], v[68:71], v[212:215]
    v_mfma_f32_16x16x32_bf16 v[216:219], a[172:175], v[72:75], v[216:219]
    v_mfma_f32_16x16x32_bf16 v[220:223], a[172:175], v[76:79], v[220:223]
    buffer_load_dwordx4 a[52:55], v5, s[56:59], s78 offen offset:3072
    v_mfma_f32_16x16x32_bf16 v[224:227], a[180:183], v[64:67], v[224:227]
    v_mfma_f32_16x16x32_bf16 v[228:231], a[180:183], v[68:71], v[228:231]
    v_mfma_f32_16x16x32_bf16 v[232:235], a[180:183], v[72:75], v[232:235]
    v_mfma_f32_16x16x32_bf16 v[236:239], a[180:183], v[76:79], v[236:239]
    v_mfma_f32_16x16x32_bf16 v[240:243], a[188:191], v[64:67], v[240:243]
    v_mfma_f32_16x16x32_bf16 v[244:247], a[188:191], v[68:71], v[244:247]
    s_add_u32 s78, s78, 131072
    buffer_load_dwordx4 a[56:59], v2, s[56:59], s78 offen
    v_mfma_f32_16x16x32_bf16 v[248:251], a[188:191], v[72:75], v[248:251]
    v_mfma_f32_16x16x32_bf16 v[252:255], a[188:191], v[76:79], v[252:255]
    s_waitcnt lgkmcnt(0)
    v_mfma_f32_16x16x32_bf16 v[192:195], a[160:163], v[80:83], v[192:195]
    ds_read2_b64 v[64:67], v17 offset0:40 offset1:41
    ds_read2_b64 v[68:71], v32 offset0:40 offset1:41
    v_mfma_f32_16x16x32_bf16 v[196:199], a[160:163], v[84:87], v[196:199]
    ds_read2_b64 v[72:75], v33 offset0:40 offset1:41
    ds_read2_b64 v[76:79], v34 offset0:40 offset1:41
    v_mfma_f32_16x16x32_bf16 v[200:203], a[160:163], v[88:91], v[200:203]
    v_mfma_f32_16x16x32_bf16 v[204:207], a[160:163], v[92:95], v[204:207]
    buffer_load_dwordx4 a[60:63], v3, s[56:59], s78 offen offset:1024
    v_mfma_f32_16x16x32_bf16 v[208:211], a[168:171], v[80:83], v[208:211]
    v_mfma_f32_16x16x32_bf16 v[212:215], a[168:171], v[84:87], v[212:215]
    v_mfma_f32_16x16x32_bf16 v[216:219], a[168:171], v[88:91], v[216:219]
    v_mfma_f32_16x16x32_bf16 v[220:223], a[168:171], v[92:95], v[220:223]
    v_mfma_f32_16x16x32_bf16 v[224:227], a[176:179], v[80:83], v[224:227]
    s_nop 0
    v_add_f32 v108, v199, v202
    v_add_f32 v109, v203, v206
    v_mfma_f32_16x16x32_bf16 v[228:231], a[176:179], v[84:87], v[228:231]
    buffer_load_dwordx4 a[64:67], v4, s[56:59], s78 offen offset:2048
    v_add_f32 v108, v108, v205
    v_add_f32 v193, v193, v196
    v_mfma_f32_16x16x32_bf16 v[232:235], a[176:179], v[88:91], v[232:235]
    v_add_f32 v194, v194, v197
    v_add_f32 v195, v195, v198
    v_mfma_f32_16x16x32_bf16 v[236:239], a[176:179], v[92:95], v[236:239]
    v_pk_add_f32 v[194:195], v[194:195], v[200:201]
    v_add_f32 v195, v195, v204
    v_mfma_f32_16x16x32_bf16 v[240:243], a[184:187], v[80:83], v[240:243]
    v_cndmask_b32 v199, v108, v105, s[86:87]
    v_cndmask_b32 v203, v109, v106, s[86:87]
    v_mfma_f32_16x16x32_bf16 v[244:247], a[184:187], v[84:87], v[244:247]
    v_cndmask_b32 v110, v207, v191, s[86:87]
    ds_bpermute_b32 v199, v16, v199
    v_mfma_f32_16x16x32_bf16 v[248:251], a[184:187], v[88:91], v[248:251]
    ds_bpermute_b32 v203, v16, v203
    ds_bpermute_b32 v110, v16, v110
    v_mfma_f32_16x16x32_bf16 v[252:255], a[184:187], v[92:95], v[252:255]
    buffer_load_dwordx4 a[68:71], v5, s[56:59], s78 offen offset:3072
    s_waitcnt lgkmcnt(3)
    v_mfma_f32_16x16x32_bf16 v[208:211], a[164:167], v[64:67], v[208:211]
    ds_read2_b64 v[80:83], v17 offset0:32 offset1:33
    ds_read2_b64 v[84:87], v32 offset0:32 offset1:33
    v_mfma_f32_16x16x32_bf16 v[212:215], a[164:167], v[68:71], v[212:215]
    ds_read2_b64 v[88:91], v33 offset0:32 offset1:33
    ds_read2_b64 v[92:95], v34 offset0:32 offset1:33
    v_mfma_f32_16x16x32_bf16 v[216:219], a[164:167], v[72:75], v[216:219]
    s_waitcnt lgkmcnt(4)
    v_add_f32 v192, v192, v199
    v_mfma_f32_16x16x32_bf16 v[220:223], a[164:167], v[76:79], v[220:223]
    v_add_f32 v193, v193, v203
    v_add_f32 v194, v194, v110
    v_mfma_f32_16x16x32_bf16 v[224:227], a[172:175], v[64:67], v[224:227]
    v_cvt_pk_bf16_f32 v196, v192, v193
    v_cvt_pk_bf16_f32 v197, v194, v195
    v_mfma_f32_16x16x32_bf16 v[228:231], a[172:175], v[68:71], v[228:231]
    s_add_u32 s78, s78, 131072
    buffer_load_dwordx4 a[224:227], v2, s[56:59], s78 offen
    ds_write_b64 v19, v[196:197] offset:6688
    v_mfma_f32_16x16x32_bf16 v[232:235], a[172:175], v[72:75], v[232:235]
    v_mfma_f32_16x16x32_bf16 v[236:239], a[172:175], v[76:79], v[236:239]
    v_mfma_f32_16x16x32_bf16 v[240:243], a[180:183], v[64:67], v[240:243]
    v_mfma_f32_16x16x32_bf16 v[244:247], a[180:183], v[68:71], v[244:247]
    v_mfma_f32_16x16x32_bf16 v[248:251], a[180:183], v[72:75], v[248:251]
    v_mfma_f32_16x16x32_bf16 v[252:255], a[180:183], v[76:79], v[252:255]
    buffer_load_dwordx4 a[228:231], v3, s[56:59], s78 offen offset:1024
    s_waitcnt lgkmcnt(1)
    v_mfma_f32_16x16x32_bf16 v[208:211], a[160:163], v[80:83], v[208:211]
    ds_read2_b64 v[64:67], v17 offset0:24 offset1:25
    ds_read2_b64 v[68:71], v32 offset0:24 offset1:25
    v_mfma_f32_16x16x32_bf16 v[212:215], a[160:163], v[84:87], v[212:215]
    ds_read2_b64 v[72:75], v33 offset0:24 offset1:25
    ds_read2_b64 v[76:79], v34 offset0:24 offset1:25
    v_mfma_f32_16x16x32_bf16 v[216:219], a[160:163], v[88:91], v[216:219]
    v_mfma_f32_16x16x32_bf16 v[220:223], a[160:163], v[92:95], v[220:223]
    v_mfma_f32_16x16x32_bf16 v[224:227], a[168:171], v[80:83], v[224:227]
    v_mfma_f32_16x16x32_bf16 v[228:231], a[168:171], v[84:87], v[228:231]
    buffer_load_dwordx4 a[232:235], v4, s[56:59], s78 offen offset:2048
    v_mfma_f32_16x16x32_bf16 v[232:235], a[168:171], v[88:91], v[232:235]
    v_mfma_f32_16x16x32_bf16 v[236:239], a[168:171], v[92:95], v[236:239]
    v_mfma_f32_16x16x32_bf16 v[240:243], a[176:179], v[80:83], v[240:243]
    s_nop 0
    v_add_f32 v111, v215, v218
    v_add_f32 v112, v219, v222
    v_mfma_f32_16x16x32_bf16 v[244:247], a[176:179], v[84:87], v[244:247]
    v_add_f32 v111, v111, v221
    v_add_f32 v209, v209, v212
    v_mfma_f32_16x16x32_bf16 v[248:251], a[176:179], v[88:91], v[248:251]
    v_add_f32 v210, v210, v213
    v_add_f32 v211, v211, v214
    v_mfma_f32_16x16x32_bf16 v[252:255], a[176:179], v[92:95], v[252:255]
    buffer_load_dwordx4 a[236:239], v5, s[56:59], s78 offen offset:3072
    v_pk_add_f32 v[210:211], v[210:211], v[216:217]
    v_add_f32 v211, v211, v220
    s_waitcnt lgkmcnt(0)
    v_mfma_f32_16x16x32_bf16 v[224:227], a[164:167], v[64:67], v[224:227]
    ds_read2_b64 v[80:83], v17 offset0:16 offset1:17
    ds_read2_b64 v[84:87], v32 offset0:16 offset1:17
    v_mfma_f32_16x16x32_bf16 v[228:231], a[164:167], v[68:71], v[228:231]
    ds_read2_b64 v[88:91], v33 offset0:16 offset1:17
    ds_read2_b64 v[92:95], v34 offset0:16 offset1:17
    v_mfma_f32_16x16x32_bf16 v[232:235], a[164:167], v[72:75], v[232:235]
    v_cndmask_b32 v215, v111, v108, s[86:87]
    v_cndmask_b32 v219, v112, v109, s[86:87]
    v_mfma_f32_16x16x32_bf16 v[236:239], a[164:167], v[76:79], v[236:239]
    v_cndmask_b32 v113, v223, v207, s[86:87]
    ds_bpermute_b32 v215, v16, v215
    v_mfma_f32_16x16x32_bf16 v[240:243], a[172:175], v[64:67], v[240:243]
    ds_bpermute_b32 v219, v16, v219
    ds_bpermute_b32 v113, v16, v113
    v_mfma_f32_16x16x32_bf16 v[244:247], a[172:175], v[68:71], v[244:247]
    s_waitcnt lgkmcnt(0)
    v_add_f32 v208, v208, v215
    v_mfma_f32_16x16x32_bf16 v[248:251], a[172:175], v[72:75], v[248:251]
    v_add_f32 v209, v209, v219
    v_add_f32 v210, v210, v113
    v_mfma_f32_16x16x32_bf16 v[252:255], a[172:175], v[76:79], v[252:255]
    v_cvt_pk_bf16_f32 v212, v208, v209
    v_cvt_pk_bf16_f32 v213, v210, v211
    v_mfma_f32_16x16x32_bf16 v[224:227], a[160:163], v[80:83], v[224:227]
    ds_read2_b64 v[64:67], v17 offset0:8 offset1:9
    ds_read2_b64 v[68:71], v32 offset0:8 offset1:9
    v_mfma_f32_16x16x32_bf16 v[228:231], a[160:163], v[84:87], v[228:231]
    ds_read2_b64 v[72:75], v33 offset0:8 offset1:9
    ds_read2_b64 v[76:79], v34 offset0:8 offset1:9
    v_mfma_f32_16x16x32_bf16 v[232:235], a[160:163], v[88:91], v[232:235]
    ds_write_b64 v19, v[212:213] offset:7200
    ds_read_b128 v[216:219], v18 offset:6688
    v_mfma_f32_16x16x32_bf16 v[236:239], a[160:163], v[92:95], v[236:239]
    v_mfma_f32_16x16x32_bf16 v[240:243], a[168:171], v[80:83], v[240:243]
    v_mfma_f32_16x16x32_bf16 v[244:247], a[168:171], v[84:87], v[244:247]
    v_mfma_f32_16x16x32_bf16 v[248:251], a[168:171], v[88:91], v[248:251]
    v_mfma_f32_16x16x32_bf16 v[252:255], a[168:171], v[92:95], v[252:255]
    s_waitcnt lgkmcnt(2)
    v_mfma_f32_16x16x32_bf16 v[240:243], a[164:167], v[64:67], v[240:243]
    ds_read2_b64 v[80:83], v17 offset0:0 offset1:1
    ds_read2_b64 v[84:87], v32 offset0:0 offset1:1
    v_mfma_f32_16x16x32_bf16 v[244:247], a[164:167], v[68:71], v[244:247]
    ds_read2_b64 v[88:91], v33 offset0:0 offset1:1
    ds_read2_b64 v[92:95], v34 offset0:0 offset1:1
    v_mfma_f32_16x16x32_bf16 v[248:251], a[164:167], v[72:75], v[248:251]
    v_add_f32 v114, v231, v234
    v_add_f32 v115, v235, v238
    v_mfma_f32_16x16x32_bf16 v[252:255], a[164:167], v[76:79], v[252:255]
    v_add_f32 v114, v114, v237
    v_add_f32 v225, v225, v228
    s_waitcnt lgkmcnt(0)
    v_mfma_f32_16x16x32_bf16 v[240:243], a[160:163], v[80:83], v[240:243]
    v_add_f32 v226, v226, v229
    v_add_f32 v227, v227, v230
    v_mfma_f32_16x16x32_bf16 v[244:247], a[160:163], v[84:87], v[244:247]
    v_pk_add_f32 v[226:227], v[226:227], v[232:233]
    v_add_f32 v227, v227, v236
    v_mfma_f32_16x16x32_bf16 v[248:251], a[160:163], v[88:91], v[248:251]
    v_cndmask_b32 v231, v114, v111, s[86:87]
    v_cndmask_b32 v235, v115, v112, s[86:87]
    v_mfma_f32_16x16x32_bf16 v[252:255], a[160:163], v[92:95], v[252:255]
    v_cndmask_b32 v116, v239, v223, s[86:87]
    ds_bpermute_b32 v231, v16, v231
    ds_bpermute_b32 v235, v16, v235
    ds_bpermute_b32 v116, v16, v116
    s_waitcnt lgkmcnt(0)
    v_add_f32 v224, v224, v231
    v_add_f32 v225, v225, v235
    v_add_f32 v226, v226, v116
    v_cvt_pk_bf16_f32 v228, v224, v225
    v_cvt_pk_bf16_f32 v229, v226, v227
    ds_write_b64 v19, v[228:229] offset:7712
    v_add_f32 v117, v247, v250
    v_add_f32 v118, v251, v254
    v_add_f32 v117, v117, v253
    v_add_f32 v241, v241, v244
    v_add_f32 v242, v242, v245
    v_add_f32 v243, v243, v246
    v_pk_add_f32 v[242:243], v[242:243], v[248:249]
    v_add_f32 v243, v243, v252
    v_cndmask_b32 v247, v117, v114, s[86:87]
    v_cndmask_b32 v251, v118, v115, s[86:87]
    v_cndmask_b32 v119, v255, v239, s[86:87]
    ds_bpermute_b32 v247, v16, v247
    ds_bpermute_b32 v251, v16, v251
    ds_bpermute_b32 v119, v16, v119
    s_waitcnt lgkmcnt(0)
    v_add_f32 v240, v240, v247
    v_add_f32 v241, v241, v251
    v_add_f32 v242, v242, v119
    v_cvt_pk_bf16_f32 v244, v240, v241
    v_cvt_pk_bf16_f32 v245, v242, v243
    ds_write_b64 v19, v[244:245] offset:8224
    ds_read_b128 v[248:251], v18 offset:7712
    buffer_store_dwordx4 v[152:155], v1, s[60:63], s80 offen sc1
    buffer_store_dwordx4 v[184:187], v1, s[60:63], s80 offen offset:1024 sc1
    buffer_store_dwordx4 v[216:219], v1, s[60:63], s80 offen offset:2048 sc1
    s_waitcnt lgkmcnt(0)
    buffer_store_dwordx4 v[248:251], v1, s[60:63], s80 offen offset:3072 sc1
    s_cmp_eq_u32 s11, 1
    s_cbranch_scc1 L_nop7
    s_mov_b32 s58, 0x6c0000
    v_mov_b32 v20, 157316
    s_mov_b32 s84, 0
L_cntw2:
    ds_read_b32 v21, v20
    s_waitcnt lgkmcnt(0)
    v_readfirstlane_b32 s14, v21
    s_nop 0
    s_cmp_ge_u32 s14, 1
    s_cbranch_scc1 L_cntw2_ok
    s_sleep 1
    s_add_u32 s84, s84, 1
    s_cmp_lt_u32 s84, 0x80000
    s_cbranch_scc1 L_cntw2
L_cntw2_ok:
    s_add_u32 s78, s74, 0
    s_add_u32 m0, s72, 16384
    s_nop 0
    buffer_load_dwordx4 v2, s[56:59], s78 offen lds
    buffer_load_dwordx4 v3, s[56:59], s78 offen offset:1024 lds
    buffer_load_dwordx4 v4, s[56:59], s78 offen offset:2048 lds
    buffer_load_dwordx4 v5, s[56:59], s78 offen offset:3072 lds
    s_add_u32 s78, s78, 131072
    s_add_u32 m0, s72, 20480
    s_nop 0
    buffer_load_dwordx4 v2, s[56:59], s78 offen lds
    buffer_load_dwordx4 v3, s[56:59], s78 offen offset:1024 lds
    buffer_load_dwordx4 v4, s[56:59], s78 offen offset:2048 lds
    buffer_load_dwordx4 v5, s[56:59], s78 offen offset:3072 lds
    s_add_u32 s78, s78, 131072
    s_add_u32 m0, s72, 24576
    s_nop 0
    buffer_load_dwordx4 v2, s[56:59], s78 offen lds
    buffer_load_dwordx4 v3, s[56:59], s78 offen offset:1024 lds
    buffer_load_dwordx4 v4, s[56:59], s78 offen offset:2048 lds
    buffer_load_dwordx4 v5, s[56:59], s78 offen offset:3072 lds
    s_add_u32 s78, s78, 131072
    s_add_u32 m0, s72, 28672
    s_nop 0
    buffer_load_dwordx4 v2, s[56:59], s78 offen lds
    buffer_load_dwordx4 v3, s[56:59], s78 offen offset:1024 lds
    buffer_load_dwordx4 v4, s[56:59], s78 offen offset:2048 lds
    buffer_load_dwordx4 v5, s[56:59], s78 offen offset:3072 lds
    s_add_u32 s78, s74, 1048576
    buffer_load_dwordx4 a[80:83], v2, s[56:59], s78 offen
    buffer_load_dwordx4 a[84:87], v3, s[56:59], s78 offen offset:1024
    buffer_load_dwordx4 a[88:91], v4, s[56:59], s78 offen offset:2048
    buffer_load_dwordx4 a[92:95], v5, s[56:59], s78 offen offset:3072
    s_add_u32 s78, s78, 131072
    buffer_load_dwordx4 a[96:99], v2, s[56:59], s78 offen
    buffer_load_dwordx4 a[100:103], v3, s[56:59], s78 offen offset:1024
    buffer_load_dwordx4 a[104:107], v4, s[56:59], s78 offen offset:2048
    buffer_load_dwordx4 a[108:111], v5, s[56:59], s78 offen offset:3072
    s_add_u32 s78, s78, 131072
    buffer_load_dwordx4 a[40:43], v2, s[56:59], s78 offen
    buffer_load_dwordx4 a[44:47], v3, s[56:59], s78 offen offset:1024
    buffer_load_dwordx4 a[48:51], v4, s[56:59], s78 offen offset:2048
    buffer_load_dwordx4 a[52:55], v5, s[56:59], s78 offen offset:3072
    s_add_u32 s78, s78, 131072
    buffer_load_dwordx4 a[56:59], v2, s[56:59], s78 offen
    buffer_load_dwordx4 a[60:63], v3, s[56:59], s78 offen offset:1024
    buffer_load_dwordx4 a[64:67], v4, s[56:59], s78 offen offset:2048
    buffer_load_dwordx4 a[68:71], v5, s[56:59], s78 offen offset:3072
    s_add_u32 s78, s78, 131072
    buffer_load_dwordx4 a[224:227], v2, s[56:59], s78 offen
    buffer_load_dwordx4 a[228:231], v3, s[56:59], s78 offen offset:1024
    buffer_load_dwordx4 a[232:235], v4, s[56:59], s78 offen offset:2048
    buffer_load_dwordx4 a[236:239], v5, s[56:59], s78 offen offset:3072
    s_waitcnt vmcnt(0)
L_nop7:
    s_waitcnt vmcnt(4)
    s_branch L_wait2
L_idle2:
    s_add_u32 s78, s74, 1048576
    buffer_load_dwordx4 a[80:83], v2, s[56:59], s78 offen
    buffer_load_dwordx4 a[84:87], v3, s[56:59], s78 offen offset:1024
    buffer_load_dwordx4 a[88:91], v4, s[56:59], s78 offen offset:2048
    buffer_load_dwordx4 a[92:95], v5, s[56:59], s78 offen offset:3072
    s_add_u32 s78, s78, 131072
    buffer_load_dwordx4 a[96:99], v2, s[56:59], s78 offen
    buffer_load_dwordx4 a[100:103], v3, s[56:59], s78 offen offset:1024
    buffer_load_dwordx4 a[104:107], v4, s[56:59], s78 offen offset:2048
    buffer_load_dwordx4 a[108:111], v5, s[56:59], s78 offen offset:3072
    s_waitcnt vmcnt(8)
    v_mov_b32 v20, 157300
    v_mov_b32 v21, 1
    s_mov_b64 exec, 1
    ds_add_u32 v20, v21
    s_mov_b64 exec, -1
    s_add_u32 s78, s78, 131072
    buffer_load_dwordx4 a[40:43], v2, s[56:59], s78 offen
    buffer_load_dwordx4 a[44:47], v3, s[56:59], s78 offen offset:1024
    buffer_load_dwordx4 a[48:51], v4, s[56:59], s78 offen offset:2048
    buffer_load_dwordx4 a[52:55], v5, s[56:59], s78 offen offset:3072
    s_add_u32 s78, s78, 131072
    buffer_load_dwordx4 a[56:59], v2, s[56:59], s78 offen
    buffer_load_dwordx4 a[60:63], v3, s[56:59], s78 offen offset:1024
    buffer_load_dwordx4 a[64:67], v4, s[56:59], s78 offen offset:2048
    buffer_load_dwordx4 a[68:71], v5, s[56:59], s78 offen offset:3072
    s_add_u32 s78, s78, 131072
    buffer_load_dwordx4 a[224:227], v2, s[56:59], s78 offen
    buffer_load_dwordx4 a[228:231], v3, s[56:59], s78 offen offset:1024
    buffer_load_dwordx4 a[232:235], v4, s[56:59], s78 offen offset:2048
    buffer_load_dwordx4 a[236:239], v5, s[56:59], s78 offen offset:3072
    s_waitcnt vmcnt(0)
L_wait2:
    s_nop 1
    v_mov_b32 v20, 157304
    s_mov_b32 s84, 0
L_cnt2:
    ds_read_b32 v21, v20
    s_waitcnt lgkmcnt(0)
    v_readfirstlane_b32 s14, v21
    s_nop 0
    s_cmp_ge_u32 s14, 1
    s_cbranch_scc1 L_cnt2_ok
    s_sleep 1
    s_add_u32 s84, s84, 1
    s_cmp_lt_u32 s84, 0x80000
    s_cbranch_scc1 L_cnt2
L_cnt2_ok:
    s_branch L_join2
L_plain2:
    s_nop 1
    v_min_u32 v22, 26, v0
    v_lshlrev_b32 v22, 4, v22
    s_lshl_b32 s80, s5, 12
    s_lshl_b32 s15, s90, 9
    s_add_u32 s80, s80, s15
    s_add_u32 s80, s80, 0x30000
    s_mov_b32 s84, 0
Lpoll_7:
    buffer_load_dword v24, v22, s[60:63], s80 offen sc1
    s_waitcnt vmcnt(0)
    v_xor_b32 v24, s4, v24
    v_cmp_ne_u32 vcc, 0, v24
    s_cbranch_vccz Lpolled_8
    s_sleep 6
    s_add_u32 s84, s84, 1
    s_cmp_lt_u32 s84, 0x4000
    s_cbranch_scc1 Lpoll_7
Lpolled_8:
    v_mov_b32 v20, 157304
    v_mov_b32 v21, 1
    s_mov_b64 exec, 1
    ds_add_u32 v20, v21
    s_mov_b64 exec, -1
L_join2:
    s_nop 1
    s_mul_i32 s76, s3, 532480
    s_mul_i32 s15, s90, 1280
    s_add_u32 s76, s76, s15
    s_add_u32 s79, s76, 0
    buffer_load_dwordx4 a[0:3], v10, s[64:67], s79 offen sc1
    buffer_load_dwordx4 a[4:7], v10, s[64:67], s79 offen offset:256 sc1
    buffer_load_dwordx4 a[8:11], v10, s[64:67], s79 offen offset:512 sc1
    buffer_load_dwordx4 a[12:15], v10, s[64:67], s79 offen offset:768 sc1
    buffer_load_dwordx4 a[16:19], v10, s[64:67], s79 offen offset:1024 sc1
    s_add_u32 s79, s76, 40960
    buffer_load_dwordx4 a[20:23], v10, s[64:67], s79 offen sc1
    buffer_load_dwordx4 a[24:27], v10, s[64:67], s79 offen offset:256 sc1
    buffer_load_dwordx4 a[28:31], v10, s[64:67], s79 offen offset:512 sc1
    buffer_load_dwordx4 a[32:35], v10, s[64:67], s79 offen offset:768 sc1
    buffer_load_dwordx4 a[36:39], v10, s[64:67], s79 offen offset:1024 sc1
    s_cmp_eq_u32 s3, 3
    s_cbranch_scc1 L_loop2b
    ds_read_b64_tr_b16 v[96:97], v6 offset:16384
    ds_read_b64_tr_b16 v[98:99], v6 offset:16896
    ds_read_b64_tr_b16 v[100:101], v7 offset:16384
    ds_read_b64_tr_b16 v[102:103], v7 offset:16896
    ds_read_b64_tr_b16 v[104:105], v8 offset:16384
    ds_read_b64_tr_b16 v[106:107], v8 offset:16896
    ds_read_b64_tr_b16 v[108:109], v9 offset:16384
    ds_read_b64_tr_b16 v[110:111], v9 offset:16896
    s_waitcnt lgkmcnt(0)
    s_waitcnt vmcnt(9)
    v_mfma_f32_16x16x32_bf16 v[128:131], a[0:3], v[96:99], 0
    s_add_u32 s79, s79, 40960
    ds_read_b64_tr_b16 v[112:113], v6 offset:20480
    v_mfma_f32_16x16x32_bf16 v[148:151], a[0:3], v[100:103], 0
    ds_read_b64_tr_b16 v[114:115], v6 offset:20992
    ds_read_b64_tr_b16 v[116:117], v7 offset:20480
    v_mfma_f32_16x16x32_bf16 v[168:171], a[0:3], v[104:107], 0
    v_mfma_f32_16x16x32_bf16 v[188:191], a[0:3], v[108:111], 0
    buffer_load_dwordx4 a[0:3], v10, s[64:67], s79 offen sc1
    s_waitcnt vmcnt(9)
    v_mfma_f32_16x16x32_bf16 v[132:135], a[4:7], v[96:99], 0
    ds_read_b64_tr_b16 v[118:119], v7 offset:20992
    ds_read_b64_tr_b16 v[120:121], v8 offset:20480
    v_mfma_f32_16x16x32_bf16 v[152:155], a[4:7], v[100:103], 0
    ds_read_b64_tr_b16 v[122:123], v8 offset:20992
    v_mfma_f32_16x16x32_bf16 v[172:175], a[4:7], v[104:107], 0
    v_mfma_f32_16x16x32_bf16 v[192:195], a[4:7], v[108:111], 0
    buffer_load_dwordx4 a[4:7], v10, s[64:67], s79 offen offset:256 sc1
    s_waitcnt vmcnt(9)
    v_mfma_f32_16x16x32_bf16 v[136:139], a[8:11], v[96:99], 0
    ds_read_b64_tr_b16 v[124:125], v9 offset:20480
    ds_read_b64_tr_b16 v[126:127], v9 offset:20992
    v_mfma_f32_16x16x32_bf16 v[156:159], a[8:11], v[100:103], 0
    ds_write_b128 v11, a[80:83] offset:16384
    ds_write_b128 v11, a[84:87] offset:17408
    v_mfma_f32_16x16x32_bf16 v[176:179], a[8:11], v[104:107], 0
    v_mfma_f32_16x16x32_bf16 v[196:199], a[8:11], v[108:111], 0
    buffer_load_dwordx4 a[8:11], v10, s[64:67], s79 offen offset:512 sc1
    s_waitcnt vmcnt(9)
    v_mfma_f32_16x16x32_bf16 v[140:143], a[12:15], v[96:99], 0
    ds_write_b128 v11, a[88:91] offset:18432
    v_mfma_f32_16x16x32_bf16 v[160:163], a[12:15], v[100:103], 0
    v_mfma_f32_16x16x32_bf16 v[180:183], a[12:15], v[104:107], 0
    v_mfma_f32_16x16x32_bf16 v[200:203], a[12:15], v[108:111], 0
    buffer_load_dwordx4 a[12:15], v10, s[64:67], s79 offen offset:768 sc1
    s_waitcnt vmcnt(9)
    v_mfma_f32_16x16x32_bf16 v[144:147], a[16:19], v[96:99], 0
    ds_write_b128 v11, a[92:95] offset:19456
    v_mfma_f32_16x16x32_bf16 v[164:167], a[16:19], v[100:103], 0
    v_mfma_f32_16x16x32_bf16 v[184:187], a[16:19], v[104:107], 0
    v_mfma_f32_16x16x32_bf16 v[204:207], a[16:19], v[108:111], 0
    buffer_load_dwordx4 a[16:19], v10, s[64:67], s79 offen offset:1024 sc1
    s_waitcnt lgkmcnt(4)
    s_waitcnt vmcnt(9)
    v_mfma_f32_16x16x32_bf16 v[128:131], a[20:23], v[112:115], v[128:131]
    s_add_u32 s79, s79, 40960
    ds_read_b64_tr_b16 v[96:97], v6 offset:24576
    v_mfma_f32_16x16x32_bf16 v[148:151], a[20:23], v[116:119], v[148:151]
    ds_read_b64_tr_b16 v[98:99], v6 offset:25088
    ds_read_b64_tr_b16 v[100:101], v7 offset:24576
    v_mfma_f32_16x16x32_bf16 v[168:171], a[20:23], v[120:123], v[168:171]
    v_mfma_f32_16x16x32_bf16 v[188:191], a[20:23], v[124:127], v[188:191]
    buffer_load_dwordx4 a[20:23], v10, s[64:67], s79 offen sc1
    s_waitcnt vmcnt(9)
    v_mfma_f32_16x16x32_bf16 v[132:135], a[24:27], v[112:115], v[132:135]
    ds_read_b64_tr_b16 v[102:103], v7 offset:25088
    ds_read_b64_tr_b16 v[104:105], v8 offset:24576
    v_mfma_f32_16x16x32_bf16 v[152:155], a[24:27], v[116:119], v[152:155]
    ds_read_b64_tr_b16 v[106:107], v8 offset:25088
    v_mfma_f32_16x16x32_bf16 v[172:175], a[24:27], v[120:123], v[172:175]
    v_mfma_f32_16x16x32_bf16 v[192:195], a[24:27], v[124:127], v[192:195]
    buffer_load_dwordx4 a[24:27], v10, s[64:67], s79 offen offset:256 sc1
    s_waitcnt vmcnt(9)
    v_mfma_f32_16x16x32_bf16 v[136:139], a[28:31], v[112:115], v[136:139]
    ds_read_b64_tr_b16 v[108:109], v9 offset:24576
    ds_read_b64_tr_b16 v[110:111], v9 offset:25088
    v_mfma_f32_16x16x32_bf16 v[156:159], a[28:31], v[116:119], v[156:159]
    ds_write_b128 v11, a[96:99] offset:20480
    ds_write_b128 v11, a[100:103] offset:21504
    v_mfma_f32_16x16x32_bf16 v[176:179], a[28:31], v[120:123], v[176:179]
    v_mfma_f32_16x16x32_bf16 v[196:199], a[28:31], v[124:127], v[196:199]
    buffer_load_dwordx4 a[28:31], v10, s[64:67], s79 offen offset:512 sc1
    s_waitcnt vmcnt(9)
    v_mfma_f32_16x16x32_bf16 v[140:143], a[32:35], v[112:115], v[140:143]
    ds_write_b128 v11, a[104:107] offset:22528
    v_mfma_f32_16x16x32_bf16 v[160:163], a[32:35], v[116:119], v[160:163]
    v_mfma_f32_16x16x32_bf16 v[180:183], a[32:35], v[120:123], v[180:183]
    v_mfma_f32_16x16x32_bf16 v[200:203], a[32:35], v[124:127], v[200:203]
    buffer_load_dwordx4 a[32:35], v10, s[64:67], s79 offen offset:768 sc1
    s_waitcnt vmcnt(9)
    v_mfma_f32_16x16x32_bf16 v[144:147], a[36:39], v[112:115], v[144:147]
    ds_write_b128 v11, a[108:111] offset:23552
    v_mfma_f32_16x16x32_bf16 v[164:167], a[36:39], v[116:119], v[164:167]
    v_mfma_f32_16x16x32_bf16 v[184:187], a[36:39], v[120:123], v[184:187]
    v_mfma_f32_16x16x32_bf16 v[204:207], a[36:39], v[124:127], v[204:207]
    buffer_load_dwordx4 a[36:39], v10, s[64:67], s79 offen offset:1024 sc1
    s_waitcnt lgkmcnt(4)
    s_waitcnt vmcnt(9)
    v_mfma_f32_16x16x32_bf16 v[128:131], a[0:3], v[96:99], v[128:131]
    s_add_u32 s79, s79, 40960
    ds_read_b64_tr_b16 v[112:113], v6 offset:28672
    v_mfma_f32_16x16x32_bf16 v[148:151], a[0:3], v[100:103], v[148:151]
    ds_read_b64_tr_b16 v[114:115], v6 offset:29184
    ds_read_b64_tr_b16 v[116:117], v7 offset:28672
    v_mfma_f32_16x16x32_bf16 v[168:171], a[0:3], v[104:107], v[168:171]
    v_mfma_f32_16x16x32_bf16 v[188:191], a[0:3], v[108:111], v[188:191]
    buffer_load_dwordx4 a[0:3], v10, s[64:67], s79 offen sc1
    s_waitcnt vmcnt(9)
    v_mfma_f32_16x16x32_bf16 v[132:135], a[4:7], v[96:99], v[132:135]
    ds_read_b64_tr_b16 v[118:119], v7 offset:29184
    ds_read_b64_tr_b16 v[120:121], v8 offset:28672
    v_mfma_f32_16x16x32_bf16 v[152:155], a[4:7], v[100:103], v[152:155]
    ds_read_b64_tr_b16 v[122:123], v8 offset:29184
    v_mfma_f32_16x16x32_bf16 v[172:175], a[4:7], v[104:107], v[172:175]
    v_mfma_f32_16x16x32_bf16 v[192:195], a[4:7], v[108:111], v[192:195]
    buffer_load_dwordx4 a[4:7], v10, s[64:67], s79 offen offset:256 sc1
    s_waitcnt vmcnt(9)
    v_mfma_f32_16x16x32_bf16 v[136:139], a[8:11], v[96:99], v[136:139]
    ds_read_b64_tr_b16 v[124:125], v9 offset:28672
    ds_read_b64_tr_b16 v[126:127], v9 offset:29184
    v_mfma_f32_16x16x32_bf16 v[156:159], a[8:11], v[100:103], v[156:159]
    ds_write_b128 v11, a[40:43] offset:24576
    ds_write_b128 v11, a[44:47] offset:25600
    v_mfma_f32_16x16x32_bf16 v[176:179], a[8:11], v[104:107], v[176:179]
    v_mfma_f32_16x16x32_bf16 v[196:199], a[8:11], v[108:111], v[196:199]
    buffer_load_dwordx4 a[8:11], v10, s[64:67], s79 offen offset:512 sc1
    s_waitcnt vmcnt(9)
    v_mfma_f32_16x16x32_bf16 v[140:143], a[12:15], v[96:99], v[140:143]
    ds_write_b128 v11, a[48:51] offset:26624
    v_mfma_f32_16x16x32_bf16 v[160:163], a[12:15], v[100:103], v[160:163]
    v_mfma_f32_16x16x32_bf16 v[180:183], a[12:15], v[104:107], v[180:183]
    v_mfma_f32_16x16x32_bf16 v[200:203], a[12:15], v[108:111], v[200:203]
    buffer_load_dwordx4 a[12:15], v10, s[64:67], s79 offen offset:768 sc1
    s_waitcnt vmcnt(9)
    v_mfma_f32_16x16x32_bf16 v[144:147], a[16:19], v[96:99], v[144:147]
    ds_write_b128 v11, a[52:55] offset:27648
    v_mfma_f32_16x16x32_bf16 v[164:167], a[16:19], v[100:103], v[164:167]
    v_mfma_f32_16x16x32_bf16 v[184:187], a[16:19], v[104:107], v[184:187]
    v_mfma_f32_16x16x32_bf16 v[204:207], a[16:19], v[108:111], v[204:207]
    buffer_load_dwordx4 a[16:19], v10, s[64:67], s79 offen offset:1024 sc1
    s_cmp_eq_u32 s10, 1
    s_cselect_b32 s14, s9, 1032192
    v_mov_b32 v32, s4
    v_mov_b32 v33, s4
    v_mov_b32 v34, s4
    v_mov_b32 v35, s4
    v_mul_u32_u24 v36, 16384, v0
    s_lshl_b32 s85, s14, 4
    s_add_u32 s85, s85, 0x40000
    s_mov_b64 exec, 0xff
    buffer_store_dwordx4 v[32:35], v36, s[60:63], s85 offen sc1
    s_mov_b64 exec, -1
    s_waitcnt lgkmcnt(4)
    s_waitcnt vmcnt(10)
    v_mfma_f32_16x16x32_bf16 v[128:131], a[20:23], v[112:115], v[128:131]
    s_add_u32 s79, s79, 40960
    ds_read_b64_tr_b16 v[96:97], v6 offset:0
    v_mfma_f32_16x16x32_bf16 v[148:151], a[20:23], v[116:119], v[148:151]
    ds_read_b64_tr_b16 v[98:99], v6 offset:512
    ds_read_b64_tr_b16 v[100:101], v7 offset:0
    v_mfma_f32_16x16x32_bf16 v[168:171], a[20:23], v[120:123], v[168:171]
    v_mfma_f32_16x16x32_bf16 v[188:191], a[20:23], v[124:127], v[188:191]
    buffer_load_dwordx4 a[20:23], v10, s[64:67], s79 offen sc1
    s_waitcnt vmcnt(10)
    v_mfma_f32_16x16x32_bf16 v[132:135], a[24:27], v[112:115], v[132:135]
    ds_read_b64_tr_b16 v[102:103], v7 offset:512
    ds_read_b64_tr_b16 v[104:105], v8 offset:0
    v_mfma_f32_16x16x32_bf16 v[152:155], a[24:27], v[116:119], v[152:155]
    ds_read_b64_tr_b16 v[106:107], v8 offset:512
    v_mfma_f32_16x16x32_bf16 v[172:175], a[24:27], v[120:123], v[172:175]
    v_mfma_f32_16x16x32_bf16 v[192:195], a[24:27], v[124:127], v[192:195]
    buffer_load_dwordx4 a[24:27], v10, s[64:67], s79 offen offset:256 sc1
    s_waitcnt vmcnt(10)
    v_mfma_f32_16x16x32_bf16 v[136:139], a[28:31], v[112:115], v[136:139]
    ds_read_b64_tr_b16 v[108:109], v9 offset:0
    ds_read_b64_tr_b16 v[110:111], v9 offset:512
    v_mfma_f32_16x16x32_bf16 v[156:159], a[28:31], v[116:119], v[156:159]
    ds_write_b128 v11, a[56:59] offset:28672
    ds_write_b128 v11, a[60:63] offset:29696
    v_mfma_f32_16x16x32_bf16 v[176:179], a[28:31], v[120:123], v[176:179]
    v_mfma_f32_16x16x32_bf16 v[196:199], a[28:31], v[124:127], v[196:199]
    buffer_load_dwordx4 a[28:31], v10, s[64:67], s79 offen offset:512 sc1
    s_waitcnt vmcnt(10)
    v_mfma_f32_16x16x32_bf16 v[140:143], a[32:35], v[112:115], v[140:143]
    ds_write_b128 v11, a[64:67] offset:30720
    v_mfma_f32_16x16x32_bf16 v[160:163], a[32:35], v[116:119], v[160:163]
    v_mfma_f32_16x16x32_bf16 v[180:183], a[32:35], v[120:123], v[180:183]
    v_mfma_f32_16x16x32_bf16 v[200:203], a[32:35], v[124:127], v[200:203]
    buffer_load_dwordx4 a[32:35], v10, s[64:67], s79 offen offset:768 sc1
    s_waitcnt vmcnt(10)
    v_mfma_f32_16x16x32_bf16 v[144:147], a[36:39], v[112:115], v[144:147]
    s_lshl_b32 s80, s5, 14
    s_mul_i32 s15, s90, 1280
    v_mfma_f32_16x16x32_bf16 v[164:167], a[36:39], v[116:119], v[164:167]
    s_add_u32 s80, s80, s15
    s_mul_i32 s15, s3, 640
    v_mfma_f32_16x16x32_bf16 v[184:187], a[36:39], v[120:123], v[184:187]
    s_add_u32 s80, s80, s15
    s_add_u32 s80, s80, 0x40000
    v_mfma_f32_16x16x32_bf16 v[204:207], a[36:39], v[124:127], v[204:207]
    s_lshl_b32 s14, s5, 12
    s_lshl_b32 s15, s8, 7
    s_add_u32 s14, s14, s15
    s_add_u32 s14, s14, 0x60000
    buffer_load_dwordx4 a[36:39], v10, s[64:67], s79 offen offset:1024 sc1
    s_waitcnt lgkmcnt(3)
    s_waitcnt vmcnt(10)
    v_mfma_f32_16x16x32_bf16 v[128:131], a[0:3], v[96:99], v[128:131]
    v_add_u32 v24, s80, v1
    v_and_b32 v25, 7, v0
    v_mfma_f32_16x16x32_bf16 v[148:151], a[0:3], v[100:103], v[148:151]
    v_lshlrev_b32 v25, 4, v25
    v_add_u32 v25, s14, v25
    v_mfma_f32_16x16x32_bf16 v[168:171], a[0:3], v[104:107], v[168:171]
    v_cmp_gt_u32 vcc, 40, v0
    v_lshrrev_b32 v20, 3, v0
    v_mfma_f32_16x16x32_bf16 v[188:191], a[0:3], v[108:111], v[188:191]
    v_lshlrev_b32 v20, 12, v20
    v_cndmask_b32 v24, v25, v24, vcc
    s_waitcnt vmcnt(9)
    v_mfma_f32_16x16x32_bf16 v[132:135], a[4:7], v[96:99], v[132:135]
    v_and_b32 v25, 7, v0
    v_lshl_add_u32 v25, v25, 4, v20
    v_mfma_f32_16x16x32_bf16 v[152:155], a[4:7], v[100:103], v[152:155]
    ds_write_b128 v11, a[68:71] offset:31744
    s_add_u32 s79, s79, 40960
    v_mfma_f32_16x16x32_bf16 v[172:175], a[4:7], v[104:107], v[172:175]
    buffer_load_dwordx4 a[0:3], v10, s[64:67], s79 offen sc1
    v_mfma_f32_16x16x32_bf16 v[192:195], a[4:7], v[108:111], v[192:195]
    buffer_load_dwordx4 a[4:7], v10, s[64:67], s79 offen offset:256 sc1
    s_waitcnt vmcnt(10)
    v_mfma_f32_16x16x32_bf16 v[136:139], a[8:11], v[96:99], v[136:139]
    ds_read_b64_tr_b16 v[112:113], v6 offset:4096
    ds_read_b64_tr_b16 v[114:115], v6 offset:4608
    v_mfma_f32_16x16x32_bf16 v[156:159], a[8:11], v[100:103], v[156:159]
    ds_read_b64_tr_b16 v[116:117], v7 offset:4096
    ds_read_b64_tr_b16 v[118:119], v7 offset:4608
    v_mfma_f32_16x16x32_bf16 v[176:179], a[8:11], v[104:107], v[176:179]
    ds_read_b64_tr_b16 v[120:121], v8 offset:4096
    ds_read_b64_tr_b16 v[122:123], v8 offset:4608
    v_mfma_f32_16x16x32_bf16 v[196:199], a[8:11], v[108:111], v[196:199]
    buffer_load_dwordx4 a[8:11], v10, s[64:67], s79 offen offset:512 sc1
    s_waitcnt vmcnt(10)
    v_mfma_f32_16x16x32_bf16 v[140:143], a[12:15], v[96:99], v[140:143]
    ds_read_b64_tr_b16 v[124:125], v9 offset:4096
    ds_read_b64_tr_b16 v[126:127], v9 offset:4608
    v_mfma_f32_16x16x32_bf16 v[160:163], a[12:15], v[100:103], v[160:163]
    ds_write_b128 v11, a[224:227] offset:0
    ds_write_b128 v11, a[228:231] offset:1024
    v_mfma_f32_16x16x32_bf16 v[180:183], a[12:15], v[104:107], v[180:183]
    ds_write_b128 v11, a[232:235] offset:2048
    v_mfma_f32_16x16x32_bf16 v[200:203], a[12:15], v[108:111], v[200:203]
    buffer_load_dwordx4 a[12:15], v10, s[64:67], s79 offen offset:768 sc1
    s_waitcnt vmcnt(10)
    v_mfma_f32_16x16x32_bf16 v[144:147], a[16:19], v[96:99], v[144:147]
    s_mul_i32 s99, s90, 80
    s_mul_i32 s15, s3, 40
    v_mfma_f32_16x16x32_bf16 v[164:167], a[16:19], v[100:103], v[164:167]
    s_add_u32 s99, s99, s15
    s_lshl_b32 s99, s99, 12
    v_mfma_f32_16x16x32_bf16 v[184:187], a[16:19], v[104:107], v[184:187]
    s_lshl_b32 s15, s8, 7
    s_add_u32 s99, s99, s15
    v_mfma_f32_16x16x32_bf16 v[204:207], a[16:19], v[108:111], v[204:207]
    s_add_u32 s99, s99, 0xa00000
    s_add_u32 s15, s15, 0x80000
    s_mov_b32 s80, 0
    buffer_load_dwordx4 a[16:19], v10, s[64:67], s79 offen offset:1024 sc1
    s_waitcnt lgkmcnt(3)
    s_waitcnt vmcnt(9)
    v_mfma_f32_16x16x32_bf16 v[128:131], a[20:23], v[112:115], v[128:131]
    ds_write_b128 v11, a[236:239] offset:3072
    s_add_u32 s79, s79, 40960
    v_mfma_f32_16x16x32_bf16 v[148:151], a[20:23], v[116:119], v[148:151]
    ds_read_b64_tr_b16 v[96:97], v6 offset:8192
    ds_read_b64_tr_b16 v[98:99], v6 offset:8704
    v_mfma_f32_16x16x32_bf16 v[168:171], a[20:23], v[120:123], v[168:171]
    ds_read_b64_tr_b16 v[100:101], v7 offset:8192
    v_mfma_f32_16x16x32_bf16 v[188:191], a[20:23], v[124:127], v[188:191]
    buffer_load_dwordx4 a[20:23], v10, s[64:67], s79 offen sc1
    s_waitcnt vmcnt(9)
    v_mfma_f32_16x16x32_bf16 v[132:135], a[24:27], v[112:115], v[132:135]
    ds_read_b64_tr_b16 v[102:103], v7 offset:8704
    ds_read_b64_tr_b16 v[104:105], v8 offset:8192
    v_mfma_f32_16x16x32_bf16 v[152:155], a[24:27], v[116:119], v[152:155]
    ds_read_b64_tr_b16 v[106:107], v8 offset:8704
    v_mfma_f32_16x16x32_bf16 v[172:175], a[24:27], v[120:123], v[172:175]
    v_mfma_f32_16x16x32_bf16 v[192:195], a[24:27], v[124:127], v[192:195]
    buffer_load_dwordx4 a[24:27], v10, s[64:67], s79 offen offset:256 sc1
    s_waitcnt vmcnt(9)
    v_mfma_f32_16x16x32_bf16 v[136:139], a[28:31], v[112:115], v[136:139]
    ds_read_b64_tr_b16 v[108:109], v9 offset:8192
    ds_read_b64_tr_b16 v[110:111], v9 offset:8704
    v_mfma_f32_16x16x32_bf16 v[156:159], a[28:31], v[116:119], v[156:159]
    v_mfma_f32_16x16x32_bf16 v[176:179], a[28:31], v[120:123], v[176:179]
    v_mfma_f32_16x16x32_bf16 v[196:199], a[28:31], v[124:127], v[196:199]
    buffer_load_dwordx4 a[28:31], v10, s[64:67], s79 offen offset:512 sc1
    s_waitcnt vmcnt(9)
    v_mfma_f32_16x16x32_bf16 v[140:143], a[32:35], v[112:115], v[140:143]
    v_mfma_f32_16x16x32_bf16 v[160:163], a[32:35], v[116:119], v[160:163]
    v_mfma_f32_16x16x32_bf16 v[180:183], a[32:35], v[120:123], v[180:183]
    v_mfma_f32_16x16x32_bf16 v[200:203], a[32:35], v[124:127], v[200:203]
    buffer_load_dwordx4 a[32:35], v10, s[64:67], s79 offen offset:768 sc1
    s_waitcnt vmcnt(9)
    v_mfma_f32_16x16x32_bf16 v[144:147], a[36:39], v[112:115], v[144:147]
    s_movk_i32 s85, 6554
    v_add_u32 v21, 0, v0
    v_mfma_f32_16x16x32_bf16 v[164:167], a[36:39], v[116:119], v[164:167]
    v_mul_lo_u32 v22, v21, s85
    v_lshrrev_b32 v22, 16, v22
    v_mfma_f32_16x16x32_bf16 v[184:187], a[36:39], v[120:123], v[184:187]
    v_mul_u32_u24 v23, 10, v22
    v_sub_u32 v21, v21, v23
    v_mfma_f32_16x16x32_bf16 v[204:207], a[36:39], v[124:127], v[204:207]
    buffer_load_dwordx4 a[36:39], v10, s[64:67], s79 offen offset:1024 sc1
    s_waitcnt lgkmcnt(0)
    s_waitcnt vmcnt(9)
    v_mfma_f32_16x16x32_bf16 v[128:131], a[0:3], v[96:99], v[128:131]
    v_mul_u32_u24 v22, 1280, v22
    v_lshl_add_u32 v61, v21, 4, v22
    v_mfma_f32_16x16x32_bf16 v[148:151], a[0:3], v[100:103], v[148:151]
    v_add_u32 v21, 64, v0
    v_mul_lo_u32 v22, v21, s85
    v_mfma_f32_16x16x32_bf16 v[168:171], a[0:3], v[104:107], v[168:171]
    v_lshrrev_b32 v22, 16, v22
    v_mul_u32_u24 v23, 10, v22
    v_mfma_f32_16x16x32_bf16 v[188:191], a[0:3], v[108:111], v[188:191]
    v_sub_u32 v21, v21, v23
    v_mul_u32_u24 v22, 1280, v22
    s_waitcnt vmcnt(8)
    v_mfma_f32_16x16x32_bf16 v[132:135], a[4:7], v[96:99], v[132:135]
    v_lshl_add_u32 v62, v21, 4, v22
    v_add_u32 v21, 128, v0
    v_mfma_f32_16x16x32_bf16 v[152:155], a[4:7], v[100:103], v[152:155]
    v_mul_lo_u32 v22, v21, s85
    v_lshrrev_b32 v22, 16, v22
    v_mfma_f32_16x16x32_bf16 v[172:175], a[4:7], v[104:107], v[172:175]
    v_mul_u32_u24 v23, 10, v22
    v_sub_u32 v21, v21, v23
    v_mfma_f32_16x16x32_bf16 v[192:195], a[4:7], v[108:111], v[192:195]
    v_mul_u32_u24 v22, 1280, v22
    v_lshl_add_u32 v63, v21, 4, v22
    s_waitcnt vmcnt(7)
    v_mfma_f32_16x16x32_bf16 v[136:139], a[8:11], v[96:99], v[136:139]
    s_add_u32 s79, s79, 40960
    v_mfma_f32_16x16x32_bf16 v[156:159], a[8:11], v[100:103], v[156:159]
    buffer_load_dwordx4 a[4:7], v10, s[64:67], s79 offen offset:256 sc1
    v_mfma_f32_16x16x32_bf16 v[176:179], a[8:11], v[104:107], v[176:179]
    buffer_load_dwordx4 a[0:3], v10, s[64:67], s79 offen sc1
    v_mfma_f32_16x16x32_bf16 v[196:199], a[8:11], v[108:111], v[196:199]
    buffer_load_dwordx4 a[8:11], v10, s[64:67], s79 offen offset:512 sc1
    s_waitcnt vmcnt(9)
    v_mfma_f32_16x16x32_bf16 v[140:143], a[12:15], v[96:99], v[140:143]
    ds_read_b64_tr_b16 v[112:113], v6 offset:12288
    ds_read_b64_tr_b16 v[114:115], v6 offset:12800
    v_mfma_f32_16x16x32_bf16 v[160:163], a[12:15], v[100:103], v[160:163]
    ds_read_b64_tr_b16 v[116:117], v7 offset:12288
    ds_read_b64_tr_b16 v[118:119], v7 offset:12800
    v_mfma_f32_16x16x32_bf16 v[180:183], a[12:15], v[104:107], v[180:183]
    ds_read_b64_tr_b16 v[120:121], v8 offset:12288
    ds_read_b64_tr_b16 v[122:123], v8 offset:12800
    v_mfma_f32_16x16x32_bf16 v[200:203], a[12:15], v[108:111], v[200:203]
    buffer_load_dwordx4 a[12:15], v10, s[64:67], s79 offen offset:768 sc1
    s_waitcnt vmcnt(9)
    v_mfma_f32_16x16x32_bf16 v[144:147], a[16:19], v[96:99], v[144:147]
    ds_read_b64_tr_b16 v[124:125], v9 offset:12288
    ds_read_b64_tr_b16 v[126:127], v9 offset:12800
    v_mfma_f32_16x16x32_bf16 v[164:167], a[16:19], v[100:103], v[164:167]
    s_lshl_b32 s14, s3, 5
    s_add_u32 s14, s14, 131072
    v_mfma_f32_16x16x32_bf16 v[184:187], a[16:19], v[104:107], v[184:187]
    v_lshrrev_b32 v16, 2, v0
    v_and_b32 v17, 3, v0
    v_mfma_f32_16x16x32_bf16 v[204:207], a[16:19], v[108:111], v[204:207]
    buffer_load_dwordx4 a[16:19], v10, s[64:67], s79 offen offset:1024 sc1
    s_waitcnt lgkmcnt(0)
    s_waitcnt vmcnt(9)
    v_mfma_f32_16x16x32_bf16 v[128:131], a[20:23], v[112:115], v[128:131]
    v_lshlrev_b32 v17, 3, v17
    v_add_u32 v17, s14, v17
    v_mfma_f32_16x16x32_bf16 v[148:151], a[20:23], v[116:119], v[148:151]
    v_add_u32 v22, 0, v16
    v_cmp_le_u32 vcc, 40, v22
    v_mfma_f32_16x16x32_bf16 v[168:171], a[20:23], v[120:123], v[168:171]
    v_lshl_add_u32 v22, v22, 7, v17
    v_add_u32 v23, 3616, v22
    v_mfma_f32_16x16x32_bf16 v[188:191], a[20:23], v[124:127], v[188:191]
    v_cndmask_b32 v56, v22, v23, vcc
    v_add_u32 v22, 16, v16
    s_waitcnt vmcnt(8)
    v_mfma_f32_16x16x32_bf16 v[132:135], a[24:27], v[112:115], v[132:135]
    v_cmp_le_u32 vcc, 40, v22
    v_lshl_add_u32 v22, v22, 7, v17
    v_mfma_f32_16x16x32_bf16 v[152:155], a[24:27], v[116:119], v[152:155]
    v_add_u32 v23, 3616, v22
    v_cndmask_b32 v57, v22, v23, vcc
    v_mfma_f32_16x16x32_bf16 v[172:175], a[24:27], v[120:123], v[172:175]
    v_add_u32 v22, 32, v16
    v_cmp_le_u32 vcc, 40, v22
    v_mfma_f32_16x16x32_bf16 v[192:195], a[24:27], v[124:127], v[192:195]
    v_lshl_add_u32 v22, v22, 7, v17
    v_add_u32 v23, 3616, v22
    s_waitcnt vmcnt(7)
    v_mfma_f32_16x16x32_bf16 v[136:139], a[28:31], v[112:115], v[136:139]
    v_cndmask_b32 v58, v22, v23, vcc
    v_add_u32 v22, 48, v16
    v_mfma_f32_16x16x32_bf16 v[156:159], a[28:31], v[116:119], v[156:159]
    v_cmp_le_u32 vcc, 40, v22
    v_lshl_add_u32 v22, v22, 7, v17
    v_mfma_f32_16x16x32_bf16 v[176:179], a[28:31], v[120:123], v[176:179]
    v_add_u32 v23, 3616, v22
    v_cndmask_b32 v59, v22, v23, vcc
    v_mfma_f32_16x16x32_bf16 v[196:199], a[28:31], v[124:127], v[196:199]
    v_add_u32 v22, 64, v16
    v_cmp_le_u32 vcc, 40, v22
    s_waitcnt vmcnt(6)
    v_mfma_f32_16x16x32_bf16 v[140:143], a[32:35], v[112:115], v[140:143]
    v_lshl_add_u32 v22, v22, 7, v17
    v_add_u32 v23, 3616, v22
    v_mfma_f32_16x16x32_bf16 v[160:163], a[32:35], v[116:119], v[160:163]
    v_cndmask_b32 v60, v22, v23, vcc
    v_and_b32 v16, 15, v0
    v_mfma_f32_16x16x32_bf16 v[180:183], a[32:35], v[120:123], v[180:183]
    v_mul_u32_u24 v16, 160, v16
    v_lshrrev_b32 v17, 4, v0
    v_mfma_f32_16x16x32_bf16 v[200:203], a[32:35], v[124:127], v[200:203]
    v_lshl_add_u32 v16, v17, 3, v16
    v_add_u32 v16, s72, v16
    s_waitcnt vmcnt(5)
    v_mfma_f32_16x16x32_bf16 v[144:147], a[36:39], v[112:115], v[144:147]
    v_and_b32 v27, 127, v30
    v_add_u32 v27, 157408, v27
    v_mfma_f32_16x16x32_bf16 v[164:167], a[36:39], v[116:119], v[164:167]
    s_add_u32 s79, s79, 40960
    v_mfma_f32_16x16x32_bf16 v[184:187], a[36:39], v[120:123], v[184:187]
    buffer_load_dwordx4 a[32:35], v10, s[64:67], s79 offen offset:768 sc1
    v_mfma_f32_16x16x32_bf16 v[204:207], a[36:39], v[124:127], v[204:207]
    buffer_load_dwordx4 a[36:39], v10, s[64:67], s79 offen offset:1024 sc1
    buffer_load_dwordx4 a[28:31], v10, s[64:67], s79 offen offset:512 sc1
    buffer_load_dwordx4 a[24:27], v10, s[64:67], s79 offen offset:256 sc1
    buffer_load_dwordx4 a[20:23], v10, s[64:67], s79 offen sc1
    ds_read_b64_tr_b16 v[96:97], v6 offset:16384
    ds_read_b64_tr_b16 v[98:99], v6 offset:16896
    ds_read_b64_tr_b16 v[100:101], v7 offset:16384
    ds_read_b64_tr_b16 v[102:103], v7 offset:16896
    ds_read_b64_tr_b16 v[104:105], v8 offset:16384
    ds_read_b64_tr_b16 v[106:107], v8 offset:16896
    ds_read_b64_tr_b16 v[108:109], v9 offset:16384
    ds_read_b64_tr_b16 v[110:111], v9 offset:16896
    s_waitcnt lgkmcnt(0)
    s_waitcnt vmcnt(8)
    v_mfma_f32_16x16x32_bf16 v[128:131], a[0:3], v[96:99], v[128:131]
    s_add_u32 s79, s79, 40960
    ds_read_b64_tr_b16 v[112:113], v6 offset:20480
    v_mfma_f32_16x16x32_bf16 v[148:151], a[0:3], v[100:103], v[148:151]
    ds_read_b64_tr_b16 v[114:115], v6 offset:20992
    ds_read_b64_tr_b16 v[116:117], v7 offset:20480
    v_mfma_f32_16x16x32_bf16 v[168:171], a[0:3], v[104:107], v[168:171]
    v_mfma_f32_16x16x32_bf16 v[188:191], a[0:3], v[108:111], v[188:191]
    buffer_load_dwordx4 a[0:3], v10, s[64:67], s79 offen sc1
    s_cmp_ge_u32 s3, 2
    s_cbranch_scc1 L_nop3
    buffer_load_dword v26, v24, s[60:63], s80 offen sc1
L_nop3:
    v_mfma_f32_16x16x32_bf16 v[132:135], a[4:7], v[96:99], v[132:135]
    ds_read_b64_tr_b16 v[118:119], v7 offset:20992
    ds_read_b64_tr_b16 v[120:121], v8 offset:20480
    v_mfma_f32_16x16x32_bf16 v[152:155], a[4:7], v[100:103], v[152:155]
    ds_read_b64_tr_b16 v[122:123], v8 offset:20992
    v_mfma_f32_16x16x32_bf16 v[172:175], a[4:7], v[104:107], v[172:175]
    v_mfma_f32_16x16x32_bf16 v[192:195], a[4:7], v[108:111], v[192:195]
    buffer_load_dwordx4 a[4:7], v10, s[64:67], s79 offen offset:256 sc1
    s_waitcnt vmcnt(9)
    v_mfma_f32_16x16x32_bf16 v[136:139], a[8:11], v[96:99], v[136:139]
    ds_read_b64_tr_b16 v[124:125], v9 offset:20480
    ds_read_b64_tr_b16 v[126:127], v9 offset:20992
    v_mfma_f32_16x16x32_bf16 v[156:159], a[8:11], v[100:103], v[156:159]
    v_mfma_f32_16x16x32_bf16 v[176:179], a[8:11], v[104:107], v[176:179]
    v_mfma_f32_16x16x32_bf16 v[196:199], a[8:11], v[108:111], v[196:199]
    buffer_load_dwordx4 a[8:11], v10, s[64:67], s79 offen offset:512 sc1
    s_waitcnt vmcnt(9)
    v_mfma_f32_16x16x32_bf16 v[140:143], a[12:15], v[96:99], v[140:143]
    v_mfma_f32_16x16x32_bf16 v[160:163], a[12:15], v[100:103], v[160:163]
    v_mfma_f32_16x16x32_bf16 v[180:183], a[12:15], v[104:107], v[180:183]
    v_mfma_f32_16x16x32_bf16 v[200:203], a[12:15], v[108:111], v[200:203]
    buffer_load_dwordx4 a[12:15], v10, s[64:67], s79 offen offset:768 sc1
    s_waitcnt vmcnt(9)
    v_mfma_f32_16x16x32_bf16 v[144:147], a[16:19], v[96:99], v[144:147]
    v_mfma_f32_16x16x32_bf16 v[164:167], a[16:19], v[100:103], v[164:167]
    v_mfma_f32_16x16x32_bf16 v[184:187], a[16:19], v[104:107], v[184:187]
    v_mfma_f32_16x16x32_bf16 v[204:207], a[16:19], v[108:111], v[204:207]
    buffer_load_dwordx4 a[16:19], v10, s[64:67], s79 offen offset:1024 sc1
    s_waitcnt lgkmcnt(0)
    s_waitcnt vmcnt(5)
    v_mfma_f32_16x16x32_bf16 v[128:131], a[20:23], v[112:115], v[128:131]
    s_add_u32 s79, s79, 40960
    ds_read_b64_tr_b16 v[96:97], v6 offset:24576
    v_mfma_f32_16x16x32_bf16 v[148:151], a[20:23], v[116:119], v[148:151]
    ds_read_b64_tr_b16 v[98:99], v6 offset:25088
    ds_read_b64_tr_b16 v[100:101], v7 offset:24576
    v_mfma_f32_16x16x32_bf16 v[168:171], a[20:23], v[120:123], v[168:171]
    v_mfma_f32_16x16x32_bf16 v[188:191], a[20:23], v[124:127], v[188:191]
    buffer_load_dwordx4 a[20:23], v10, s[64:67], s79 offen sc1
    v_mfma_f32_16x16x32_bf16 v[132:135], a[24:27], v[112:115], v[132:135]
    ds_read_b64_tr_b16 v[102:103], v7 offset:25088
    ds_read_b64_tr_b16 v[104:105], v8 offset:24576
    v_mfma_f32_16x16x32_bf16 v[152:155], a[24:27], v[116:119], v[152:155]
    ds_read_b64_tr_b16 v[106:107], v8 offset:25088
    v_mfma_f32_16x16x32_bf16 v[172:175], a[24:27], v[120:123], v[172:175]
    v_mfma_f32_16x16x32_bf16 v[192:195], a[24:27], v[124:127], v[192:195]
    buffer_load_dwordx4 a[24:27], v10, s[64:67], s79 offen offset:256 sc1
    v_mfma_f32_16x16x32_bf16 v[136:139], a[28:31], v[112:115], v[136:139]
    ds_read_b64_tr_b16 v[108:109], v9 offset:24576
    ds_read_b64_tr_b16 v[110:111], v9 offset:25088
    v_mfma_f32_16x16x32_bf16 v[156:159], a[28:31], v[116:119], v[156:159]
    v_mfma_f32_16x16x32_bf16 v[176:179], a[28:31], v[120:123], v[176:179]
    v_mfma_f32_16x16x32_bf16 v[196:199], a[28:31], v[124:127], v[196:199]
    buffer_load_dwordx4 a[28:31], v10, s[64:67], s79 offen offset:512 sc1
    v_mfma_f32_16x16x32_bf16 v[140:143], a[32:35], v[112:115], v[140:143]
    v_mfma_f32_16x16x32_bf16 v[160:163], a[32:35], v[116:119], v[160:163]
    v_mfma_f32_16x16x32_bf16 v[180:183], a[32:35], v[120:123], v[180:183]
    v_mfma_f32_16x16x32_bf16 v[200:203], a[32:35], v[124:127], v[200:203]
    buffer_load_dwordx4 a[32:35], v10, s[64:67], s79 offen offset:768 sc1
    v_mfma_f32_16x16x32_bf16 v[144:147], a[36:39], v[112:115], v[144:147]
    v_mfma_f32_16x16x32_bf16 v[164:167], a[36:39], v[116:119], v[164:167]
    v_mfma_f32_16x16x32_bf16 v[184:187], a[36:39], v[120:123], v[184:187]
    v_mfma_f32_16x16x32_bf16 v[204:207], a[36:39], v[124:127], v[204:207]
    buffer_load_dwordx4 a[36:39], v10, s[64:67], s79 offen offset:1024 sc1
    s_waitcnt lgkmcnt(0)
    s_waitcnt vmcnt(9)
    v_mfma_f32_16x16x32_bf16 v[128:131], a[0:3], v[96:99], v[128:131]
    s_add_u32 s79, s79, 40960
    ds_read_b64_tr_b16 v[112:113], v6 offset:28672
    v_mfma_f32_16x16x32_bf16 v[148:151], a[0:3], v[100:103], v[148:151]
    ds_read_b64_tr_b16 v[114:115], v6 offset:29184
    ds_read_b64_tr_b16 v[116:117], v7 offset:28672
    v_mfma_f32_16x16x32_bf16 v[168:171], a[0:3], v[104:107], v[168:171]
    v_mfma_f32_16x16x32_bf16 v[188:191], a[0:3], v[108:111], v[188:191]
    buffer_load_dwordx4 a[0:3], v10, s[64:67], s79 offen sc1
    s_waitcnt vmcnt(9)
    v_mfma_f32_16x16x32_bf16 v[132:135], a[4:7], v[96:99], v[132:135]
    ds_read_b64_tr_b16 v[118:119], v7 offset:29184
    ds_read_b64_tr_b16 v[120:121], v8 offset:28672
    v_mfma_f32_16x16x32_bf16 v[152:155], a[4:7], v[100:103], v[152:155]
    ds_read_b64_tr_b16 v[122:123], v8 offset:29184
    v_mfma_f32_16x16x32_bf16 v[172:175], a[4:7], v[104:107], v[172:175]
    v_mfma_f32_16x16x32_bf16 v[192:195], a[4:7], v[108:111], v[192:195]
    buffer_load_dwordx4 a[4:7], v10, s[64:67], s79 offen offset:256 sc1
    s_waitcnt vmcnt(9)
    v_mfma_f32_16x16x32_bf16 v[136:139], a[8:11], v[96:99], v[136:139]
    ds_read_b64_tr_b16 v[124:125], v9 offset:28672
    ds_read_b64_tr_b16 v[126:127], v9 offset:29184
    v_mfma_f32_16x16x32_bf16 v[156:159], a[8:11], v[100:103], v[156:159]
    v_mfma_f32_16x16x32_bf16 v[176:179], a[8:11], v[104:107], v[176:179]
    v_mfma_f32_16x16x32_bf16 v[196:199], a[8:11], v[108:111], v[196:199]
    buffer_load_dwordx4 a[8:11], v10, s[64:67], s79 offen offset:512 sc1
    s_waitcnt vmcnt(9)
    v_mfma_f32_16x16x32_bf16 v[140:143], a[12:15], v[96:99], v[140:143]
    v_mfma_f32_16x16x32_bf16 v[160:163], a[12:15], v[100:103], v[160:163]
    v_mfma_f32_16x16x32_bf16 v[180:183], a[12:15], v[104:107], v[180:183]
    v_mfma_f32_16x16x32_bf16 v[200:203], a[12:15], v[108:111], v[200:203]
    buffer_load_dwordx4 a[12:15], v10, s[64:67], s79 offen offset:768 sc1
    s_waitcnt vmcnt(9)
    v_mfma_f32_16x16x32_bf16 v[144:147], a[16:19], v[96:99], v[144:147]
    v_mfma_f32_16x16x32_bf16 v[164:167], a[16:19], v[100:103], v[164:167]
    v_mfma_f32_16x16x32_bf16 v[184:187], a[16:19], v[104:107], v[184:187]
    v_mfma_f32_16x16x32_bf16 v[204:207], a[16:19], v[108:111], v[204:207]
    buffer_load_dwordx4 a[16:19], v10, s[64:67], s79 offen offset:1024 sc1
    s_cmp_ge_u32 s3, 2
    s_cbranch_scc1 L_nop4
    v_cmp_ne_u32 vcc, s4, v26
    s_cbranch_vccz L_f3ok
    s_mov_b32 s84, 0
Lpoll_9:
    buffer_load_dword v26, v24, s[60:63], s80 offen sc1
    s_waitcnt vmcnt(0)
    v_xor_b32 v26, s4, v26
    v_cmp_ne_u32 vcc, 0, v26
    s_cbranch_vccz Lpolled_10
    s_sleep 4
    s_add_u32 s84, s84, 1
    s_cmp_lt_u32 s84, 0x4000
    s_cbranch_scc1 Lpoll_9
Lpolled_10:
L_f3ok:
    buffer_load_dwordx4 v[32:35], v25, s[60:63], s99 offen sc1
    s_add_u32 s99, s99, 0x8000
    buffer_load_dwordx4 v[36:39], v25, s[60:63], s99 offen sc1
    s_add_u32 s99, s99, 0x8000
    buffer_load_dwordx4 v[40:43], v25, s[60:63], s99 offen sc1
    s_add_u32 s99, s99, 0x8000
    buffer_load_dwordx4 v[44:47], v25, s[60:63], s99 offen sc1
    s_add_u32 s99, s99, 0x8000
    buffer_load_dwordx4 v[48:51], v25, s[60:63], s99 offen sc1
    s_mov_b64 exec, 0xff
    buffer_load_dwordx4 v[52:55], v1, s[60:63], s15 offen sc1
    s_mov_b64 exec, -1
L_nop4:
    s_waitcnt lgkmcnt(0)
    s_waitcnt vmcnt(9)
    v_mfma_f32_16x16x32_bf16 v[128:131], a[20:23], v[112:115], v[128:131]
    ds_read_b64_tr_b16 v[96:97], v6 offset:0
    ds_read_b64_tr_b16 v[98:99], v6 offset:512
    v_mfma_f32_16x16x32_bf16 v[148:151], a[20:23], v[116:119], v[148:151]
    ds_read_b64_tr_b16 v[100:101], v7 offset:0
    v_mfma_f32_16x16x32_bf16 v[168:171], a[20:23], v[120:123], v[168:171]
    v_mfma_f32_16x16x32_bf16 v[188:191], a[20:23], v[124:127], v[188:191]
    s_waitcnt vmcnt(8)
    v_mfma_f32_16x16x32_bf16 v[132:135], a[24:27], v[112:115], v[132:135]
    ds_read_b64_tr_b16 v[102:103], v7 offset:512
    ds_read_b64_tr_b16 v[104:105], v8 offset:0
    v_mfma_f32_16x16x32_bf16 v[152:155], a[24:27], v[116:119], v[152:155]
    ds_read_b64_tr_b16 v[106:107], v8 offset:512
    v_mfma_f32_16x16x32_bf16 v[172:175], a[24:27], v[120:123], v[172:175]
    v_mfma_f32_16x16x32_bf16 v[192:195], a[24:27], v[124:127], v[192:195]
    s_waitcnt vmcnt(7)
    v_mfma_f32_16x16x32_bf16 v[136:139], a[28:31], v[112:115], v[136:139]
    ds_read_b64_tr_b16 v[108:109], v9 offset:0
    ds_read_b64_tr_b16 v[110:111], v9 offset:512
    v_mfma_f32_16x16x32_bf16 v[156:159], a[28:31], v[116:119], v[156:159]
    v_mfma_f32_16x16x32_bf16 v[176:179], a[28:31], v[120:123], v[176:179]
    v_mfma_f32_16x16x32_bf16 v[196:199], a[28:31], v[124:127], v[196:199]
    s_waitcnt vmcnt(6)
    v_mfma_f32_16x16x32_bf16 v[140:143], a[32:35], v[112:115], v[140:143]
    v_mfma_f32_16x16x32_bf16 v[160:163], a[32:35], v[116:119], v[160:163]
    v_mfma_f32_16x16x32_bf16 v[180:183], a[32:35], v[120:123], v[180:183]
    v_mfma_f32_16x16x32_bf16 v[200:203], a[32:35], v[124:127], v[200:203]
    s_waitcnt vmcnt(5)
    v_mfma_f32_16x16x32_bf16 v[144:147], a[36:39], v[112:115], v[144:147]
    v_mfma_f32_16x16x32_bf16 v[164:167], a[36:39], v[116:119], v[164:167]
    v_mfma_f32_16x16x32_bf16 v[184:187], a[36:39], v[120:123], v[184:187]
    v_mfma_f32_16x16x32_bf16 v[204:207], a[36:39], v[124:127], v[204:207]
    s_waitcnt lgkmcnt(0)
    s_waitcnt vmcnt(4)
    v_mfma_f32_16x16x32_bf16 v[148:151], a[0:3], v[100:103], v[148:151]
    s_waitcnt vmcnt(3)
    v_mfma_f32_16x16x32_bf16 v[152:155], a[4:7], v[100:103], v[152:155]
    s_waitcnt vmcnt(2)
    v_mfma_f32_16x16x32_bf16 v[156:159], a[8:11], v[100:103], v[156:159]
    s_waitcnt vmcnt(1)
    v_mfma_f32_16x16x32_bf16 v[160:163], a[12:15], v[100:103], v[160:163]
    s_waitcnt vmcnt(0)
    v_mfma_f32_16x16x32_bf16 v[164:167], a[16:19], v[100:103], v[164:167]
    v_mfma_f32_16x16x32_bf16 v[168:171], a[0:3], v[104:107], v[168:171]
    ds_write_b128 v11, v[148:151] offset:0
    v_mfma_f32_16x16x32_bf16 v[172:175], a[4:7], v[104:107], v[172:175]
    ds_write_b128 v11, v[152:155] offset:1024
    v_mfma_f32_16x16x32_bf16 v[176:179], a[8:11], v[104:107], v[176:179]
    ds_write_b128 v11, v[156:159] offset:2048
    v_mfma_f32_16x16x32_bf16 v[180:183], a[12:15], v[104:107], v[180:183]
    ds_write_b128 v11, v[160:163] offset:3072
    v_mfma_f32_16x16x32_bf16 v[184:187], a[16:19], v[104:107], v[184:187]
    ds_write_b128 v11, v[164:167] offset:4096
    v_mfma_f32_16x16x32_bf16 v[188:191], a[0:3], v[108:111], v[188:191]
    ds_write_b128 v11, v[168:171] offset:5120
    v_mfma_f32_16x16x32_bf16 v[192:195], a[4:7], v[108:111], v[192:195]
    ds_write_b128 v11, v[172:175] offset:6144
    v_mfma_f32_16x16x32_bf16 v[196:199], a[8:11], v[108:111], v[196:199]
    ds_write_b128 v11, v[176:179] offset:7168
    v_mfma_f32_16x16x32_bf16 v[200:203], a[12:15], v[108:111], v[200:203]
    ds_write_b128 v11, v[180:183] offset:8192
    v_mfma_f32_16x16x32_bf16 v[204:207], a[16:19], v[108:111], v[204:207]
    ds_write_b128 v11, v[184:187] offset:9216
    v_mfma_f32_16x16x32_bf16 v[128:131], a[0:3], v[96:99], v[128:131]
    ds_write_b128 v11, v[188:191] offset:10240
    v_mfma_f32_16x16x32_bf16 v[132:135], a[4:7], v[96:99], v[132:135]
    v_mfma_f32_16x16x32_bf16 v[136:139], a[8:11], v[96:99], v[136:139]
    v_mfma_f32_16x16x32_bf16 v[140:143], a[12:15], v[96:99], v[140:143]
    v_mfma_f32_16x16x32_bf16 v[144:147], a[16:19], v[96:99], v[144:147]
    s_cmp_ge_u32 s3, 2
    s_cbranch_scc1 L_nop5
    v_add_u32 v20, s73, v1
    v_add_u32 v21, 157408, v1
    s_waitcnt vmcnt(0)
    ds_write_b128 v20, v[32:35] offset:0
    ds_write_b128 v20, v[36:39] offset:1024
    ds_write_b128 v20, v[40:43] offset:2048
    ds_write_b128 v20, v[44:47] offset:3072
    ds_write_b128 v20, v[48:51] offset:4096
    s_mov_b64 exec, 0xff
    ds_write_b128 v21, v[52:55]
    s_mov_b64 exec, -1
L_nop5:
    ds_write_b128 v11, v[192:195] offset:11264
    ds_write_b128 v11, v[196:199] offset:12288
    ds_write_b128 v11, v[200:203] offset:13312
    ds_write_b128 v11, v[204:207] offset:14336
    s_branch L_loop2e
L_loop2b:
    ds_read_b64_tr_b16 v[96:97], v6 offset:16384
    ds_read_b64_tr_b16 v[98:99], v6 offset:16896
    ds_read_b64_tr_b16 v[100:101], v7 offset:16384
    ds_read_b64_tr_b16 v[102:103], v7 offset:16896
    ds_read_b64_tr_b16 v[104:105], v8 offset:16384
    ds_read_b64_tr_b16 v[106:107], v8 offset:16896
    ds_read_b64_tr_b16 v[108:109], v9 offset:16384
    ds_read_b64_tr_b16 v[110:111], v9 offset:16896
    s_waitcnt lgkmcnt(0)
    s_waitcnt vmcnt(9)
    v_mfma_f32_16x16x32_bf16 v[128:131], a[0:3], v[96:99], 0
    s_add_u32 s79, s79, 40960
    ds_read_b64_tr_b16 v[112:113], v6 offset:20480
    v_mfma_f32_16x16x32_bf16 v[148:151], a[0:3], v[100:103], 0
    ds_read_b64_tr_b16 v[114:115], v6 offset:20992
    ds_read_b64_tr_b16 v[116:117], v7 offset:20480
    v_mfma_f32_16x16x32_bf16 v[168:171], a[0:3], v[104:107], 0
    v_mfma_f32_16x16x32_bf16 v[188:191], a[0:3], v[108:111], 0
    buffer_load_dwordx4 a[0:3], v10, s[64:67], s79 offen sc1
    s_waitcnt vmcnt(9)
    v_mfma_f32_16x16x32_bf16 v[132:135], a[4:7], v[96:99], 0
    ds_read_b64_tr_b16 v[118:119], v7 offset:20992
    ds_read_b64_tr_b16 v[120:121], v8 offset:20480
    v_mfma_f32_16x16x32_bf16 v[152:155], a[4:7], v[100:103], 0
    ds_read_b64_tr_b16 v[122:123], v8 offset:20992
    v_mfma_f32_16x16x32_bf16 v[172:175], a[4:7], v[104:107], 0
    v_mfma_f32_16x16x32_bf16 v[192:195], a[4:7], v[108:111], 0
    buffer_load_dwordx4 a[4:7], v10, s[64:67], s79 offen offset:256 sc1
    s_waitcnt vmcnt(9)
    v_mfma_f32_16x16x32_bf16 v[136:139], a[8:11], v[96:99], 0
    ds_read_b64_tr_b16 v[124:125], v9 offset:20480
    ds_read_b64_tr_b16 v[126:127], v9 offset:20992
    v_mfma_f32_16x16x32_bf16 v[156:159], a[8:11], v[100:103], 0
    ds_write_b128 v11, a[80:83] offset:16384
    ds_write_b128 v11, a[84:87] offset:17408
    v_mfma_f32_16x16x32_bf16 v[176:179], a[8:11], v[104:107], 0
    v_mfma_f32_16x16x32_bf16 v[196:199], a[8:11], v[108:111], 0
    buffer_load_dwordx4 a[8:11], v10, s[64:67], s79 offen offset:512 sc1
    s_waitcnt vmcnt(9)
    v_mfma_f32_16x16x32_bf16 v[140:143], a[12:15], v[96:99], 0
    ds_write_b128 v11, a[88:91] offset:18432
    v_mfma_f32_16x16x32_bf16 v[160:163], a[12:15], v[100:103], 0
    v_mfma_f32_16x16x32_bf16 v[180:183], a[12:15], v[104:107], 0
    v_mfma_f32_16x16x32_bf16 v[200:203], a[12:15], v[108:111], 0
    buffer_load_dwordx4 a[12:15], v10, s[64:67], s79 offen offset:768 sc1
    s_waitcnt vmcnt(9)
    v_mfma_f32_16x16x32_bf16 v[144:147], a[16:19], v[96:99], 0
    ds_write_b128 v11, a[92:95] offset:19456
    v_mfma_f32_16x16x32_bf16 v[164:167], a[16:19], v[100:103], 0
    v_mfma_f32_16x16x32_bf16 v[184:187], a[16:19], v[104:107], 0
    v_mfma_f32_16x16x32_bf16 v[204:207], a[16:19], v[108:111], 0
    buffer_load_dwordx4 a[16:19], v10, s[64:67], s79 offen offset:1024 sc1
    s_waitcnt lgkmcnt(4)
    s_waitcnt vmcnt(9)
    v_mfma_f32_16x16x32_bf16 v[128:131], a[20:23], v[112:115], v[128:131]
    s_add_u32 s79, s79, 40960
    ds_read_b64_tr_b16 v[96:97], v6 offset:24576
    v_mfma_f32_16x16x32_bf16 v[148:151], a[20:23], v[116:119], v[148:151]
    ds_read_b64_tr_b16 v[98:99], v6 offset:25088
    ds_read_b64_tr_b16 v[100:101], v7 offset:24576
    v_mfma_f32_16x16x32_bf16 v[168:171], a[20:23], v[120:123], v[168:171]
    v_mfma_f32_16x16x32_bf16 v[188:191], a[20:23], v[124:127], v[188:191]
    buffer_load_dwordx4 a[20:23], v10, s[64:67], s79 offen sc1
    s_waitcnt vmcnt(9)
    v_mfma_f32_16x16x32_bf16 v[132:135], a[24:27], v[112:115], v[132:135]
    ds_read_b64_tr_b16 v[102:103], v7 offset:25088
    ds_read_b64_tr_b16 v[104:105], v8 offset:24576
    v_mfma_f32_16x16x32_bf16 v[152:155], a[24:27], v[116:119], v[152:155]
    ds_read_b64_tr_b16 v[106:107], v8 offset:25088
    v_mfma_f32_16x16x32_bf16 v[172:175], a[24:27], v[120:123], v[172:175]
    v_mfma_f32_16x16x32_bf16 v[192:195], a[24:27], v[124:127], v[192:195]
    buffer_load_dwordx4 a[24:27], v10, s[64:67], s79 offen offset:256 sc1
    s_waitcnt vmcnt(9)
    v_mfma_f32_16x16x32_bf16 v[136:139], a[28:31], v[112:115], v[136:139]
    ds_read_b64_tr_b16 v[108:109], v9 offset:24576
    ds_read_b64_tr_b16 v[110:111], v9 offset:25088
    v_mfma_f32_16x16x32_bf16 v[156:159], a[28:31], v[116:119], v[156:159]
    ds_write_b128 v11, a[96:99] offset:20480
    ds_write_b128 v11, a[100:103] offset:21504
    v_mfma_f32_16x16x32_bf16 v[176:179], a[28:31], v[120:123], v[176:179]
    v_mfma_f32_16x16x32_bf16 v[196:199], a[28:31], v[124:127], v[196:199]
    buffer_load_dwordx4 a[28:31], v10, s[64:67], s79 offen offset:512 sc1
    s_waitcnt vmcnt(9)
    v_mfma_f32_16x16x32_bf16 v[140:143], a[32:35], v[112:115], v[140:143]
    ds_write_b128 v11, a[104:107] offset:22528
    v_mfma_f32_16x16x32_bf16 v[160:163], a[32:35], v[116:119], v[160:163]
    v_mfma_f32_16x16x32_bf16 v[180:183], a[32:35], v[120:123], v[180:183]
    v_mfma_f32_16x16x32_bf16 v[200:203], a[32:35], v[124:127], v[200:203]
    buffer_load_dwordx4 a[32:35], v10, s[64:67], s79 offen offset:768 sc1
    s_waitcnt vmcnt(9)
    v_mfma_f32_16x16x32_bf16 v[144:147], a[36:39], v[112:115], v[144:147]
    ds_write_b128 v11, a[108:111] offset:23552
    v_mfma_f32_16x16x32_bf16 v[164:167], a[36:39], v[116:119], v[164:167]
    v_mfma_f32_16x16x32_bf16 v[184:187], a[36:39], v[120:123], v[184:187]
    v_mfma_f32_16x16x32_bf16 v[204:207], a[36:39], v[124:127], v[204:207]
    buffer_load_dwordx4 a[36:39], v10, s[64:67], s79 offen offset:1024 sc1
    s_waitcnt lgkmcnt(4)
    s_waitcnt vmcnt(9)
    v_mfma_f32_16x16x32_bf16 v[128:131], a[0:3], v[96:99], v[128:131]
    s_add_u32 s79, s79, 40960
    ds_read_b64_tr_b16 v[112:113], v6 offset:28672
    v_mfma_f32_16x16x32_bf16 v[148:151], a[0:3], v[100:103], v[148:151]
    ds_read_b64_tr_b16 v[114:115], v6 offset:29184
    ds_read_b64_tr_b16 v[116:117], v7 offset:28672
    v_mfma_f32_16x16x32_bf16 v[168:171], a[0:3], v[104:107], v[168:171]
    v_mfma_f32_16x16x32_bf16 v[188:191], a[0:3], v[108:111], v[188:191]
    buffer_load_dwordx4 a[0:3], v10, s[64:67], s79 offen sc1
    s_waitcnt vmcnt(9)
    v_mfma_f32_16x16x32_bf16 v[132:135], a[4:7], v[96:99], v[132:135]
    ds_read_b64_tr_b16 v[118:119], v7 offset:29184
    ds_read_b64_tr_b16 v[120:121], v8 offset:28672
    v_mfma_f32_16x16x32_bf16 v[152:155], a[4:7], v[100:103], v[152:155]
    ds_read_b64_tr_b16 v[122:123], v8 offset:29184
    v_mfma_f32_16x16x32_bf16 v[172:175], a[4:7], v[104:107], v[172:175]
    v_mfma_f32_16x16x32_bf16 v[192:195], a[4:7], v[108:111], v[192:195]
    buffer_load_dwordx4 a[4:7], v10, s[64:67], s79 offen offset:256 sc1
    s_waitcnt vmcnt(9)
    v_mfma_f32_16x16x32_bf16 v[136:139], a[8:11], v[96:99], v[136:139]
    ds_read_b64_tr_b16 v[124:125], v9 offset:28672
    ds_read_b64_tr_b16 v[126:127], v9 offset:29184
    v_mfma_f32_16x16x32_bf16 v[156:159], a[8:11], v[100:103], v[156:159]
    ds_write_b128 v11, a[40:43] offset:24576
    ds_write_b128 v11, a[44:47] offset:25600
    v_mfma_f32_16x16x32_bf16 v[176:179], a[8:11], v[104:107], v[176:179]
    v_mfma_f32_16x16x32_bf16 v[196:199], a[8:11], v[108:111], v[196:199]
    buffer_load_dwordx4 a[8:11], v10, s[64:67], s79 offen offset:512 sc1
    s_waitcnt vmcnt(9)
    v_mfma_f32_16x16x32_bf16 v[140:143], a[12:15], v[96:99], v[140:143]
    ds_write_b128 v11, a[48:51] offset:26624
    v_mfma_f32_16x16x32_bf16 v[160:163], a[12:15], v[100:103], v[160:163]
    v_mfma_f32_16x16x32_bf16 v[180:183], a[12:15], v[104:107], v[180:183]
    v_mfma_f32_16x16x32_bf16 v[200:203], a[12:15], v[108:111], v[200:203]
    buffer_load_dwordx4 a[12:15], v10, s[64:67], s79 offen offset:768 sc1
    s_waitcnt vmcnt(9)
    v_mfma_f32_16x16x32_bf16 v[144:147], a[16:19], v[96:99], v[144:147]
    ds_write_b128 v11, a[52:55] offset:27648
    v_mfma_f32_16x16x32_bf16 v[164:167], a[16:19], v[100:103], v[164:167]
    v_mfma_f32_16x16x32_bf16 v[184:187], a[16:19], v[104:107], v[184:187]
    v_mfma_f32_16x16x32_bf16 v[204:207], a[16:19], v[108:111], v[204:207]
    buffer_load_dwordx4 a[16:19], v10, s[64:67], s79 offen offset:1024 sc1
    s_waitcnt lgkmcnt(4)
    s_waitcnt vmcnt(9)
    v_mfma_f32_16x16x32_bf16 v[128:131], a[20:23], v[112:115], v[128:131]
    s_add_u32 s79, s79, 40960
    ds_read_b64_tr_b16 v[96:97], v6 offset:0
    v_mfma_f32_16x16x32_bf16 v[148:151], a[20:23], v[116:119], v[148:151]
    ds_read_b64_tr_b16 v[98:99], v6 offset:512
    ds_read_b64_tr_b16 v[100:101], v7 offset:0
    v_mfma_f32_16x16x32_bf16 v[168:171], a[20:23], v[120:123], v[168:171]
    v_mfma_f32_16x16x32_bf16 v[188:191], a[20:23], v[124:127], v[188:191]
    buffer_load_dwordx4 a[20:23], v10, s[64:67], s79 offen sc1
    s_waitcnt vmcnt(9)
    v_mfma_f32_16x16x32_bf16 v[132:135], a[24:27], v[112:115], v[132:135]
    ds_read_b64_tr_b16 v[102:103], v7 offset:512
    ds_read_b64_tr_b16 v[104:105], v8 offset:0
    v_mfma_f32_16x16x32_bf16 v[152:155], a[24:27], v[116:119], v[152:155]
    ds_read_b64_tr_b16 v[106:107], v8 offset:512
    v_mfma_f32_16x16x32_bf16 v[172:175], a[24:27], v[120:123], v[172:175]
    v_mfma_f32_16x16x32_bf16 v[192:195], a[24:27], v[124:127], v[192:195]
    buffer_load_dwordx4 a[24:27], v10, s[64:67], s79 offen offset:256 sc1
    s_waitcnt vmcnt(9)
    v_mfma_f32_16x16x32_bf16 v[136:139], a[28:31], v[112:115], v[136:139]
    ds_read_b64_tr_b16 v[108:109], v9 offset:0
    ds_read_b64_tr_b16 v[110:111], v9 offset:512
    v_mfma_f32_16x16x32_bf16 v[156:159], a[28:31], v[116:119], v[156:159]
    ds_write_b128 v11, a[56:59] offset:28672
    ds_write_b128 v11, a[60:63] offset:29696
    v_mfma_f32_16x16x32_bf16 v[176:179], a[28:31], v[120:123], v[176:179]
    v_mfma_f32_16x16x32_bf16 v[196:199], a[28:31], v[124:127], v[196:199]
    buffer_load_dwordx4 a[28:31], v10, s[64:67], s79 offen offset:512 sc1
    s_waitcnt vmcnt(9)
    v_mfma_f32_16x16x32_bf16 v[140:143], a[32:35], v[112:115], v[140:143]
    ds_write_b128 v11, a[64:67] offset:30720
    v_mfma_f32_16x16x32_bf16 v[160:163], a[32:35], v[116:119], v[160:163]
    v_mfma_f32_16x16x32_bf16 v[180:183], a[32:35], v[120:123], v[180:183]
    v_mfma_f32_16x16x32_bf16 v[200:203], a[32:35], v[124:127], v[200:203]
    buffer_load_dwordx4 a[32:35], v10, s[64:67], s79 offen offset:768 sc1
    s_waitcnt vmcnt(9)
    v_mfma_f32_16x16x32_bf16 v[144:147], a[36:39], v[112:115], v[144:147]
    ds_write_b128 v11, a[68:71] offset:31744
    v_mfma_f32_16x16x32_bf16 v[164:167], a[36:39], v[116:119], v[164:167]
    v_mfma_f32_16x16x32_bf16 v[184:187], a[36:39], v[120:123], v[184:187]
    v_mfma_f32_16x16x32_bf16 v[204:207], a[36:39], v[124:127], v[204:207]
    buffer_load_dwordx4 a[36:39], v10, s[64:67], s79 offen offset:1024 sc1
    s_waitcnt lgkmcnt(4)
    s_waitcnt vmcnt(9)
    v_mfma_f32_16x16x32_bf16 v[128:131], a[0:3], v[96:99], v[128:131]
    s_add_u32 s79, s79, 40960
    ds_read_b64_tr_b16 v[112:113], v6 offset:4096
    v_mfma_f32_16x16x32_bf16 v[148:151], a[0:3], v[100:103], v[148:151]
    ds_read_b64_tr_b16 v[114:115], v6 offset:4608
    ds_read_b64_tr_b16 v[116:117], v7 offset:4096
    v_mfma_f32_16x16x32_bf16 v[168:171], a[0:3], v[104:107], v[168:171]
    v_mfma_f32_16x16x32_bf16 v[188:191], a[0:3], v[108:111], v[188:191]
    buffer_load_dwordx4 a[0:3], v10, s[64:67], s79 offen sc1
    s_waitcnt vmcnt(9)
    v_mfma_f32_16x16x32_bf16 v[132:135], a[4:7], v[96:99], v[132:135]
    ds_read_b64_tr_b16 v[118:119], v7 offset:4608
    ds_read_b64_tr_b16 v[120:121], v8 offset:4096
    v_mfma_f32_16x16x32_bf16 v[152:155], a[4:7], v[100:103], v[152:155]
    ds_read_b64_tr_b16 v[122:123], v8 offset:4608
    v_mfma_f32_16x16x32_bf16 v[172:175], a[4:7], v[104:107], v[172:175]
    v_mfma_f32_16x16x32_bf16 v[192:195], a[4:7], v[108:111], v[192:195]
    buffer_load_dwordx4 a[4:7], v10, s[64:67], s79 offen offset:256 sc1
    s_waitcnt vmcnt(9)
    v_mfma_f32_16x16x32_bf16 v[136:139], a[8:11], v[96:99], v[136:139]
    ds_read_b64_tr_b16 v[124:125], v9 offset:4096
    ds_read_b64_tr_b16 v[126:127], v9 offset:4608
    v_mfma_f32_16x16x32_bf16 v[156:159], a[8:11], v[100:103], v[156:159]
    ds_write_b128 v11, a[224:227] offset:0
    ds_write_b128 v11, a[228:231] offset:1024
    v_mfma_f32_16x16x32_bf16 v[176:179], a[8:11], v[104:107], v[176:179]
    v_mfma_f32_16x16x32_bf16 v[196:199], a[8:11], v[108:111], v[196:199]
    buffer_load_dwordx4 a[8:11], v10, s[64:67], s79 offen offset:512 sc1
    s_waitcnt vmcnt(9)
    v_mfma_f32_16x16x32_bf16 v[140:143], a[12:15], v[96:99], v[140:143]
    ds_write_b128 v11, a[232:235] offset:2048
    v_mfma_f32_16x16x32_bf16 v[160:163], a[12:15], v[100:103], v[160:163]
    v_mfma_f32_16x16x32_bf16 v[180:183], a[12:15], v[104:107], v[180:183]
    v_mfma_f32_16x16x32_bf16 v[200:203], a[12:15], v[108:111], v[200:203]
    buffer_load_dwordx4 a[12:15], v10, s[64:67], s79 offen offset:768 sc1
    s_waitcnt vmcnt(9)
    v_mfma_f32_16x16x32_bf16 v[144:147], a[16:19], v[96:99], v[144:147]
    ds_write_b128 v11, a[236:239] offset:3072
    v_mfma_f32_16x16x32_bf16 v[164:167], a[16:19], v[100:103], v[164:167]
    v_mfma_f32_16x16x32_bf16 v[184:187], a[16:19], v[104:107], v[184:187]
    v_mfma_f32_16x16x32_bf16 v[204:207], a[16:19], v[108:111], v[204:207]
    buffer_load_dwordx4 a[16:19], v10, s[64:67], s79 offen offset:1024 sc1
    s_waitcnt lgkmcnt(4)
    s_waitcnt vmcnt(9)
    v_mfma_f32_16x16x32_bf16 v[128:131], a[20:23], v[112:115], v[128:131]
    s_add_u32 s79, s79, 40960
    ds_read_b64_tr_b16 v[96:97], v6 offset:8192
    v_mfma_f32_16x16x32_bf16 v[148:151], a[20:23], v[116:119], v[148:151]
    ds_read_b64_tr_b16 v[98:99], v6 offset:8704
    ds_read_b64_tr_b16 v[100:101], v7 offset:8192
    v_mfma_f32_16x16x32_bf16 v[168:171], a[20:23], v[120:123], v[168:171]
    v_mfma_f32_16x16x32_bf16 v[188:191], a[20:23], v[124:127], v[188:191]
    buffer_load_dwordx4 a[20:23], v10, s[64:67], s79 offen sc1
    s_waitcnt vmcnt(9)
    v_mfma_f32_16x16x32_bf16 v[132:135], a[24:27], v[112:115], v[132:135]
    ds_read_b64_tr_b16 v[102:103], v7 offset:8704
    ds_read_b64_tr_b16 v[104:105], v8 offset:8192
    v_mfma_f32_16x16x32_bf16 v[152:155], a[24:27], v[116:119], v[152:155]
    ds_read_b64_tr_b16 v[106:107], v8 offset:8704
    v_mfma_f32_16x16x32_bf16 v[172:175], a[24:27], v[120:123], v[172:175]
    v_mfma_f32_16x16x32_bf16 v[192:195], a[24:27], v[124:127], v[192:195]
    buffer_load_dwordx4 a[24:27], v10, s[64:67], s79 offen offset:256 sc1
    s_waitcnt vmcnt(9)
    v_mfma_f32_16x16x32_bf16 v[136:139], a[28:31], v[112:115], v[136:139]
    ds_read_b64_tr_b16 v[108:109], v9 offset:8192
    ds_read_b64_tr_b16 v[110:111], v9 offset:8704
    v_mfma_f32_16x16x32_bf16 v[156:159], a[28:31], v[116:119], v[156:159]
    ds_write_b128 v11, a[240:243] offset:4096
    ds_write_b128 v11, a[244:247] offset:5120
    v_mfma_f32_16x16x32_bf16 v[176:179], a[28:31], v[120:123], v[176:179]
    v_mfma_f32_16x16x32_bf16 v[196:199], a[28:31], v[124:127], v[196:199]
    buffer_load_dwordx4 a[28:31], v10, s[64:67], s79 offen offset:512 sc1
    s_waitcnt vmcnt(9)
    v_mfma_f32_16x16x32_bf16 v[140:143], a[32:35], v[112:115], v[140:143]
    ds_write_b128 v11, a[248:251] offset:6144
    v_mfma_f32_16x16x32_bf16 v[160:163], a[32:35], v[116:119], v[160:163]
    v_mfma_f32_16x16x32_bf16 v[180:183], a[32:35], v[120:123], v[180:183]
    v_mfma_f32_16x16x32_bf16 v[200:203], a[32:35], v[124:127], v[200:203]
    buffer_load_dwordx4 a[32:35], v10, s[64:67], s79 offen offset:768 sc1
    s_waitcnt vmcnt(9)
    v_mfma_f32_16x16x32_bf16 v[144:147], a[36:39], v[112:115], v[144:147]
    s_movk_i32 s85, 6554
    v_add_u32 v21, 0, v0
    v_mfma_f32_16x16x32_bf16 v[164:167], a[36:39], v[116:119], v[164:167]
    v_mul_lo_u32 v22, v21, s85
    v_lshrrev_b32 v22, 16, v22
    v_mfma_f32_16x16x32_bf16 v[184:187], a[36:39], v[120:123], v[184:187]
    v_mul_u32_u24 v23, 10, v22
    v_sub_u32 v21, v21, v23
    v_mfma_f32_16x16x32_bf16 v[204:207], a[36:39], v[124:127], v[204:207]
    buffer_load_dwordx4 a[36:39], v10, s[64:67], s79 offen offset:1024 sc1
    s_waitcnt lgkmcnt(3)
    s_waitcnt vmcnt(9)
    v_mfma_f32_16x16x32_bf16 v[128:131], a[0:3], v[96:99], v[128:131]
    v_mul_u32_u24 v22, 1280, v22
    v_lshl_add_u32 v61, v21, 4, v22
    v_mfma_f32_16x16x32_bf16 v[148:151], a[0:3], v[100:103], v[148:151]
    v_add_u32 v21, 64, v0
    v_mul_lo_u32 v22, v21, s85
    v_mfma_f32_16x16x32_bf16 v[168:171], a[0:3], v[104:107], v[168:171]
    v_lshrrev_b32 v22, 16, v22
    v_mul_u32_u24 v23, 10, v22
    v_mfma_f32_16x16x32_bf16 v[188:191], a[0:3], v[108:111], v[188:191]
    v_sub_u32 v21, v21, v23
    v_mul_u32_u24 v22, 1280, v22
    s_waitcnt vmcnt(8)
    v_mfma_f32_16x16x32_bf16 v[132:135], a[4:7], v[96:99], v[132:135]
    v_lshl_add_u32 v62, v21, 4, v22
    v_add_u32 v21, 128, v0
    v_mfma_f32_16x16x32_bf16 v[152:155], a[4:7], v[100:103], v[152:155]
    v_mul_lo_u32 v22, v21, s85
    v_lshrrev_b32 v22, 16, v22
    v_mfma_f32_16x16x32_bf16 v[172:175], a[4:7], v[104:107], v[172:175]
    v_mul_u32_u24 v23, 10, v22
    v_sub_u32 v21, v21, v23
    v_mfma_f32_16x16x32_bf16 v[192:195], a[4:7], v[108:111], v[192:195]
    v_mul_u32_u24 v22, 1280, v22
    v_lshl_add_u32 v63, v21, 4, v22
    s_waitcnt vmcnt(7)
    v_mfma_f32_16x16x32_bf16 v[136:139], a[8:11], v[96:99], v[136:139]
    ds_write_b128 v11, a[252:255] offset:7168
    s_add_u32 s79, s79, 40960
    v_mfma_f32_16x16x32_bf16 v[156:159], a[8:11], v[100:103], v[156:159]
    buffer_load_dwordx4 a[4:7], v10, s[64:67], s79 offen offset:256 sc1
    v_mfma_f32_16x16x32_bf16 v[176:179], a[8:11], v[104:107], v[176:179]
    buffer_load_dwordx4 a[0:3], v10, s[64:67], s79 offen sc1
    v_mfma_f32_16x16x32_bf16 v[196:199], a[8:11], v[108:111], v[196:199]
    buffer_load_dwordx4 a[8:11], v10, s[64:67], s79 offen offset:512 sc1
    s_waitcnt vmcnt(9)
    v_mfma_f32_16x16x32_bf16 v[140:143], a[12:15], v[96:99], v[140:143]
    ds_read_b64_tr_b16 v[112:113], v6 offset:12288
    ds_read_b64_tr_b16 v[114:115], v6 offset:12800
    v_mfma_f32_16x16x32_bf16 v[160:163], a[12:15], v[100:103], v[160:163]
    ds_read_b64_tr_b16 v[116:117], v7 offset:12288
    ds_read_b64_tr_b16 v[118:119], v7 offset:12800
    v_mfma_f32_16x16x32_bf16 v[180:183], a[12:15], v[104:107], v[180:183]
    ds_read_b64_tr_b16 v[120:121], v8 offset:12288
    ds_read_b64_tr_b16 v[122:123], v8 offset:12800
    v_mfma_f32_16x16x32_bf16 v[200:203], a[12:15], v[108:111], v[200:203]
    buffer_load_dwordx4 a[12:15], v10, s[64:67], s79 offen offset:768 sc1
    s_waitcnt vmcnt(9)
    v_mfma_f32_16x16x32_bf16 v[144:147], a[16:19], v[96:99], v[144:147]
    ds_read_b64_tr_b16 v[124:125], v9 offset:12288
    ds_read_b64_tr_b16 v[126:127], v9 offset:12800
    v_mfma_f32_16x16x32_bf16 v[164:167], a[16:19], v[100:103], v[164:167]
    ds_write_b128 v11, a[112:115] offset:8192
    ds_write_b128 v11, a[116:119] offset:9216
    v_mfma_f32_16x16x32_bf16 v[184:187], a[16:19], v[104:107], v[184:187]
    ds_write_b128 v11, a[120:123] offset:10240
    s_lshl_b32 s14, s3, 5
    v_mfma_f32_16x16x32_bf16 v[204:207], a[16:19], v[108:111], v[204:207]
    s_add_u32 s14, s14, 131072
    buffer_load_dwordx4 a[16:19], v10, s[64:67], s79 offen offset:1024 sc1
    s_waitcnt lgkmcnt(3)
    s_waitcnt vmcnt(9)
    v_mfma_f32_16x16x32_bf16 v[128:131], a[20:23], v[112:115], v[128:131]
    v_lshrrev_b32 v16, 2, v0
    v_and_b32 v17, 3, v0
    v_mfma_f32_16x16x32_bf16 v[148:151], a[20:23], v[116:119], v[148:151]
    v_lshlrev_b32 v17, 3, v17
    v_add_u32 v17, s14, v17
    v_mfma_f32_16x16x32_bf16 v[168:171], a[20:23], v[120:123], v[168:171]
    v_add_u32 v22, 0, v16
    v_cmp_le_u32 vcc, 40, v22
    v_mfma_f32_16x16x32_bf16 v[188:191], a[20:23], v[124:127], v[188:191]
    v_lshl_add_u32 v22, v22, 7, v17
    v_add_u32 v23, 3616, v22
    s_waitcnt vmcnt(8)
    v_mfma_f32_16x16x32_bf16 v[132:135], a[24:27], v[112:115], v[132:135]
    v_cndmask_b32 v56, v22, v23, vcc
    v_add_u32 v22, 16, v16
    v_mfma_f32_16x16x32_bf16 v[152:155], a[24:27], v[116:119], v[152:155]
    v_cmp_le_u32 vcc, 40, v22
    v_lshl_add_u32 v22, v22, 7, v17
    v_mfma_f32_16x16x32_bf16 v[172:175], a[24:27], v[120:123], v[172:175]
    v_add_u32 v23, 3616, v22
    v_cndmask_b32 v57, v22, v23, vcc
    v_mfma_f32_16x16x32_bf16 v[192:195], a[24:27], v[124:127], v[192:195]
    v_add_u32 v22, 32, v16
    v_cmp_le_u32 vcc, 40, v22
    s_waitcnt vmcnt(7)
    v_mfma_f32_16x16x32_bf16 v[136:139], a[28:31], v[112:115], v[136:139]
    v_lshl_add_u32 v22, v22, 7, v17
    v_add_u32 v23, 3616, v22
    v_mfma_f32_16x16x32_bf16 v[156:159], a[28:31], v[116:119], v[156:159]
    v_cndmask_b32 v58, v22, v23, vcc
    v_add_u32 v22, 48, v16
    v_mfma_f32_16x16x32_bf16 v[176:179], a[28:31], v[120:123], v[176:179]
    v_cmp_le_u32 vcc, 40, v22
    v_lshl_add_u32 v22, v22, 7, v17
    v_mfma_f32_16x16x32_bf16 v[196:199], a[28:31], v[124:127], v[196:199]
    v_add_u32 v23, 3616, v22
    v_cndmask_b32 v59, v22, v23, vcc
    s_waitcnt vmcnt(6)
    v_mfma_f32_16x16x32_bf16 v[140:143], a[32:35], v[112:115], v[140:143]
    v_add_u32 v22, 64, v16
    v_cmp_le_u32 vcc, 40, v22
    v_mfma_f32_16x16x32_bf16 v[160:163], a[32:35], v[116:119], v[160:163]
    v_lshl_add_u32 v22, v22, 7, v17
    v_add_u32 v23, 3616, v22
    v_mfma_f32_16x16x32_bf16 v[180:183], a[32:35], v[120:123], v[180:183]
    v_cndmask_b32 v60, v22, v23, vcc
    v_and_b32 v16, 15, v0
    v_mfma_f32_16x16x32_bf16 v[200:203], a[32:35], v[124:127], v[200:203]
    v_mul_u32_u24 v16, 160, v16
    v_lshrrev_b32 v17, 4, v0
    s_waitcnt vmcnt(5)
    v_mfma_f32_16x16x32_bf16 v[144:147], a[36:39], v[112:115], v[144:147]
    v_lshl_add_u32 v16, v17, 3, v16
    v_add_u32 v16, s72, v16
    v_mfma_f32_16x16x32_bf16 v[164:167], a[36:39], v[116:119], v[164:167]
    v_and_b32 v27, 127, v30
    v_add_u32 v27, 157408, v27
    v_mfma_f32_16x16x32_bf16 v[184:187], a[36:39], v[120:123], v[184:187]
    ds_write_b128 v11, a[124:127] offset:11264
    s_add_u32 s79, s79, 40960
    v_mfma_f32_16x16x32_bf16 v[204:207], a[36:39], v[124:127], v[204:207]
    buffer_load_dwordx4 a[36:39], v10, s[64:67], s79 offen offset:1024 sc1
    buffer_load_dwordx4 a[32:35], v10, s[64:67], s79 offen offset:768 sc1
    buffer_load_dwordx4 a[28:31], v10, s[64:67], s79 offen offset:512 sc1
    buffer_load_dwordx4 a[24:27], v10, s[64:67], s79 offen offset:256 sc1
    buffer_load_dwordx4 a[20:23], v10, s[64:67], s79 offen sc1
    ds_read_b64_tr_b16 v[96:97], v6 offset:16384
    ds_read_b64_tr_b16 v[98:99], v6 offset:16896
    ds_read_b64_tr_b16 v[100:101], v7 offset:16384
    ds_read_b64_tr_b16 v[102:103], v7 offset:16896
    ds_read_b64_tr_b16 v[104:105], v8 offset:16384
    ds_read_b64_tr_b16 v[106:107], v8 offset:16896
    ds_read_b64_tr_b16 v[108:109], v9 offset:16384
    ds_read_b64_tr_b16 v[110:111], v9 offset:16896
    s_waitcnt lgkmcnt(0)
    s_waitcnt vmcnt(8)
    v_mfma_f32_16x16x32_bf16 v[128:131], a[0:3], v[96:99], v[128:131]
    s_add_u32 s79, s79, 40960
    ds_read_b64_tr_b16 v[112:113], v6 offset:20480
    v_mfma_f32_16x16x32_bf16 v[148:151], a[0:3], v[100:103], v[148:151]
    ds_read_b64_tr_b16 v[114:115], v6 offset:20992
    ds_read_b64_tr_b16 v[116:117], v7 offset:20480
    v_mfma_f32_16x16x32_bf16 v[168:171], a[0:3], v[104:107], v[168:171]
    v_mfma_f32_16x16x32_bf16 v[188:191], a[0:3], v[108:111], v[188:191]
    buffer_load_dwordx4 a[0:3], v10, s[64:67], s79 offen sc1
    v_mfma_f32_16x16x32_bf16 v[132:135], a[4:7], v[96:99], v[132:135]
    ds_read_b64_tr_b16 v[118:119], v7 offset:20992
    ds_read_b64_tr_b16 v[120:121], v8 offset:20480
    v_mfma_f32_16x16x32_bf16 v[152:155], a[4:7], v[100:103], v[152:155]
    ds_read_b64_tr_b16 v[122:123], v8 offset:20992
    v_mfma_f32_16x16x32_bf16 v[172:175], a[4:7], v[104:107], v[172:175]
    v_mfma_f32_16x16x32_bf16 v[192:195], a[4:7], v[108:111], v[192:195]
    buffer_load_dwordx4 a[4:7], v10, s[64:67], s79 offen offset:256 sc1
    s_waitcnt vmcnt(9)
    v_mfma_f32_16x16x32_bf16 v[136:139], a[8:11], v[96:99], v[136:139]
    ds_read_b64_tr_b16 v[124:125], v9 offset:20480
    ds_read_b64_tr_b16 v[126:127], v9 offset:20992
    v_mfma_f32_16x16x32_bf16 v[156:159], a[8:11], v[100:103], v[156:159]
    v_mfma_f32_16x16x32_bf16 v[176:179], a[8:11], v[104:107], v[176:179]
    v_mfma_f32_16x16x32_bf16 v[196:199], a[8:11], v[108:111], v[196:199]
    buffer_load_dwordx4 a[8:11], v10, s[64:67], s79 offen offset:512 sc1
    s_waitcnt vmcnt(9)
    v_mfma_f32_16x16x32_bf16 v[140:143], a[12:15], v[96:99], v[140:143]
    v_mfma_f32_16x16x32_bf16 v[160:163], a[12:15], v[100:103], v[160:163]
    v_mfma_f32_16x16x32_bf16 v[180:183], a[12:15], v[104:107], v[180:183]
    v_mfma_f32_16x16x32_bf16 v[200:203], a[12:15], v[108:111], v[200:203]
    buffer_load_dwordx4 a[12:15], v10, s[64:67], s79 offen offset:768 sc1
    s_waitcnt vmcnt(9)
    v_mfma_f32_16x16x32_bf16 v[144:147], a[16:19], v[96:99], v[144:147]
    v_mfma_f32_16x16x32_bf16 v[164:167], a[16:19], v[100:103], v[164:167]
    v_mfma_f32_16x16x32_bf16 v[184:187], a[16:19], v[104:107], v[184:187]
    v_mfma_f32_16x16x32_bf16 v[204:207], a[16:19], v[108:111], v[204:207]
    buffer_load_dwordx4 a[16:19], v10, s[64:67], s79 offen offset:1024 sc1
    s_waitcnt lgkmcnt(0)
    s_waitcnt vmcnt(5)
    v_mfma_f32_16x16x32_bf16 v[128:131], a[20:23], v[112:115], v[128:131]
    s_add_u32 s79, s79, 40960
    ds_read_b64_tr_b16 v[96:97], v6 offset:24576
    v_mfma_f32_16x16x32_bf16 v[148:151], a[20:23], v[116:119], v[148:151]
    ds_read_b64_tr_b16 v[98:99], v6 offset:25088
    ds_read_b64_tr_b16 v[100:101], v7 offset:24576
    v_mfma_f32_16x16x32_bf16 v[168:171], a[20:23], v[120:123], v[168:171]
    v_mfma_f32_16x16x32_bf16 v[188:191], a[20:23], v[124:127], v[188:191]
    buffer_load_dwordx4 a[20:23], v10, s[64:67], s79 offen sc1
    v_mfma_f32_16x16x32_bf16 v[132:135], a[24:27], v[112:115], v[132:135]
    ds_read_b64_tr_b16 v[102:103], v7 offset:25088
    ds_read_b64_tr_b16 v[104:105], v8 offset:24576
    v_mfma_f32_16x16x32_bf16 v[152:155], a[24:27], v[116:119], v[152:155]
    ds_read_b64_tr_b16 v[106:107], v8 offset:25088
    v_mfma_f32_16x16x32_bf16 v[172:175], a[24:27], v[120:123], v[172:175]
    v_mfma_f32_16x16x32_bf16 v[192:195], a[24:27], v[124:127], v[192:195]
    buffer_load_dwordx4 a[24:27], v10, s[64:67], s79 offen offset:256 sc1
    v_mfma_f32_16x16x32_bf16 v[136:139], a[28:31], v[112:115], v[136:139]
    ds_read_b64_tr_b16 v[108:109], v9 offset:24576
    ds_read_b64_tr_b16 v[110:111], v9 offset:25088
    v_mfma_f32_16x16x32_bf16 v[156:159], a[28:31], v[116:119], v[156:159]
    v_mfma_f32_16x16x32_bf16 v[176:179], a[28:31], v[120:123], v[176:179]
    v_mfma_f32_16x16x32_bf16 v[196:199], a[28:31], v[124:127], v[196:199]
    buffer_load_dwordx4 a[28:31], v10, s[64:67], s79 offen offset:512 sc1
    v_mfma_f32_16x16x32_bf16 v[140:143], a[32:35], v[112:115], v[140:143]
    v_mfma_f32_16x16x32_bf16 v[160:163], a[32:35], v[116:119], v[160:163]
    v_mfma_f32_16x16x32_bf16 v[180:183], a[32:35], v[120:123], v[180:183]
    v_mfma_f32_16x16x32_bf16 v[200:203], a[32:35], v[124:127], v[200:203]
    buffer_load_dwordx4 a[32:35], v10, s[64:67], s79 offen offset:768 sc1
    v_mfma_f32_16x16x32_bf16 v[144:147], a[36:39], v[112:115], v[144:147]
    v_mfma_f32_16x16x32_bf16 v[164:167], a[36:39], v[116:119], v[164:167]
    v_mfma_f32_16x16x32_bf16 v[184:187], a[36:39], v[120:123], v[184:187]
    v_mfma_f32_16x16x32_bf16 v[204:207], a[36:39], v[124:127], v[204:207]
    buffer_load_dwordx4 a[36:39], v10, s[64:67], s79 offen offset:1024 sc1
    s_waitcnt lgkmcnt(0)
    s_waitcnt vmcnt(9)
    v_mfma_f32_16x16x32_bf16 v[128:131], a[0:3], v[96:99], v[128:131]
    s_add_u32 s79, s79, 40960
    ds_read_b64_tr_b16 v[112:113], v6 offset:28672
    v_mfma_f32_16x16x32_bf16 v[148:151], a[0:3], v[100:103], v[148:151]
    ds_read_b64_tr_b16 v[114:115], v6 offset:29184
    ds_read_b64_tr_b16 v[116:117], v7 offset:28672
    v_mfma_f32_16x16x32_bf16 v[168:171], a[0:3], v[104:107], v[168:171]
    v_mfma_f32_16x16x32_bf16 v[188:191], a[0:3], v[108:111], v[188:191]
    buffer_load_dwordx4 a[0:3], v10, s[64:67], s79 offen sc1
    s_waitcnt vmcnt(9)
    v_mfma_f32_16x16x32_bf16 v[132:135], a[4:7], v[96:99], v[132:135]
    ds_read_b64_tr_b16 v[118:119], v7 offset:29184
    ds_read_b64_tr_b16 v[120:121], v8 offset:28672
    v_mfma_f32_16x16x32_bf16 v[152:155], a[4:7], v[100:103], v[152:155]
    ds_read_b64_tr_b16 v[122:123], v8 offset:29184
    v_mfma_f32_16x16x32_bf16 v[172:175], a[4:7], v[104:107], v[172:175]
    v_mfma_f32_16x16x32_bf16 v[192:195], a[4:7], v[108:111], v[192:195]
    buffer_load_dwordx4 a[4:7], v10, s[64:67], s79 offen offset:256 sc1
    s_waitcnt vmcnt(9)
    v_mfma_f32_16x16x32_bf16 v[136:139], a[8:11], v[96:99], v[136:139]
    ds_read_b64_tr_b16 v[124:125], v9 offset:28672
    ds_read_b64_tr_b16 v[126:127], v9 offset:29184
    v_mfma_f32_16x16x32_bf16 v[156:159], a[8:11], v[100:103], v[156:159]
    v_mfma_f32_16x16x32_bf16 v[176:179], a[8:11], v[104:107], v[176:179]
    v_mfma_f32_16x16x32_bf16 v[196:199], a[8:11], v[108:111], v[196:199]
    buffer_load_dwordx4 a[8:11], v10, s[64:67], s79 offen offset:512 sc1
    s_waitcnt vmcnt(9)
    v_mfma_f32_16x16x32_bf16 v[140:143], a[12:15], v[96:99], v[140:143]
    v_mfma_f32_16x16x32_bf16 v[160:163], a[12:15], v[100:103], v[160:163]
    v_mfma_f32_16x16x32_bf16 v[180:183], a[12:15], v[104:107], v[180:183]
    v_mfma_f32_16x16x32_bf16 v[200:203], a[12:15], v[108:111], v[200:203]
    buffer_load_dwordx4 a[12:15], v10, s[64:67], s79 offen offset:768 sc1
    s_waitcnt vmcnt(9)
    v_mfma_f32_16x16x32_bf16 v[144:147], a[16:19], v[96:99], v[144:147]
    v_mfma_f32_16x16x32_bf16 v[164:167], a[16:19], v[100:103], v[164:167]
    v_mfma_f32_16x16x32_bf16 v[184:187], a[16:19], v[104:107], v[184:187]
    v_mfma_f32_16x16x32_bf16 v[204:207], a[16:19], v[108:111], v[204:207]
    buffer_load_dwordx4 a[16:19], v10, s[64:67], s79 offen offset:1024 sc1
    s_waitcnt lgkmcnt(0)
    s_waitcnt vmcnt(9)
    v_mfma_f32_16x16x32_bf16 v[128:131], a[20:23], v[112:115], v[128:131]
    s_add_u32 s79, s79, 40960
    ds_read_b64_tr_b16 v[96:97], v6 offset:0
    v_mfma_f32_16x16x32_bf16 v[148:151], a[20:23], v[116:119], v[148:151]
    ds_read_b64_tr_b16 v[98:99], v6 offset:512
    ds_read_b64_tr_b16 v[100:101], v7 offset:0
    v_mfma_f32_16x16x32_bf16 v[168:171], a[20:23], v[120:123], v[168:171]
    v_mfma_f32_16x16x32_bf16 v[188:191], a[20:23], v[124:127], v[188:191]
    buffer_load_dwordx4 a[20:23], v10, s[64:67], s79 offen sc1
    s_waitcnt vmcnt(9)
    v_mfma_f32_16x16x32_bf16 v[132:135], a[24:27], v[112:115], v[132:135]
    ds_read_b64_tr_b16 v[102:103], v7 offset:512
    ds_read_b64_tr_b16 v[104:105], v8 offset:0
    v_mfma_f32_16x16x32_bf16 v[152:155], a[24:27], v[116:119], v[152:155]
    ds_read_b64_tr_b16 v[106:107], v8 offset:512
    v_mfma_f32_16x16x32_bf16 v[172:175], a[24:27], v[120:123], v[172:175]
    v_mfma_f32_16x16x32_bf16 v[192:195], a[24:27], v[124:127], v[192:195]
    buffer_load_dwordx4 a[24:27], v10, s[64:67], s79 offen offset:256 sc1
    s_waitcnt vmcnt(9)
    v_mfma_f32_16x16x32_bf16 v[136:139], a[28:31], v[112:115], v[136:139]
    ds_read_b64_tr_b16 v[108:109], v9 offset:0
    ds_read_b64_tr_b16 v[110:111], v9 offset:512
    v_mfma_f32_16x16x32_bf16 v[156:159], a[28:31], v[116:119], v[156:159]
    v_mfma_f32_16x16x32_bf16 v[176:179], a[28:31], v[120:123], v[176:179]
    v_mfma_f32_16x16x32_bf16 v[196:199], a[28:31], v[124:127], v[196:199]
    buffer_load_dwordx4 a[28:31], v10, s[64:67], s79 offen offset:512 sc1
    s_waitcnt vmcnt(9)
    v_mfma_f32_16x16x32_bf16 v[140:143], a[32:35], v[112:115], v[140:143]
    v_mfma_f32_16x16x32_bf16 v[160:163], a[32:35], v[116:119], v[160:163]
    v_mfma_f32_16x16x32_bf16 v[180:183], a[32:35], v[120:123], v[180:183]
    v_mfma_f32_16x16x32_bf16 v[200:203], a[32:35], v[124:127], v[200:203]
    buffer_load_dwordx4 a[32:35], v10, s[64:67], s79 offen offset:768 sc1
    s_waitcnt vmcnt(9)
    v_mfma_f32_16x16x32_bf16 v[144:147], a[36:39], v[112:115], v[144:147]
    v_mfma_f32_16x16x32_bf16 v[164:167], a[36:39], v[116:119], v[164:167]
    v_mfma_f32_16x16x32_bf16 v[184:187], a[36:39], v[120:123], v[184:187]
    v_mfma_f32_16x16x32_bf16 v[204:207], a[36:39], v[124:127], v[204:207]
    buffer_load_dwordx4 a[36:39], v10, s[64:67], s79 offen offset:1024 sc1
    s_waitcnt lgkmcnt(0)
    s_waitcnt vmcnt(9)
    v_mfma_f32_16x16x32_bf16 v[128:131], a[0:3], v[96:99], v[128:131]
    s_add_u32 s79, s79, 40960
    ds_read_b64_tr_b16 v[112:113], v6 offset:4096
    v_mfma_f32_16x16x32_bf16 v[148:151], a[0:3], v[100:103], v[148:151]
    ds_read_b64_tr_b16 v[114:115], v6 offset:4608
    ds_read_b64_tr_b16 v[116:117], v7 offset:4096
    v_mfma_f32_16x16x32_bf16 v[168:171], a[0:3], v[104:107], v[168:171]
    v_mfma_f32_16x16x32_bf16 v[188:191], a[0:3], v[108:111], v[188:191]
    buffer_load_dwordx4 a[0:3], v10, s[64:67], s79 offen sc1
    s_waitcnt vmcnt(9)
    v_mfma_f32_16x16x32_bf16 v[132:135], a[4:7], v[96:99], v[132:135]
    ds_read_b64_tr_b16 v[118:119], v7 offset:4608
    ds_read_b64_tr_b16 v[120:121], v8 offset:4096
    v_mfma_f32_16x16x32_bf16 v[152:155], a[4:7], v[100:103], v[152:155]
    ds_read_b64_tr_b16 v[122:123], v8 offset:4608
    v_mfma_f32_16x16x32_bf16 v[172:175], a[4:7], v[104:107], v[172:175]
    v_mfma_f32_16x16x32_bf16 v[192:195], a[4:7], v[108:111], v[192:195]
    buffer_load_dwordx4 a[4:7], v10, s[64:67], s79 offen offset:256 sc1
    s_waitcnt vmcnt(9)
    v_mfma_f32_16x16x32_bf16 v[136:139], a[8:11], v[96:99], v[136:139]
    ds_read_b64_tr_b16 v[124:125], v9 offset:4096
    ds_read_b64_tr_b16 v[126:127], v9 offset:4608
    v_mfma_f32_16x16x32_bf16 v[156:159], a[8:11], v[100:103], v[156:159]
    v_mfma_f32_16x16x32_bf16 v[176:179], a[8:11], v[104:107], v[176:179]
    v_mfma_f32_16x16x32_bf16 v[196:199], a[8:11], v[108:111], v[196:199]
    buffer_load_dwordx4 a[8:11], v10, s[64:67], s79 offen offset:512 sc1
    s_waitcnt vmcnt(9)
    v_mfma_f32_16x16x32_bf16 v[140:143], a[12:15], v[96:99], v[140:143]
    v_mfma_f32_16x16x32_bf16 v[160:163], a[12:15], v[100:103], v[160:163]
    v_mfma_f32_16x16x32_bf16 v[180:183], a[12:15], v[104:107], v[180:183]
    v_mfma_f32_16x16x32_bf16 v[200:203], a[12:15], v[108:111], v[200:203]
    buffer_load_dwordx4 a[12:15], v10, s[64:67], s79 offen offset:768 sc1
    s_waitcnt vmcnt(9)
    v_mfma_f32_16x16x32_bf16 v[144:147], a[16:19], v[96:99], v[144:147]
    v_mfma_f32_16x16x32_bf16 v[164:167], a[16:19], v[100:103], v[164:167]
    v_mfma_f32_16x16x32_bf16 v[184:187], a[16:19], v[104:107], v[184:187]
    v_mfma_f32_16x16x32_bf16 v[204:207], a[16:19], v[108:111], v[204:207]
    buffer_load_dwordx4 a[16:19], v10, s[64:67], s79 offen offset:1024 sc1
    s_waitcnt lgkmcnt(0)
    s_waitcnt vmcnt(9)
    v_mfma_f32_16x16x32_bf16 v[128:131], a[20:23], v[112:115], v[128:131]
    ds_read_b64_tr_b16 v[96:97], v6 offset:8192
    ds_read_b64_tr_b16 v[98:99], v6 offset:8704
    v_mfma_f32_16x16x32_bf16 v[148:151], a[20:23], v[116:119], v[148:151]
    ds_read_b64_tr_b16 v[100:101], v7 offset:8192
    v_mfma_f32_16x16x32_bf16 v[168:171], a[20:23], v[120:123], v[168:171]
    v_mfma_f32_16x16x32_bf16 v[188:191], a[20:23], v[124:127], v[188:191]
    s_waitcnt vmcnt(8)
    v_mfma_f32_16x16x32_bf16 v[132:135], a[24:27], v[112:115], v[132:135]
    ds_read_b64_tr_b16 v[102:103], v7 offset:8704
    ds_read_b64_tr_b16 v[104:105], v8 offset:8192
    v_mfma_f32_16x16x32_bf16 v[152:155], a[24:27], v[116:119], v[152:155]
    ds_read_b64_tr_b16 v[106:107], v8 offset:8704
    v_mfma_f32_16x16x32_bf16 v[172:175], a[24:27], v[120:123], v[172:175]
    v_mfma_f32_16x16x32_bf16 v[192:195], a[24:27], v[124:127], v[192:195]
    s_waitcnt vmcnt(7)
    v_mfma_f32_16x16x32_bf16 v[136:139], a[28:31], v[112:115], v[136:139]
    ds_read_b64_tr_b16 v[108:109], v9 offset:8192
    ds_read_b64_tr_b16 v[110:111], v9 offset:8704
    v_mfma_f32_16x16x32_bf16 v[156:159], a[28:31], v[116:119], v[156:159]
    v_mfma_f32_16x16x32_bf16 v[176:179], a[28:31], v[120:123], v[176:179]
    v_mfma_f32_16x16x32_bf16 v[196:199], a[28:31], v[124:127], v[196:199]
    s_waitcnt vmcnt(6)
    v_mfma_f32_16x16x32_bf16 v[140:143], a[32:35], v[112:115], v[140:143]
    v_mfma_f32_16x16x32_bf16 v[160:163], a[32:35], v[116:119], v[160:163]
    v_mfma_f32_16x16x32_bf16 v[180:183], a[32:35], v[120:123], v[180:183]
    v_mfma_f32_16x16x32_bf16 v[200:203], a[32:35], v[124:127], v[200:203]
    s_waitcnt vmcnt(5)
    v_mfma_f32_16x16x32_bf16 v[144:147], a[36:39], v[112:115], v[144:147]
    v_mfma_f32_16x16x32_bf16 v[164:167], a[36:39], v[116:119], v[164:167]
    v_mfma_f32_16x16x32_bf16 v[184:187], a[36:39], v[120:123], v[184:187]
    v_mfma_f32_16x16x32_bf16 v[204:207], a[36:39], v[124:127], v[204:207]
    s_waitcnt lgkmcnt(0)
    s_waitcnt vmcnt(4)
    v_mfma_f32_16x16x32_bf16 v[148:151], a[0:3], v[100:103], v[148:151]
    s_waitcnt vmcnt(3)
    v_mfma_f32_16x16x32_bf16 v[152:155], a[4:7], v[100:103], v[152:155]
    s_waitcnt vmcnt(2)
    v_mfma_f32_16x16x32_bf16 v[156:159], a[8:11], v[100:103], v[156:159]
    s_waitcnt vmcnt(1)
    v_mfma_f32_16x16x32_bf16 v[160:163], a[12:15], v[100:103], v[160:163]
    s_waitcnt vmcnt(0)
    v_mfma_f32_16x16x32_bf16 v[164:167], a[16:19], v[100:103], v[164:167]
    v_mfma_f32_16x16x32_bf16 v[168:171], a[0:3], v[104:107], v[168:171]
    ds_write_b128 v11, v[148:151] offset:0
    v_mfma_f32_16x16x32_bf16 v[172:175], a[4:7], v[104:107], v[172:175]
    ds_write_b128 v11, v[152:155] offset:1024
    v_mfma_f32_16x16x32_bf16 v[176:179], a[8:11], v[104:107], v[176:179]
    ds_write_b128 v11, v[156:159] offset:2048
    v_mfma_f32_16x16x32_bf16 v[180:183], a[12:15], v[104:107], v[180:183]
    ds_write_b128 v11, v[160:163] offset:3072
    v_mfma_f32_16x16x32_bf16 v[184:187], a[16:19], v[104:107], v[184:187]
    ds_write_b128 v11, v[164:167] offset:4096
    v_mfma_f32_16x16x32_bf16 v[188:191], a[0:3], v[108:111], v[188:191]
    ds_write_b128 v11, v[168:171] offset:5120
    v_mfma_f32_16x16x32_bf16 v[192:195], a[4:7], v[108:111], v[192:195]
    ds_write_b128 v11, v[172:175] offset:6144
    v_mfma_f32_16x16x32_bf16 v[196:199], a[8:11], v[108:111], v[196:199]
    ds_write_b128 v11, v[176:179] offset:7168
    v_mfma_f32_16x16x32_bf16 v[200:203], a[12:15], v[108:111], v[200:203]
    ds_write_b128 v11, v[180:183] offset:8192
    v_mfma_f32_16x16x32_bf16 v[204:207], a[16:19], v[108:111], v[204:207]
    ds_write_b128 v11, v[184:187] offset:9216
    v_mfma_f32_16x16x32_bf16 v[128:131], a[0:3], v[96:99], v[128:131]
    ds_write_b128 v11, v[188:191] offset:10240
    v_mfma_f32_16x16x32_bf16 v[132:135], a[4:7], v[96:99], v[132:135]
    v_mfma_f32_16x16x32_bf16 v[136:139], a[8:11], v[96:99], v[136:139]
    v_mfma_f32_16x16x32_bf16 v[140:143], a[12:15], v[96:99], v[140:143]
    v_mfma_f32_16x16x32_bf16 v[144:147], a[16:19], v[96:99], v[144:147]
    ds_write_b128 v11, v[192:195] offset:11264
    ds_write_b128 v11, v[196:199] offset:12288
    ds_write_b128 v11, v[200:203] offset:13312
    ds_write_b128 v11, v[204:207] offset:14336
L_loop2e:
    s_lshl_b32 s14, s8, 2
    s_add_u32 s14, s14, s3
    s_mul_i32 s14, s14, 20480
    s_mul_i32 s15, s90, 160
    s_add_u32 s14, s14, s15
    v_lshlrev_b32 v28, 16, v15
    s_waitcnt lgkmcnt(0)
    s_barrier
    ds_read_u16 v27, v27
    ds_read_b128 v[148:151], v12 offset:0
    ds_read_b128 v[168:171], v13 offset:5120
    ds_read_b128 v[188:191], v14 offset:10240
    ds_read_b64_tr_b16 v[32:33], v56
    ds_read_b128 v[152:155], v12 offset:1024
    ds_read_b128 v[172:175], v13 offset:6144
    ds_read_b128 v[192:195], v14 offset:11264
    ds_read_b64_tr_b16 v[34:35], v57
    ds_read_b128 v[156:159], v12 offset:2048
    ds_read_b128 v[176:179], v13 offset:7168
    ds_read_b128 v[196:199], v14 offset:12288
    ds_read_b64_tr_b16 v[36:37], v58
    ds_read_b128 v[160:163], v12 offset:3072
    ds_read_b128 v[180:183], v13 offset:8192
    ds_read_b128 v[200:203], v14 offset:13312
    ds_read_b64_tr_b16 v[38:39], v59
    ds_read_b128 v[164:167], v12 offset:4096
    ds_read_b128 v[184:187], v13 offset:9216
    ds_read_b128 v[204:207], v14 offset:14336
    ds_read_b64_tr_b16 v[40:41], v60
    v_pk_add_f32 v[128:129], v[128:129], v[28:29] op_sel_hi:[1,0]
    v_pk_add_f32 v[130:131], v[130:131], v[28:29] op_sel_hi:[1,0]
    v_pk_add_f32 v[132:133], v[132:133], v[28:29] op_sel_hi:[1,0]
    v_pk_add_f32 v[134:135], v[134:135], v[28:29] op_sel_hi:[1,0]
    v_pk_add_f32 v[136:137], v[136:137], v[28:29] op_sel_hi:[1,0]
    v_pk_add_f32 v[138:139], v[138:139], v[28:29] op_sel_hi:[1,0]
    v_pk_add_f32 v[140:141], v[140:141], v[28:29] op_sel_hi:[1,0]
    v_pk_add_f32 v[142:143], v[142:143], v[28:29] op_sel_hi:[1,0]
    v_pk_add_f32 v[144:145], v[144:145], v[28:29] op_sel_hi:[1,0]
    v_pk_add_f32 v[146:147], v[146:147], v[28:29] op_sel_hi:[1,0]
    s_waitcnt lgkmcnt(15)
    v_lshlrev_b32 v24, 16, v27
    v_sub_f32 v26, 1.0, v24
    v_cvt_pk_bf16_f32 v26, v26, v26
    v_lshlrev_b32 v26, 16, v26
    v_pk_add_f32 v[128:129], v[128:129], v[148:149]
    v_pk_add_f32 v[168:169], v[168:169], v[188:189]
    v_pk_add_f32 v[130:131], v[130:131], v[150:151]
    v_pk_add_f32 v[170:171], v[170:171], v[190:191]
    v_pk_add_f32 v[128:129], v[128:129], v[168:169]
    v_pk_add_f32 v[130:131], v[130:131], v[170:171]
    v_lshlrev_b32 v82, 16, v32
    v_and_b32 v83, s83, v32
    v_lshlrev_b32 v86, 16, v33
    v_and_b32 v87, s83, v33
    v_pk_mul_f32 v[128:129], v[128:129], v[26:27] op_sel_hi:[1,0]
    v_pk_mul_f32 v[130:131], v[130:131], v[26:27] op_sel_hi:[1,0]
    v_pk_fma_f32 v[128:129], v[82:83], v[24:25], v[128:129] op_sel_hi:[1,0,1]
    v_pk_fma_f32 v[130:131], v[86:87], v[24:25], v[130:131] op_sel_hi:[1,0,1]
    v_cvt_pk_bf16_f32 v64, v128, v129
    v_cvt_pk_bf16_f32 v65, v130, v131
    ds_write_b64 v16, v[64:65] offset:16384
    s_waitcnt lgkmcnt(13)
    v_pk_add_f32 v[132:133], v[132:133], v[152:153]
    v_pk_add_f32 v[172:173], v[172:173], v[192:193]
    v_pk_add_f32 v[134:135], v[134:135], v[154:155]
    v_pk_add_f32 v[174:175], v[174:175], v[194:195]
    v_pk_add_f32 v[132:133], v[132:133], v[172:173]
    v_pk_add_f32 v[134:135], v[134:135], v[174:175]
    v_lshlrev_b32 v82, 16, v34
    v_and_b32 v83, s83, v34
    v_lshlrev_b32 v86, 16, v35
    v_and_b32 v87, s83, v35
    v_pk_mul_f32 v[132:133], v[132:133], v[26:27] op_sel_hi:[1,0]
    v_pk_mul_f32 v[134:135], v[134:135], v[26:27] op_sel_hi:[1,0]
    v_pk_fma_f32 v[132:133], v[82:83], v[24:25], v[132:133] op_sel_hi:[1,0,1]
    v_pk_fma_f32 v[134:135], v[86:87], v[24:25], v[134:135] op_sel_hi:[1,0,1]
    v_cvt_pk_bf16_f32 v66, v132, v133
    v_cvt_pk_bf16_f32 v67, v134, v135
    ds_write_b64 v16, v[66:67] offset:16416
    s_waitcnt lgkmcnt(10)
    v_pk_add_f32 v[136:137], v[136:137], v[156:157]
    v_pk_add_f32 v[176:177], v[176:177], v[196:197]
    v_pk_add_f32 v[138:139], v[138:139], v[158:159]
    v_pk_add_f32 v[178:179], v[178:179], v[198:199]
    v_pk_add_f32 v[136:137], v[136:137], v[176:177]
    v_pk_add_f32 v[138:139], v[138:139], v[178:179]
    v_lshlrev_b32 v82, 16, v36
    v_and_b32 v83, s83, v36
    v_lshlrev_b32 v86, 16, v37
    v_and_b32 v87, s83, v37
    v_pk_mul_f32 v[136:137], v[136:137], v[26:27] op_sel_hi:[1,0]
    v_pk_mul_f32 v[138:139], v[138:139], v[26:27] op_sel_hi:[1,0]
    v_pk_fma_f32 v[136:137], v[82:83], v[24:25], v[136:137] op_sel_hi:[1,0,1]
    v_pk_fma_f32 v[138:139], v[86:87], v[24:25], v[138:139] op_sel_hi:[1,0,1]
    v_cvt_pk_bf16_f32 v68, v136, v137
    v_cvt_pk_bf16_f32 v69, v138, v139
    ds_write_b64 v16, v[68:69] offset:16448
    s_waitcnt lgkmcnt(7)
    v_pk_add_f32 v[140:141], v[140:141], v[160:161]
    v_pk_add_f32 v[180:181], v[180:181], v[200:201]
    v_pk_add_f32 v[142:143], v[142:143], v[162:163]
    v_pk_add_f32 v[182:183], v[182:183], v[202:203]
    v_pk_add_f32 v[140:141], v[140:141], v[180:181]
    v_pk_add_f32 v[142:143], v[142:143], v[182:183]
    v_lshlrev_b32 v82, 16, v38
    v_and_b32 v83, s83, v38
    v_lshlrev_b32 v86, 16, v39
    v_and_b32 v87, s83, v39
    v_pk_mul_f32 v[140:141], v[140:141], v[26:27] op_sel_hi:[1,0]
    v_pk_mul_f32 v[142:143], v[142:143], v[26:27] op_sel_hi:[1,0]
    v_pk_fma_f32 v[140:141], v[82:83], v[24:25], v[140:141] op_sel_hi:[1,0,1]
    v_pk_fma_f32 v[142:143], v[86:87], v[24:25], v[142:143] op_sel_hi:[1,0,1]
    v_cvt_pk_bf16_f32 v70, v140, v141
    v_cvt_pk_bf16_f32 v71, v142, v143
    ds_write_b64 v16, v[70:71] offset:16480
    s_waitcnt lgkmcnt(4)
    v_pk_add_f32 v[144:145], v[144:145], v[164:165]
    v_pk_add_f32 v[184:185], v[184:185], v[204:205]
    v_pk_add_f32 v[146:147], v[146:147], v[166:167]
    v_pk_add_f32 v[186:187], v[186:187], v[206:207]
    v_pk_add_f32 v[144:145], v[144:145], v[184:185]
    v_pk_add_f32 v[146:147], v[146:147], v[186:187]
    v_lshlrev_b32 v82, 16, v40
    v_and_b32 v83, s83, v40
    v_lshlrev_b32 v86, 16, v41
    v_and_b32 v87, s83, v41
    v_pk_mul_f32 v[144:145], v[144:145], v[26:27] op_sel_hi:[1,0]
    v_pk_mul_f32 v[146:147], v[146:147], v[26:27] op_sel_hi:[1,0]
    v_pk_fma_f32 v[144:145], v[82:83], v[24:25], v[144:145] op_sel_hi:[1,0,1]
    v_pk_fma_f32 v[146:147], v[86:87], v[24:25], v[146:147] op_sel_hi:[1,0,1]
    v_cvt_pk_bf16_f32 v72, v144, v145
    v_cvt_pk_bf16_f32 v73, v146, v147
    ds_write_b64 v16, v[72:73] offset:16512
    ds_read_b128 v[76:79], v11 offset:16384
    ds_read_b128 v[80:83], v11 offset:17408
    ds_read_b128 v[84:87], v11 offset:18432
    s_waitcnt lgkmcnt(2)
    buffer_store_dwordx4 v[76:79], v61, s[68:71], s14 offen nt
    s_waitcnt lgkmcnt(1)
    buffer_store_dwordx4 v[80:83], v62, s[68:71], s14 offen nt
    s_waitcnt lgkmcnt(0)
    s_mov_b64 exec, 0xffffffff
    buffer_store_dwordx4 v[84:87], v63, s[68:71], s14 offen nt
    s_mov_b64 exec, -1
    s_lshl_b32 s14, s2, 2
    s_add_u32 s14, s14, s3
    s_cmp_lg_u32 s14, 3
    s_cbranch_scc1 L_exit
    v_mov_b32 v20, s4
    v_mov_b32 v21, 0
    s_mov_b64 exec, 1
    buffer_store_dword v20, v21, s[60:63], 0 offen
L_exit:
    s_endpgm
.section .rodata,"a"
.p2align 6
.amdhsa_kernel gated_mix__ssm_conv_s4d__mixer_token_mlp__prompt_kernel
  .amdhsa_next_free_vgpr 512
  .amdhsa_next_free_sgpr 102
  .amdhsa_accum_offset 256
  .amdhsa_group_segment_fixed_size 0
  .amdhsa_kernarg_size 128
  .amdhsa_user_sgpr_count 2
  .amdhsa_user_sgpr_kernarg_segment_ptr 1
  .amdhsa_system_sgpr_workgroup_id_x 1
  .amdhsa_float_denorm_mode_32 3
.end_amdhsa_kernel
```
